```python
import torch

def _softmax(x, axis=-1):
    return torch.softmax(x, dim=axis)
def _gelu(x):
    return torch.nn.functional.gelu(x, approximate="tanh")
def _silu(x):
    return torch.nn.functional.silu(x)
def _sigmoid(x):
    return torch.sigmoid(x)
def _layernorm(x, axis=-1, eps=1e-5):
    m = x.mean(dim=axis, keepdim=True)
    v = x.var(dim=axis, keepdim=True, unbiased=False)
    return (x - m) / torch.sqrt(v + eps)
def _scatter_add(tgt, idx, src, axis=0):
    return tgt.clone().index_add_(axis, idx, src)
def _segment_sum(src, seg, n):
    out = torch.zeros((n,) + src.shape[1:], dtype=src.dtype)
    return out.index_add_(0, seg, src)
def _pad(x, pw):
    flat = tuple(v for pair in reversed(pw) for v in pair)
    return torch.nn.functional.pad(x, flat)

kernel_name = 'sequential_preLN__sliding_local_dilated__glu_gated_glu__prompt'

def setup_inputs():

    _w = (lambda a: (lambda t: t.to(torch.bfloat16) if t.is_floating_point() else t)(torch.as_tensor(a)))
    def _A_setup():
        B, S, D = 1, 2048, 640
        return {
            "x": _w((lambda *s: torch.randn(*s, dtype=torch.bfloat16) * 0.05)(B, S, D)),
            "wqkv": _w((lambda *s: torch.randn(*s, dtype=torch.bfloat16) * 0.05)(D, 3 * D)),
            "wo": _w((lambda *s: torch.randn(*s, dtype=torch.bfloat16) * 0.05)(D, D)),
        }
    _A_in = _A_setup()

    def _B_setup():
        B, S, D, F = 1, 2048, 640, 1536
        return {
            "x": _w((lambda *s: torch.randn(*s, dtype=torch.bfloat16) * 0.05)(B, S, D)),
            "w_gate": _w((lambda *s: torch.randn(*s, dtype=torch.bfloat16) * 0.05)(D, F)),
            "w_up": _w((lambda *s: torch.randn(*s, dtype=torch.bfloat16) * 0.05)(D, F)),
            "w_down": _w((lambda *s: torch.randn(*s, dtype=torch.bfloat16) * 0.05)(F, D)),
        }
    _B_in = _B_setup()

    return {
        "A_x": _A_in["x"],
        "A_wqkv": _A_in["wqkv"],
        "A_wo": _A_in["wo"],
        "B_x": _B_in["x"],
        "B_w_gate": _B_in["w_gate"],
        "B_w_up": _B_in["w_up"],
        "B_w_down": _B_in["w_down"],
    }

def reference(A_x, A_wqkv, A_wo, B_x, B_w_gate, B_w_up, B_w_down):
    def _A_ref(x, wqkv, wo):
        B, S, D = x.shape
        H = 32; Dh = D // H
        W, dil = 8, 2
        qkv = (lambda x, *d: x.permute(*d))((x @ wqkv).reshape(B, S, 3, H, Dh), 2, 0, 3, 1, 4)
        q, k, v = qkv[0], qkv[1], qkv[2]
        scale = Dh ** -0.5
        pos = torch.arange(S)
        off = torch.arange(W) * dil
        idx = pos[:, None] - off[None, :]
        mask = idx >= 0
        idx_c = torch.where(mask, idx, 0).reshape(-1)
        kg = k[:, :, idx_c, :].reshape(B, H, S, W, Dh)
        vg = v[:, :, idx_c, :].reshape(B, H, S, W, Dh)
        logits = torch.einsum("bhsd,bhswd->bhsw", q, kg) * scale
        logits = torch.where(mask[None, None, :, :], logits, -1e9)
        attn = _softmax(logits, axis=-1)
        o = torch.einsum("bhsw,bhswd->bhsd", attn, vg)
        return (lambda x, *d: x.permute(*d))(o, 0, 2, 1, 3).reshape(B, S, D) @ wo

    def _B_ref(x, w_gate, w_up, w_down):
        g = torch.einsum("bsd,df->bsf", x, w_gate)
        u = torch.einsum("bsd,df->bsf", x, w_up)
        h = _sigmoid(g) * u
        return torch.einsum("bsf,fd->bsd", h, w_down)

    x = A_x
    h = x + _A_ref(_layernorm(x, axis=-1), A_wqkv, A_wo)
    h2 = h + _B_ref(_layernorm(h, axis=-1), B_w_gate, B_w_up, B_w_down)
    return h2
```

```asm
; @launch grid=(256,1,1) block=(512,1,1) lds=163840
.amdgcn_target "amdgcn-amd-amdhsa--gfx950"
.text
.globl sequential_preLN__sliding_local_dilated__glu_gated_glu__prompt_kernel
.p2align 8
.type sequential_preLN__sliding_local_dilated__glu_gated_glu__prompt_kernel,@function
sequential_preLN__sliding_local_dilated__glu_gated_glu__prompt_kernel:
L_code_begin:
s_cmp_ge_u32 s2, 256
s_cbranch_scc1 L_end
s_load_dwordx4 s[68:71], s[0:1], 0
s_load_dwordx2 s[72:73], s[0:1], 16
s_load_dwordx8 s[76:83], s[0:1], 32
s_load_dwordx4 s[84:87], s[0:1], 64
s_and_b32 s36, s2, 7
s_lshr_b32 s3, s2, 7
s_lshl_b32 s3, s3, 3
s_add_u32 s36, s36, s3
s_lshr_b32 s37, s2, 3
s_and_b32 s37, s37, 15
v_lshrrev_b32 v4, 6, v0
v_and_b32 v1, 63, v0
v_readfirstlane_b32 s38, v4
v_and_b32 v2, 15, v0
v_bfe_u32 v3, v0, 4, 2
s_getreg_b32 s41, hwreg(HW_REG_XCC_ID, 0, 4)
s_mov_b32 s39, 0
s_mov_b32 s40, 0
s_cmp_eq_u32 s38, 6
s_cbranch_scc1 L_stat
s_cmp_eq_u32 s38, 7
s_cbranch_scc1 L_poll
s_cmp_ge_u32 s38, 4
s_cbranch_scc1 L_dma
L_comp:
s_setprio 1
v_lshrrev_b32 v4, 1, v2
v_add_u32 v6, 0, v3
v_xor_b32 v6, v6, v4
v_lshlrev_b32 v6, 4, v6
v_lshl_add_u32 v25, v2, 7, v6
v_add_u32 v26, 102400, v25
v_add_u32 v6, 4, v3
v_xor_b32 v6, v6, v4
v_lshlrev_b32 v6, 4, v6
v_lshl_add_u32 v27, v2, 7, v6
v_add_u32 v28, 102400, v27
v_lshrrev_b32 v4, 2, v2
v_and_b32 v5, 1, v3
v_lshl_or_b32 v5, v5, 2, v4
v_lshl_add_u32 v6, v3, 3, v4
v_lshlrev_b32 v6, 8, v6
v_and_b32 v7, 1, v2
v_lshl_add_u32 v6, v7, 3, v6
v_bfe_u32 v7, v2, 1, 1
v_lshl_add_u32 v6, v7, 4, v6
v_add_u32 v6, 36864, v6
s_lshl_b32 s44, s38, 1
s_add_u32 s44, s44, 0
v_xor_b32 v7, s44, v5
v_lshl_add_u32 v29, v7, 5, v6
s_lshl_b32 s44, s38, 1
s_add_u32 s44, s44, 1
v_xor_b32 v7, s44, v5
v_lshl_add_u32 v30, v7, 5, v6
v_and_b32 v4, 31, v1
v_lshrrev_b32 v5, 5, v1
v_mul_u32_u24 v5, 18432, v5
v_lshl_add_u32 v4, v4, 2, v5
v_add_u32 v6, 102400, v4
v_mov_b32 v5, 0x3f803f80
ds_write_b32 v4, v5
ds_write_b32 v6, v5
s_waitcnt lgkmcnt(0)
s_mov_b32 s4, s68
s_mov_b32 s5, s69
s_mov_b32 s6, 0x280000
s_mov_b32 s7, 0x20000
s_mov_b32 s8, s70
s_mov_b32 s9, s71
s_mov_b32 s10, 0x258000
s_mov_b32 s11, 0x20000
s_mov_b32 s12, s86
s_mov_b32 s13, s87
s_mov_b32 s14, 0x3000000
s_mov_b32 s15, 0x20000
s_mov_b32 s20, s84
s_mov_b32 s21, s85
s_mov_b32 s22, 0x100
s_mov_b32 s23, 0x20000
s_mov_b32 s16, s82
s_mov_b32 s17, s83
s_mov_b32 s18, 0x280000
s_mov_b32 s19, 0x20000
s_barrier
ds_read_b64_tr_b16 v[208:209], v29 offset:0
ds_read_b64_tr_b16 v[210:211], v29 offset:1024
ds_read_b64_tr_b16 v[212:213], v30 offset:0
ds_read_b64_tr_b16 v[214:215], v30 offset:1024
ds_read_b128 v[136:139], v25 offset:0
ds_read_b128 v[140:143], v25 offset:2048
ds_read_b128 v[144:147], v25 offset:4096
ds_read_b128 v[148:151], v25 offset:6144
ds_read_b128 v[152:155], v25 offset:8192
ds_read_b128 v[156:159], v25 offset:10240
ds_read_b128 v[160:163], v25 offset:12288
ds_read_b128 v[164:167], v25 offset:14336
ds_read_b128 v[168:171], v25 offset:16384
s_waitcnt lgkmcnt(9)
s_waitcnt lgkmcnt(8)
v_mfma_f32_16x16x32_bf16 v[64:67], v[208:211], v[136:139], 0
ds_read_b64_tr_b16 v[216:217], v29 offset:8192
v_mfma_f32_16x16x32_bf16 v[68:71], v[212:215], v[136:139], 0
ds_read_b64_tr_b16 v[218:219], v29 offset:9216
s_waitcnt lgkmcnt(9)
v_mfma_f32_16x16x32_bf16 v[72:75], v[208:211], v[140:143], 0
ds_read_b64_tr_b16 v[220:221], v30 offset:8192
v_mfma_f32_16x16x32_bf16 v[76:79], v[212:215], v[140:143], 0
ds_read_b64_tr_b16 v[222:223], v30 offset:9216
s_waitcnt lgkmcnt(10)
v_mfma_f32_16x16x32_bf16 v[80:83], v[208:211], v[144:147], 0
ds_read_b128 v[172:175], v27 offset:0
v_mfma_f32_16x16x32_bf16 v[84:87], v[212:215], v[144:147], 0
ds_read_b128 v[176:179], v27 offset:2048
s_waitcnt lgkmcnt(11)
v_mfma_f32_16x16x32_bf16 v[88:91], v[208:211], v[148:151], 0
ds_read_b128 v[180:183], v27 offset:4096
v_mfma_f32_16x16x32_bf16 v[92:95], v[212:215], v[148:151], 0
ds_read_b128 v[184:187], v27 offset:6144
s_waitcnt lgkmcnt(12)
v_mfma_f32_16x16x32_bf16 v[96:99], v[208:211], v[152:155], 0
ds_read_b128 v[188:191], v27 offset:8192
v_mfma_f32_16x16x32_bf16 v[100:103], v[212:215], v[152:155], 0
ds_read_b128 v[192:195], v27 offset:10240
s_waitcnt lgkmcnt(13)
v_mfma_f32_16x16x32_bf16 v[104:107], v[208:211], v[156:159], 0
ds_read_b128 v[196:199], v27 offset:12288
v_mfma_f32_16x16x32_bf16 v[108:111], v[212:215], v[156:159], 0
ds_read_b128 v[200:203], v27 offset:14336
s_waitcnt lgkmcnt(14)
v_mfma_f32_16x16x32_bf16 v[112:115], v[208:211], v[160:163], 0
ds_read_b128 v[204:207], v27 offset:16384
v_mfma_f32_16x16x32_bf16 v[116:119], v[212:215], v[160:163], 0
s_waitcnt lgkmcnt(14)
v_mfma_f32_16x16x32_bf16 v[120:123], v[208:211], v[164:167], 0
v_mfma_f32_16x16x32_bf16 v[124:127], v[212:215], v[164:167], 0
s_waitcnt lgkmcnt(13)
v_mfma_f32_16x16x32_bf16 v[128:131], v[208:211], v[168:171], 0
v_mfma_f32_16x16x32_bf16 v[132:135], v[212:215], v[168:171], 0
s_waitcnt lgkmcnt(0)
s_barrier
v_mfma_f32_16x16x32_bf16 v[64:67], v[216:219], v[172:175], v[64:67]
ds_read_b64_tr_b16 v[208:209], v29 offset:16384
v_mfma_f32_16x16x32_bf16 v[68:71], v[220:223], v[172:175], v[68:71]
ds_read_b64_tr_b16 v[210:211], v29 offset:17408
v_mfma_f32_16x16x32_bf16 v[72:75], v[216:219], v[176:179], v[72:75]
ds_read_b64_tr_b16 v[212:213], v30 offset:16384
v_mfma_f32_16x16x32_bf16 v[76:79], v[220:223], v[176:179], v[76:79]
ds_read_b64_tr_b16 v[214:215], v30 offset:17408
v_mfma_f32_16x16x32_bf16 v[80:83], v[216:219], v[180:183], v[80:83]
ds_read_b128 v[136:139], v25 offset:18432
v_mfma_f32_16x16x32_bf16 v[84:87], v[220:223], v[180:183], v[84:87]
ds_read_b128 v[140:143], v25 offset:20480
v_mfma_f32_16x16x32_bf16 v[88:91], v[216:219], v[184:187], v[88:91]
ds_read_b128 v[144:147], v25 offset:22528
v_mfma_f32_16x16x32_bf16 v[92:95], v[220:223], v[184:187], v[92:95]
ds_read_b128 v[148:151], v25 offset:24576
v_mfma_f32_16x16x32_bf16 v[96:99], v[216:219], v[188:191], v[96:99]
ds_read_b128 v[152:155], v25 offset:26624
v_mfma_f32_16x16x32_bf16 v[100:103], v[220:223], v[188:191], v[100:103]
ds_read_b128 v[156:159], v25 offset:28672
v_mfma_f32_16x16x32_bf16 v[104:107], v[216:219], v[192:195], v[104:107]
ds_read_b128 v[160:163], v25 offset:30720
v_mfma_f32_16x16x32_bf16 v[108:111], v[220:223], v[192:195], v[108:111]
ds_read_b128 v[164:167], v25 offset:32768
v_mfma_f32_16x16x32_bf16 v[112:115], v[216:219], v[196:199], v[112:115]
ds_read_b128 v[168:171], v25 offset:34816
v_mfma_f32_16x16x32_bf16 v[116:119], v[220:223], v[196:199], v[116:119]
v_mfma_f32_16x16x32_bf16 v[120:123], v[216:219], v[200:203], v[120:123]
v_mfma_f32_16x16x32_bf16 v[124:127], v[220:223], v[200:203], v[124:127]
v_mfma_f32_16x16x32_bf16 v[128:131], v[216:219], v[204:207], v[128:131]
v_mfma_f32_16x16x32_bf16 v[132:135], v[220:223], v[204:207], v[132:135]
s_waitcnt lgkmcnt(9)
s_waitcnt lgkmcnt(8)
v_mfma_f32_16x16x32_bf16 v[64:67], v[208:211], v[136:139], v[64:67]
ds_read_b64_tr_b16 v[216:217], v29 offset:24576
v_mfma_f32_16x16x32_bf16 v[68:71], v[212:215], v[136:139], v[68:71]
ds_read_b64_tr_b16 v[218:219], v29 offset:25600
s_waitcnt lgkmcnt(9)
v_mfma_f32_16x16x32_bf16 v[72:75], v[208:211], v[140:143], v[72:75]
ds_read_b64_tr_b16 v[220:221], v30 offset:24576
v_mfma_f32_16x16x32_bf16 v[76:79], v[212:215], v[140:143], v[76:79]
ds_read_b64_tr_b16 v[222:223], v30 offset:25600
s_waitcnt lgkmcnt(10)
v_mfma_f32_16x16x32_bf16 v[80:83], v[208:211], v[144:147], v[80:83]
ds_read_b128 v[172:175], v27 offset:18432
v_mfma_f32_16x16x32_bf16 v[84:87], v[212:215], v[144:147], v[84:87]
ds_read_b128 v[176:179], v27 offset:20480
s_waitcnt lgkmcnt(11)
v_mfma_f32_16x16x32_bf16 v[88:91], v[208:211], v[148:151], v[88:91]
ds_read_b128 v[180:183], v27 offset:22528
v_mfma_f32_16x16x32_bf16 v[92:95], v[212:215], v[148:151], v[92:95]
ds_read_b128 v[184:187], v27 offset:24576
s_waitcnt lgkmcnt(12)
v_mfma_f32_16x16x32_bf16 v[96:99], v[208:211], v[152:155], v[96:99]
ds_read_b128 v[188:191], v27 offset:26624
v_mfma_f32_16x16x32_bf16 v[100:103], v[212:215], v[152:155], v[100:103]
ds_read_b128 v[192:195], v27 offset:28672
s_waitcnt lgkmcnt(13)
v_mfma_f32_16x16x32_bf16 v[104:107], v[208:211], v[156:159], v[104:107]
ds_read_b128 v[196:199], v27 offset:30720
v_mfma_f32_16x16x32_bf16 v[108:111], v[212:215], v[156:159], v[108:111]
ds_read_b128 v[200:203], v27 offset:32768
s_waitcnt lgkmcnt(14)
v_mfma_f32_16x16x32_bf16 v[112:115], v[208:211], v[160:163], v[112:115]
ds_read_b128 v[204:207], v27 offset:34816
v_mfma_f32_16x16x32_bf16 v[116:119], v[212:215], v[160:163], v[116:119]
s_waitcnt lgkmcnt(14)
v_mfma_f32_16x16x32_bf16 v[120:123], v[208:211], v[164:167], v[120:123]
v_mfma_f32_16x16x32_bf16 v[124:127], v[212:215], v[164:167], v[124:127]
s_waitcnt lgkmcnt(13)
v_mfma_f32_16x16x32_bf16 v[128:131], v[208:211], v[168:171], v[128:131]
v_mfma_f32_16x16x32_bf16 v[132:135], v[212:215], v[168:171], v[132:135]
s_waitcnt lgkmcnt(0)
s_barrier
v_mfma_f32_16x16x32_bf16 v[64:67], v[216:219], v[172:175], v[64:67]
ds_read_b64_tr_b16 v[208:209], v29 offset:32768
v_mfma_f32_16x16x32_bf16 v[68:71], v[220:223], v[172:175], v[68:71]
ds_read_b64_tr_b16 v[210:211], v29 offset:33792
v_mfma_f32_16x16x32_bf16 v[72:75], v[216:219], v[176:179], v[72:75]
ds_read_b64_tr_b16 v[212:213], v30 offset:32768
v_mfma_f32_16x16x32_bf16 v[76:79], v[220:223], v[176:179], v[76:79]
ds_read_b64_tr_b16 v[214:215], v30 offset:33792
v_mfma_f32_16x16x32_bf16 v[80:83], v[216:219], v[180:183], v[80:83]
ds_read_b128 v[136:139], v26 offset:0
v_mfma_f32_16x16x32_bf16 v[84:87], v[220:223], v[180:183], v[84:87]
ds_read_b128 v[140:143], v26 offset:2048
v_mfma_f32_16x16x32_bf16 v[88:91], v[216:219], v[184:187], v[88:91]
ds_read_b128 v[144:147], v26 offset:4096
v_mfma_f32_16x16x32_bf16 v[92:95], v[220:223], v[184:187], v[92:95]
ds_read_b128 v[148:151], v26 offset:6144
v_mfma_f32_16x16x32_bf16 v[96:99], v[216:219], v[188:191], v[96:99]
ds_read_b128 v[152:155], v26 offset:8192
v_mfma_f32_16x16x32_bf16 v[100:103], v[220:223], v[188:191], v[100:103]
ds_read_b128 v[156:159], v26 offset:10240
v_mfma_f32_16x16x32_bf16 v[104:107], v[216:219], v[192:195], v[104:107]
ds_read_b128 v[160:163], v26 offset:12288
v_mfma_f32_16x16x32_bf16 v[108:111], v[220:223], v[192:195], v[108:111]
ds_read_b128 v[164:167], v26 offset:14336
v_mfma_f32_16x16x32_bf16 v[112:115], v[216:219], v[196:199], v[112:115]
ds_read_b128 v[168:171], v26 offset:16384
v_mfma_f32_16x16x32_bf16 v[116:119], v[220:223], v[196:199], v[116:119]
v_mfma_f32_16x16x32_bf16 v[120:123], v[216:219], v[200:203], v[120:123]
v_mfma_f32_16x16x32_bf16 v[124:127], v[220:223], v[200:203], v[124:127]
v_mfma_f32_16x16x32_bf16 v[128:131], v[216:219], v[204:207], v[128:131]
v_mfma_f32_16x16x32_bf16 v[132:135], v[220:223], v[204:207], v[132:135]
s_waitcnt lgkmcnt(9)
s_waitcnt lgkmcnt(8)
v_mfma_f32_16x16x32_bf16 v[64:67], v[208:211], v[136:139], v[64:67]
ds_read_b64_tr_b16 v[216:217], v29 offset:40960
v_mfma_f32_16x16x32_bf16 v[68:71], v[212:215], v[136:139], v[68:71]
ds_read_b64_tr_b16 v[218:219], v29 offset:41984
s_waitcnt lgkmcnt(9)
v_mfma_f32_16x16x32_bf16 v[72:75], v[208:211], v[140:143], v[72:75]
ds_read_b64_tr_b16 v[220:221], v30 offset:40960
v_mfma_f32_16x16x32_bf16 v[76:79], v[212:215], v[140:143], v[76:79]
ds_read_b64_tr_b16 v[222:223], v30 offset:41984
s_waitcnt lgkmcnt(10)
v_mfma_f32_16x16x32_bf16 v[80:83], v[208:211], v[144:147], v[80:83]
ds_read_b128 v[172:175], v28 offset:0
v_mfma_f32_16x16x32_bf16 v[84:87], v[212:215], v[144:147], v[84:87]
ds_read_b128 v[176:179], v28 offset:2048
s_waitcnt lgkmcnt(11)
v_mfma_f32_16x16x32_bf16 v[88:91], v[208:211], v[148:151], v[88:91]
ds_read_b128 v[180:183], v28 offset:4096
v_mfma_f32_16x16x32_bf16 v[92:95], v[212:215], v[148:151], v[92:95]
ds_read_b128 v[184:187], v28 offset:6144
s_waitcnt lgkmcnt(12)
v_mfma_f32_16x16x32_bf16 v[96:99], v[208:211], v[152:155], v[96:99]
ds_read_b128 v[188:191], v28 offset:8192
v_mfma_f32_16x16x32_bf16 v[100:103], v[212:215], v[152:155], v[100:103]
ds_read_b128 v[192:195], v28 offset:10240
s_waitcnt lgkmcnt(13)
v_mfma_f32_16x16x32_bf16 v[104:107], v[208:211], v[156:159], v[104:107]
ds_read_b128 v[196:199], v28 offset:12288
v_mfma_f32_16x16x32_bf16 v[108:111], v[212:215], v[156:159], v[108:111]
ds_read_b128 v[200:203], v28 offset:14336
s_waitcnt lgkmcnt(14)
v_mfma_f32_16x16x32_bf16 v[112:115], v[208:211], v[160:163], v[112:115]
ds_read_b128 v[204:207], v28 offset:16384
v_mfma_f32_16x16x32_bf16 v[116:119], v[212:215], v[160:163], v[116:119]
s_waitcnt lgkmcnt(14)
v_mfma_f32_16x16x32_bf16 v[120:123], v[208:211], v[164:167], v[120:123]
v_mfma_f32_16x16x32_bf16 v[124:127], v[212:215], v[164:167], v[124:127]
s_waitcnt lgkmcnt(13)
v_mfma_f32_16x16x32_bf16 v[128:131], v[208:211], v[168:171], v[128:131]
v_mfma_f32_16x16x32_bf16 v[132:135], v[212:215], v[168:171], v[132:135]
s_waitcnt lgkmcnt(0)
s_barrier
v_mfma_f32_16x16x32_bf16 v[64:67], v[216:219], v[172:175], v[64:67]
ds_read_b64_tr_b16 v[208:209], v29 offset:49152
v_mfma_f32_16x16x32_bf16 v[68:71], v[220:223], v[172:175], v[68:71]
ds_read_b64_tr_b16 v[210:211], v29 offset:50176
v_mfma_f32_16x16x32_bf16 v[72:75], v[216:219], v[176:179], v[72:75]
ds_read_b64_tr_b16 v[212:213], v30 offset:49152
v_mfma_f32_16x16x32_bf16 v[76:79], v[220:223], v[176:179], v[76:79]
ds_read_b64_tr_b16 v[214:215], v30 offset:50176
v_mfma_f32_16x16x32_bf16 v[80:83], v[216:219], v[180:183], v[80:83]
ds_read_b128 v[136:139], v26 offset:18432
v_mfma_f32_16x16x32_bf16 v[84:87], v[220:223], v[180:183], v[84:87]
ds_read_b128 v[140:143], v26 offset:20480
v_mfma_f32_16x16x32_bf16 v[88:91], v[216:219], v[184:187], v[88:91]
ds_read_b128 v[144:147], v26 offset:22528
v_mfma_f32_16x16x32_bf16 v[92:95], v[220:223], v[184:187], v[92:95]
ds_read_b128 v[148:151], v26 offset:24576
v_mfma_f32_16x16x32_bf16 v[96:99], v[216:219], v[188:191], v[96:99]
ds_read_b128 v[152:155], v26 offset:26624
v_mfma_f32_16x16x32_bf16 v[100:103], v[220:223], v[188:191], v[100:103]
ds_read_b128 v[156:159], v26 offset:28672
v_mfma_f32_16x16x32_bf16 v[104:107], v[216:219], v[192:195], v[104:107]
ds_read_b128 v[160:163], v26 offset:30720
v_mfma_f32_16x16x32_bf16 v[108:111], v[220:223], v[192:195], v[108:111]
ds_read_b128 v[164:167], v26 offset:32768
v_mfma_f32_16x16x32_bf16 v[112:115], v[216:219], v[196:199], v[112:115]
ds_read_b128 v[168:171], v26 offset:34816
v_mfma_f32_16x16x32_bf16 v[116:119], v[220:223], v[196:199], v[116:119]
v_mfma_f32_16x16x32_bf16 v[120:123], v[216:219], v[200:203], v[120:123]
v_mfma_f32_16x16x32_bf16 v[124:127], v[220:223], v[200:203], v[124:127]
v_mfma_f32_16x16x32_bf16 v[128:131], v[216:219], v[204:207], v[128:131]
v_mfma_f32_16x16x32_bf16 v[132:135], v[220:223], v[204:207], v[132:135]
s_waitcnt lgkmcnt(9)
s_waitcnt lgkmcnt(8)
v_mfma_f32_16x16x32_bf16 v[64:67], v[208:211], v[136:139], v[64:67]
ds_read_b64_tr_b16 v[216:217], v29 offset:57344
v_mfma_f32_16x16x32_bf16 v[68:71], v[212:215], v[136:139], v[68:71]
ds_read_b64_tr_b16 v[218:219], v29 offset:58368
s_waitcnt lgkmcnt(9)
v_mfma_f32_16x16x32_bf16 v[72:75], v[208:211], v[140:143], v[72:75]
ds_read_b64_tr_b16 v[220:221], v30 offset:57344
v_mfma_f32_16x16x32_bf16 v[76:79], v[212:215], v[140:143], v[76:79]
ds_read_b64_tr_b16 v[222:223], v30 offset:58368
s_waitcnt lgkmcnt(10)
v_mfma_f32_16x16x32_bf16 v[80:83], v[208:211], v[144:147], v[80:83]
ds_read_b128 v[172:175], v28 offset:18432
v_mfma_f32_16x16x32_bf16 v[84:87], v[212:215], v[144:147], v[84:87]
ds_read_b128 v[176:179], v28 offset:20480
s_waitcnt lgkmcnt(11)
v_mfma_f32_16x16x32_bf16 v[88:91], v[208:211], v[148:151], v[88:91]
ds_read_b128 v[180:183], v28 offset:22528
v_mfma_f32_16x16x32_bf16 v[92:95], v[212:215], v[148:151], v[92:95]
ds_read_b128 v[184:187], v28 offset:24576
s_waitcnt lgkmcnt(12)
v_mfma_f32_16x16x32_bf16 v[96:99], v[208:211], v[152:155], v[96:99]
ds_read_b128 v[188:191], v28 offset:26624
v_mfma_f32_16x16x32_bf16 v[100:103], v[212:215], v[152:155], v[100:103]
ds_read_b128 v[192:195], v28 offset:28672
s_waitcnt lgkmcnt(13)
v_mfma_f32_16x16x32_bf16 v[104:107], v[208:211], v[156:159], v[104:107]
ds_read_b128 v[196:199], v28 offset:30720
v_mfma_f32_16x16x32_bf16 v[108:111], v[212:215], v[156:159], v[108:111]
ds_read_b128 v[200:203], v28 offset:32768
s_waitcnt lgkmcnt(14)
v_mfma_f32_16x16x32_bf16 v[112:115], v[208:211], v[160:163], v[112:115]
ds_read_b128 v[204:207], v28 offset:34816
v_mfma_f32_16x16x32_bf16 v[116:119], v[212:215], v[160:163], v[116:119]
s_waitcnt lgkmcnt(14)
v_mfma_f32_16x16x32_bf16 v[120:123], v[208:211], v[164:167], v[120:123]
v_mfma_f32_16x16x32_bf16 v[124:127], v[212:215], v[164:167], v[124:127]
s_waitcnt lgkmcnt(13)
v_mfma_f32_16x16x32_bf16 v[128:131], v[208:211], v[168:171], v[128:131]
v_mfma_f32_16x16x32_bf16 v[132:135], v[212:215], v[168:171], v[132:135]
s_waitcnt lgkmcnt(0)
s_barrier
v_mfma_f32_16x16x32_bf16 v[64:67], v[216:219], v[172:175], v[64:67]
ds_read_b64_tr_b16 v[208:209], v29 offset:0
v_mfma_f32_16x16x32_bf16 v[68:71], v[220:223], v[172:175], v[68:71]
ds_read_b64_tr_b16 v[210:211], v29 offset:1024
v_mfma_f32_16x16x32_bf16 v[72:75], v[216:219], v[176:179], v[72:75]
ds_read_b64_tr_b16 v[212:213], v30 offset:0
v_mfma_f32_16x16x32_bf16 v[76:79], v[220:223], v[176:179], v[76:79]
ds_read_b64_tr_b16 v[214:215], v30 offset:1024
v_mfma_f32_16x16x32_bf16 v[80:83], v[216:219], v[180:183], v[80:83]
ds_read_b128 v[136:139], v25 offset:0
v_mfma_f32_16x16x32_bf16 v[84:87], v[220:223], v[180:183], v[84:87]
ds_read_b128 v[140:143], v25 offset:2048
v_mfma_f32_16x16x32_bf16 v[88:91], v[216:219], v[184:187], v[88:91]
ds_read_b128 v[144:147], v25 offset:4096
v_mfma_f32_16x16x32_bf16 v[92:95], v[220:223], v[184:187], v[92:95]
ds_read_b128 v[148:151], v25 offset:6144
v_mfma_f32_16x16x32_bf16 v[96:99], v[216:219], v[188:191], v[96:99]
ds_read_b128 v[152:155], v25 offset:8192
v_mfma_f32_16x16x32_bf16 v[100:103], v[220:223], v[188:191], v[100:103]
ds_read_b128 v[156:159], v25 offset:10240
v_mfma_f32_16x16x32_bf16 v[104:107], v[216:219], v[192:195], v[104:107]
ds_read_b128 v[160:163], v25 offset:12288
v_mfma_f32_16x16x32_bf16 v[108:111], v[220:223], v[192:195], v[108:111]
ds_read_b128 v[164:167], v25 offset:14336
v_mfma_f32_16x16x32_bf16 v[112:115], v[216:219], v[196:199], v[112:115]
ds_read_b128 v[168:171], v25 offset:16384
v_mfma_f32_16x16x32_bf16 v[116:119], v[220:223], v[196:199], v[116:119]
v_mfma_f32_16x16x32_bf16 v[120:123], v[216:219], v[200:203], v[120:123]
v_mfma_f32_16x16x32_bf16 v[124:127], v[220:223], v[200:203], v[124:127]
v_mfma_f32_16x16x32_bf16 v[128:131], v[216:219], v[204:207], v[128:131]
v_mfma_f32_16x16x32_bf16 v[132:135], v[220:223], v[204:207], v[132:135]
s_waitcnt lgkmcnt(9)
s_waitcnt lgkmcnt(8)
v_mfma_f32_16x16x32_bf16 v[64:67], v[208:211], v[136:139], v[64:67]
ds_read_b64_tr_b16 v[216:217], v29 offset:8192
v_mfma_f32_16x16x32_bf16 v[68:71], v[212:215], v[136:139], v[68:71]
ds_read_b64_tr_b16 v[218:219], v29 offset:9216
s_waitcnt lgkmcnt(9)
v_mfma_f32_16x16x32_bf16 v[72:75], v[208:211], v[140:143], v[72:75]
ds_read_b64_tr_b16 v[220:221], v30 offset:8192
v_mfma_f32_16x16x32_bf16 v[76:79], v[212:215], v[140:143], v[76:79]
ds_read_b64_tr_b16 v[222:223], v30 offset:9216
s_waitcnt lgkmcnt(10)
v_mfma_f32_16x16x32_bf16 v[80:83], v[208:211], v[144:147], v[80:83]
ds_read_b128 v[172:175], v27 offset:0
v_mfma_f32_16x16x32_bf16 v[84:87], v[212:215], v[144:147], v[84:87]
ds_read_b128 v[176:179], v27 offset:2048
s_waitcnt lgkmcnt(11)
v_mfma_f32_16x16x32_bf16 v[88:91], v[208:211], v[148:151], v[88:91]
ds_read_b128 v[180:183], v27 offset:4096
v_mfma_f32_16x16x32_bf16 v[92:95], v[212:215], v[148:151], v[92:95]
ds_read_b128 v[184:187], v27 offset:6144
s_waitcnt lgkmcnt(12)
v_mfma_f32_16x16x32_bf16 v[96:99], v[208:211], v[152:155], v[96:99]
ds_read_b128 v[188:191], v27 offset:8192
v_mfma_f32_16x16x32_bf16 v[100:103], v[212:215], v[152:155], v[100:103]
ds_read_b128 v[192:195], v27 offset:10240
s_waitcnt lgkmcnt(13)
v_mfma_f32_16x16x32_bf16 v[104:107], v[208:211], v[156:159], v[104:107]
ds_read_b128 v[196:199], v27 offset:12288
v_mfma_f32_16x16x32_bf16 v[108:111], v[212:215], v[156:159], v[108:111]
ds_read_b128 v[200:203], v27 offset:14336
s_waitcnt lgkmcnt(14)
v_mfma_f32_16x16x32_bf16 v[112:115], v[208:211], v[160:163], v[112:115]
ds_read_b128 v[204:207], v27 offset:16384
v_mfma_f32_16x16x32_bf16 v[116:119], v[212:215], v[160:163], v[116:119]
s_waitcnt lgkmcnt(14)
v_mfma_f32_16x16x32_bf16 v[120:123], v[208:211], v[164:167], v[120:123]
v_mfma_f32_16x16x32_bf16 v[124:127], v[212:215], v[164:167], v[124:127]
s_waitcnt lgkmcnt(13)
v_mfma_f32_16x16x32_bf16 v[128:131], v[208:211], v[168:171], v[128:131]
v_mfma_f32_16x16x32_bf16 v[132:135], v[212:215], v[168:171], v[132:135]
s_waitcnt lgkmcnt(0)
s_barrier
v_mfma_f32_16x16x32_bf16 v[64:67], v[216:219], v[172:175], v[64:67]
ds_read_b64_tr_b16 v[208:209], v29 offset:16384
v_mfma_f32_16x16x32_bf16 v[68:71], v[220:223], v[172:175], v[68:71]
ds_read_b64_tr_b16 v[210:211], v29 offset:17408
v_mfma_f32_16x16x32_bf16 v[72:75], v[216:219], v[176:179], v[72:75]
ds_read_b64_tr_b16 v[212:213], v30 offset:16384
v_mfma_f32_16x16x32_bf16 v[76:79], v[220:223], v[176:179], v[76:79]
ds_read_b64_tr_b16 v[214:215], v30 offset:17408
v_mfma_f32_16x16x32_bf16 v[80:83], v[216:219], v[180:183], v[80:83]
ds_read_b128 v[136:139], v25 offset:18432
v_mfma_f32_16x16x32_bf16 v[84:87], v[220:223], v[180:183], v[84:87]
ds_read_b128 v[140:143], v25 offset:20480
v_mfma_f32_16x16x32_bf16 v[88:91], v[216:219], v[184:187], v[88:91]
ds_read_b128 v[144:147], v25 offset:22528
v_mfma_f32_16x16x32_bf16 v[92:95], v[220:223], v[184:187], v[92:95]
ds_read_b128 v[148:151], v25 offset:24576
v_mfma_f32_16x16x32_bf16 v[96:99], v[216:219], v[188:191], v[96:99]
ds_read_b128 v[152:155], v25 offset:26624
v_mfma_f32_16x16x32_bf16 v[100:103], v[220:223], v[188:191], v[100:103]
ds_read_b128 v[156:159], v25 offset:28672
v_mfma_f32_16x16x32_bf16 v[104:107], v[216:219], v[192:195], v[104:107]
ds_read_b128 v[160:163], v25 offset:30720
v_mfma_f32_16x16x32_bf16 v[108:111], v[220:223], v[192:195], v[108:111]
ds_read_b128 v[164:167], v25 offset:32768
v_mfma_f32_16x16x32_bf16 v[112:115], v[216:219], v[196:199], v[112:115]
ds_read_b128 v[168:171], v25 offset:34816
v_mfma_f32_16x16x32_bf16 v[116:119], v[220:223], v[196:199], v[116:119]
v_mfma_f32_16x16x32_bf16 v[120:123], v[216:219], v[200:203], v[120:123]
v_mfma_f32_16x16x32_bf16 v[124:127], v[220:223], v[200:203], v[124:127]
v_mfma_f32_16x16x32_bf16 v[128:131], v[216:219], v[204:207], v[128:131]
v_mfma_f32_16x16x32_bf16 v[132:135], v[220:223], v[204:207], v[132:135]
s_waitcnt lgkmcnt(9)
s_waitcnt lgkmcnt(8)
v_mfma_f32_16x16x32_bf16 v[64:67], v[208:211], v[136:139], v[64:67]
ds_read_b64_tr_b16 v[216:217], v29 offset:24576
v_mfma_f32_16x16x32_bf16 v[68:71], v[212:215], v[136:139], v[68:71]
ds_read_b64_tr_b16 v[218:219], v29 offset:25600
s_waitcnt lgkmcnt(9)
v_mfma_f32_16x16x32_bf16 v[72:75], v[208:211], v[140:143], v[72:75]
ds_read_b64_tr_b16 v[220:221], v30 offset:24576
v_mfma_f32_16x16x32_bf16 v[76:79], v[212:215], v[140:143], v[76:79]
ds_read_b64_tr_b16 v[222:223], v30 offset:25600
s_waitcnt lgkmcnt(10)
v_mfma_f32_16x16x32_bf16 v[80:83], v[208:211], v[144:147], v[80:83]
ds_read_b128 v[172:175], v27 offset:18432
v_mfma_f32_16x16x32_bf16 v[84:87], v[212:215], v[144:147], v[84:87]
ds_read_b128 v[176:179], v27 offset:20480
s_waitcnt lgkmcnt(11)
v_mfma_f32_16x16x32_bf16 v[88:91], v[208:211], v[148:151], v[88:91]
ds_read_b128 v[180:183], v27 offset:22528
v_mfma_f32_16x16x32_bf16 v[92:95], v[212:215], v[148:151], v[92:95]
ds_read_b128 v[184:187], v27 offset:24576
s_waitcnt lgkmcnt(12)
v_mfma_f32_16x16x32_bf16 v[96:99], v[208:211], v[152:155], v[96:99]
ds_read_b128 v[188:191], v27 offset:26624
v_mfma_f32_16x16x32_bf16 v[100:103], v[212:215], v[152:155], v[100:103]
ds_read_b128 v[192:195], v27 offset:28672
s_waitcnt lgkmcnt(13)
v_mfma_f32_16x16x32_bf16 v[104:107], v[208:211], v[156:159], v[104:107]
ds_read_b128 v[196:199], v27 offset:30720
v_mfma_f32_16x16x32_bf16 v[108:111], v[212:215], v[156:159], v[108:111]
ds_read_b128 v[200:203], v27 offset:32768
s_waitcnt lgkmcnt(14)
v_mfma_f32_16x16x32_bf16 v[112:115], v[208:211], v[160:163], v[112:115]
ds_read_b128 v[204:207], v27 offset:34816
v_mfma_f32_16x16x32_bf16 v[116:119], v[212:215], v[160:163], v[116:119]
s_waitcnt lgkmcnt(14)
v_mfma_f32_16x16x32_bf16 v[120:123], v[208:211], v[164:167], v[120:123]
v_mfma_f32_16x16x32_bf16 v[124:127], v[212:215], v[164:167], v[124:127]
s_waitcnt lgkmcnt(13)
v_mfma_f32_16x16x32_bf16 v[128:131], v[208:211], v[168:171], v[128:131]
v_mfma_f32_16x16x32_bf16 v[132:135], v[212:215], v[168:171], v[132:135]
s_waitcnt lgkmcnt(0)
s_barrier
v_mfma_f32_16x16x32_bf16 v[64:67], v[216:219], v[172:175], v[64:67]
ds_read_b64_tr_b16 v[208:209], v29 offset:32768
v_mfma_f32_16x16x32_bf16 v[68:71], v[220:223], v[172:175], v[68:71]
ds_read_b64_tr_b16 v[210:211], v29 offset:33792
v_mfma_f32_16x16x32_bf16 v[72:75], v[216:219], v[176:179], v[72:75]
ds_read_b64_tr_b16 v[212:213], v30 offset:32768
v_mfma_f32_16x16x32_bf16 v[76:79], v[220:223], v[176:179], v[76:79]
ds_read_b64_tr_b16 v[214:215], v30 offset:33792
v_mfma_f32_16x16x32_bf16 v[80:83], v[216:219], v[180:183], v[80:83]
ds_read_b128 v[136:139], v26 offset:0
v_mfma_f32_16x16x32_bf16 v[84:87], v[220:223], v[180:183], v[84:87]
ds_read_b128 v[140:143], v26 offset:2048
v_mfma_f32_16x16x32_bf16 v[88:91], v[216:219], v[184:187], v[88:91]
ds_read_b128 v[144:147], v26 offset:4096
v_mfma_f32_16x16x32_bf16 v[92:95], v[220:223], v[184:187], v[92:95]
ds_read_b128 v[148:151], v26 offset:6144
v_mfma_f32_16x16x32_bf16 v[96:99], v[216:219], v[188:191], v[96:99]
ds_read_b128 v[152:155], v26 offset:8192
v_mfma_f32_16x16x32_bf16 v[100:103], v[220:223], v[188:191], v[100:103]
ds_read_b128 v[156:159], v26 offset:10240
v_mfma_f32_16x16x32_bf16 v[104:107], v[216:219], v[192:195], v[104:107]
ds_read_b128 v[160:163], v26 offset:12288
v_mfma_f32_16x16x32_bf16 v[108:111], v[220:223], v[192:195], v[108:111]
ds_read_b128 v[164:167], v26 offset:14336
v_mfma_f32_16x16x32_bf16 v[112:115], v[216:219], v[196:199], v[112:115]
ds_read_b128 v[168:171], v26 offset:16384
v_mfma_f32_16x16x32_bf16 v[116:119], v[220:223], v[196:199], v[116:119]
v_mfma_f32_16x16x32_bf16 v[120:123], v[216:219], v[200:203], v[120:123]
v_mfma_f32_16x16x32_bf16 v[124:127], v[220:223], v[200:203], v[124:127]
v_mfma_f32_16x16x32_bf16 v[128:131], v[216:219], v[204:207], v[128:131]
v_mfma_f32_16x16x32_bf16 v[132:135], v[220:223], v[204:207], v[132:135]
s_waitcnt lgkmcnt(9)
s_waitcnt lgkmcnt(8)
v_mfma_f32_16x16x32_bf16 v[64:67], v[208:211], v[136:139], v[64:67]
ds_read_b64_tr_b16 v[216:217], v29 offset:40960
v_mfma_f32_16x16x32_bf16 v[68:71], v[212:215], v[136:139], v[68:71]
ds_read_b64_tr_b16 v[218:219], v29 offset:41984
s_waitcnt lgkmcnt(9)
v_mfma_f32_16x16x32_bf16 v[72:75], v[208:211], v[140:143], v[72:75]
ds_read_b64_tr_b16 v[220:221], v30 offset:40960
v_mfma_f32_16x16x32_bf16 v[76:79], v[212:215], v[140:143], v[76:79]
ds_read_b64_tr_b16 v[222:223], v30 offset:41984
s_waitcnt lgkmcnt(10)
v_mfma_f32_16x16x32_bf16 v[80:83], v[208:211], v[144:147], v[80:83]
ds_read_b128 v[172:175], v28 offset:0
v_mfma_f32_16x16x32_bf16 v[84:87], v[212:215], v[144:147], v[84:87]
ds_read_b128 v[176:179], v28 offset:2048
s_waitcnt lgkmcnt(11)
v_mfma_f32_16x16x32_bf16 v[88:91], v[208:211], v[148:151], v[88:91]
ds_read_b128 v[180:183], v28 offset:4096
v_mfma_f32_16x16x32_bf16 v[92:95], v[212:215], v[148:151], v[92:95]
ds_read_b128 v[184:187], v28 offset:6144
s_waitcnt lgkmcnt(12)
v_mfma_f32_16x16x32_bf16 v[96:99], v[208:211], v[152:155], v[96:99]
ds_read_b128 v[188:191], v28 offset:8192
v_mfma_f32_16x16x32_bf16 v[100:103], v[212:215], v[152:155], v[100:103]
ds_read_b128 v[192:195], v28 offset:10240
s_waitcnt lgkmcnt(13)
v_mfma_f32_16x16x32_bf16 v[104:107], v[208:211], v[156:159], v[104:107]
ds_read_b128 v[196:199], v28 offset:12288
v_mfma_f32_16x16x32_bf16 v[108:111], v[212:215], v[156:159], v[108:111]
ds_read_b128 v[200:203], v28 offset:14336
s_waitcnt lgkmcnt(14)
v_mfma_f32_16x16x32_bf16 v[112:115], v[208:211], v[160:163], v[112:115]
ds_read_b128 v[204:207], v28 offset:16384
v_mfma_f32_16x16x32_bf16 v[116:119], v[212:215], v[160:163], v[116:119]
s_waitcnt lgkmcnt(14)
v_mfma_f32_16x16x32_bf16 v[120:123], v[208:211], v[164:167], v[120:123]
v_mfma_f32_16x16x32_bf16 v[124:127], v[212:215], v[164:167], v[124:127]
s_waitcnt lgkmcnt(13)
v_mfma_f32_16x16x32_bf16 v[128:131], v[208:211], v[168:171], v[128:131]
v_mfma_f32_16x16x32_bf16 v[132:135], v[212:215], v[168:171], v[132:135]
s_waitcnt lgkmcnt(0)
s_barrier
v_mfma_f32_16x16x32_bf16 v[64:67], v[216:219], v[172:175], v[64:67]
ds_read_b64_tr_b16 v[208:209], v29 offset:49152
v_mfma_f32_16x16x32_bf16 v[68:71], v[220:223], v[172:175], v[68:71]
ds_read_b64_tr_b16 v[210:211], v29 offset:50176
v_mfma_f32_16x16x32_bf16 v[72:75], v[216:219], v[176:179], v[72:75]
ds_read_b64_tr_b16 v[212:213], v30 offset:49152
v_mfma_f32_16x16x32_bf16 v[76:79], v[220:223], v[176:179], v[76:79]
ds_read_b64_tr_b16 v[214:215], v30 offset:50176
v_mfma_f32_16x16x32_bf16 v[80:83], v[216:219], v[180:183], v[80:83]
ds_read_b128 v[136:139], v26 offset:18432
v_mfma_f32_16x16x32_bf16 v[84:87], v[220:223], v[180:183], v[84:87]
ds_read_b128 v[140:143], v26 offset:20480
v_mfma_f32_16x16x32_bf16 v[88:91], v[216:219], v[184:187], v[88:91]
ds_read_b128 v[144:147], v26 offset:22528
v_mfma_f32_16x16x32_bf16 v[92:95], v[220:223], v[184:187], v[92:95]
ds_read_b128 v[148:151], v26 offset:24576
v_mfma_f32_16x16x32_bf16 v[96:99], v[216:219], v[188:191], v[96:99]
ds_read_b128 v[152:155], v26 offset:26624
v_mfma_f32_16x16x32_bf16 v[100:103], v[220:223], v[188:191], v[100:103]
ds_read_b128 v[156:159], v26 offset:28672
v_mfma_f32_16x16x32_bf16 v[104:107], v[216:219], v[192:195], v[104:107]
ds_read_b128 v[160:163], v26 offset:30720
v_mfma_f32_16x16x32_bf16 v[108:111], v[220:223], v[192:195], v[108:111]
ds_read_b128 v[164:167], v26 offset:32768
v_mfma_f32_16x16x32_bf16 v[112:115], v[216:219], v[196:199], v[112:115]
ds_read_b128 v[168:171], v26 offset:34816
v_mfma_f32_16x16x32_bf16 v[116:119], v[220:223], v[196:199], v[116:119]
v_mfma_f32_16x16x32_bf16 v[120:123], v[216:219], v[200:203], v[120:123]
v_mfma_f32_16x16x32_bf16 v[124:127], v[220:223], v[200:203], v[124:127]
v_mfma_f32_16x16x32_bf16 v[128:131], v[216:219], v[204:207], v[128:131]
v_mfma_f32_16x16x32_bf16 v[132:135], v[220:223], v[204:207], v[132:135]
s_waitcnt lgkmcnt(9)
s_waitcnt lgkmcnt(8)
v_mfma_f32_16x16x32_bf16 v[64:67], v[208:211], v[136:139], v[64:67]
ds_read_b64_tr_b16 v[216:217], v29 offset:57344
v_mfma_f32_16x16x32_bf16 v[68:71], v[212:215], v[136:139], v[68:71]
ds_read_b64_tr_b16 v[218:219], v29 offset:58368
s_waitcnt lgkmcnt(9)
v_mfma_f32_16x16x32_bf16 v[72:75], v[208:211], v[140:143], v[72:75]
ds_read_b64_tr_b16 v[220:221], v30 offset:57344
v_mfma_f32_16x16x32_bf16 v[76:79], v[212:215], v[140:143], v[76:79]
ds_read_b64_tr_b16 v[222:223], v30 offset:58368
s_waitcnt lgkmcnt(10)
v_mfma_f32_16x16x32_bf16 v[80:83], v[208:211], v[144:147], v[80:83]
ds_read_b128 v[172:175], v28 offset:18432
v_mfma_f32_16x16x32_bf16 v[84:87], v[212:215], v[144:147], v[84:87]
ds_read_b128 v[176:179], v28 offset:20480
s_waitcnt lgkmcnt(11)
v_mfma_f32_16x16x32_bf16 v[88:91], v[208:211], v[148:151], v[88:91]
ds_read_b128 v[180:183], v28 offset:22528
v_mfma_f32_16x16x32_bf16 v[92:95], v[212:215], v[148:151], v[92:95]
ds_read_b128 v[184:187], v28 offset:24576
s_waitcnt lgkmcnt(12)
v_mfma_f32_16x16x32_bf16 v[96:99], v[208:211], v[152:155], v[96:99]
ds_read_b128 v[188:191], v28 offset:26624
v_mfma_f32_16x16x32_bf16 v[100:103], v[212:215], v[152:155], v[100:103]
ds_read_b128 v[192:195], v28 offset:28672
s_waitcnt lgkmcnt(13)
v_mfma_f32_16x16x32_bf16 v[104:107], v[208:211], v[156:159], v[104:107]
ds_read_b128 v[196:199], v28 offset:30720
v_mfma_f32_16x16x32_bf16 v[108:111], v[212:215], v[156:159], v[108:111]
ds_read_b128 v[200:203], v28 offset:32768
s_waitcnt lgkmcnt(14)
v_mfma_f32_16x16x32_bf16 v[112:115], v[208:211], v[160:163], v[112:115]
ds_read_b128 v[204:207], v28 offset:34816
v_mfma_f32_16x16x32_bf16 v[116:119], v[212:215], v[160:163], v[116:119]
s_waitcnt lgkmcnt(14)
v_mfma_f32_16x16x32_bf16 v[120:123], v[208:211], v[164:167], v[120:123]
v_mfma_f32_16x16x32_bf16 v[124:127], v[212:215], v[164:167], v[124:127]
s_waitcnt lgkmcnt(13)
v_mfma_f32_16x16x32_bf16 v[128:131], v[208:211], v[168:171], v[128:131]
v_mfma_f32_16x16x32_bf16 v[132:135], v[212:215], v[168:171], v[132:135]
s_waitcnt lgkmcnt(0)
s_barrier
v_mfma_f32_16x16x32_bf16 v[64:67], v[216:219], v[172:175], v[64:67]
ds_read_b64_tr_b16 v[208:209], v29 offset:0
v_mfma_f32_16x16x32_bf16 v[68:71], v[220:223], v[172:175], v[68:71]
ds_read_b64_tr_b16 v[210:211], v29 offset:1024
v_mfma_f32_16x16x32_bf16 v[72:75], v[216:219], v[176:179], v[72:75]
ds_read_b64_tr_b16 v[212:213], v30 offset:0
v_mfma_f32_16x16x32_bf16 v[76:79], v[220:223], v[176:179], v[76:79]
ds_read_b64_tr_b16 v[214:215], v30 offset:1024
v_mfma_f32_16x16x32_bf16 v[80:83], v[216:219], v[180:183], v[80:83]
ds_read_b128 v[136:139], v25 offset:0
v_mfma_f32_16x16x32_bf16 v[84:87], v[220:223], v[180:183], v[84:87]
ds_read_b128 v[140:143], v25 offset:2048
v_mfma_f32_16x16x32_bf16 v[88:91], v[216:219], v[184:187], v[88:91]
ds_read_b128 v[144:147], v25 offset:4096
v_mfma_f32_16x16x32_bf16 v[92:95], v[220:223], v[184:187], v[92:95]
ds_read_b128 v[148:151], v25 offset:6144
v_mfma_f32_16x16x32_bf16 v[96:99], v[216:219], v[188:191], v[96:99]
ds_read_b128 v[152:155], v25 offset:8192
v_mfma_f32_16x16x32_bf16 v[100:103], v[220:223], v[188:191], v[100:103]
ds_read_b128 v[156:159], v25 offset:10240
v_mfma_f32_16x16x32_bf16 v[104:107], v[216:219], v[192:195], v[104:107]
ds_read_b128 v[160:163], v25 offset:12288
v_mfma_f32_16x16x32_bf16 v[108:111], v[220:223], v[192:195], v[108:111]
ds_read_b128 v[164:167], v25 offset:14336
v_mfma_f32_16x16x32_bf16 v[112:115], v[216:219], v[196:199], v[112:115]
ds_read_b128 v[168:171], v25 offset:16384
v_mfma_f32_16x16x32_bf16 v[116:119], v[220:223], v[196:199], v[116:119]
v_mfma_f32_16x16x32_bf16 v[120:123], v[216:219], v[200:203], v[120:123]
v_mfma_f32_16x16x32_bf16 v[124:127], v[220:223], v[200:203], v[124:127]
v_mfma_f32_16x16x32_bf16 v[128:131], v[216:219], v[204:207], v[128:131]
v_mfma_f32_16x16x32_bf16 v[132:135], v[220:223], v[204:207], v[132:135]
s_waitcnt lgkmcnt(9)
s_waitcnt lgkmcnt(8)
v_mfma_f32_16x16x32_bf16 v[64:67], v[208:211], v[136:139], v[64:67]
ds_read_b64_tr_b16 v[216:217], v29 offset:8192
v_mfma_f32_16x16x32_bf16 v[68:71], v[212:215], v[136:139], v[68:71]
ds_read_b64_tr_b16 v[218:219], v29 offset:9216
s_waitcnt lgkmcnt(9)
v_mfma_f32_16x16x32_bf16 v[72:75], v[208:211], v[140:143], v[72:75]
ds_read_b64_tr_b16 v[220:221], v30 offset:8192
v_mfma_f32_16x16x32_bf16 v[76:79], v[212:215], v[140:143], v[76:79]
ds_read_b64_tr_b16 v[222:223], v30 offset:9216
s_waitcnt lgkmcnt(10)
v_mfma_f32_16x16x32_bf16 v[80:83], v[208:211], v[144:147], v[80:83]
ds_read_b128 v[172:175], v27 offset:0
v_mfma_f32_16x16x32_bf16 v[84:87], v[212:215], v[144:147], v[84:87]
ds_read_b128 v[176:179], v27 offset:2048
s_waitcnt lgkmcnt(11)
v_mfma_f32_16x16x32_bf16 v[88:91], v[208:211], v[148:151], v[88:91]
ds_read_b128 v[180:183], v27 offset:4096
v_mfma_f32_16x16x32_bf16 v[92:95], v[212:215], v[148:151], v[92:95]
ds_read_b128 v[184:187], v27 offset:6144
s_waitcnt lgkmcnt(12)
v_mfma_f32_16x16x32_bf16 v[96:99], v[208:211], v[152:155], v[96:99]
ds_read_b128 v[188:191], v27 offset:8192
v_mfma_f32_16x16x32_bf16 v[100:103], v[212:215], v[152:155], v[100:103]
ds_read_b128 v[192:195], v27 offset:10240
s_waitcnt lgkmcnt(13)
v_mfma_f32_16x16x32_bf16 v[104:107], v[208:211], v[156:159], v[104:107]
ds_read_b128 v[196:199], v27 offset:12288
v_mfma_f32_16x16x32_bf16 v[108:111], v[212:215], v[156:159], v[108:111]
ds_read_b128 v[200:203], v27 offset:14336
s_waitcnt lgkmcnt(14)
v_mfma_f32_16x16x32_bf16 v[112:115], v[208:211], v[160:163], v[112:115]
ds_read_b128 v[204:207], v27 offset:16384
v_mfma_f32_16x16x32_bf16 v[116:119], v[212:215], v[160:163], v[116:119]
s_waitcnt lgkmcnt(14)
v_mfma_f32_16x16x32_bf16 v[120:123], v[208:211], v[164:167], v[120:123]
v_mfma_f32_16x16x32_bf16 v[124:127], v[212:215], v[164:167], v[124:127]
s_waitcnt lgkmcnt(13)
v_mfma_f32_16x16x32_bf16 v[128:131], v[208:211], v[168:171], v[128:131]
v_mfma_f32_16x16x32_bf16 v[132:135], v[212:215], v[168:171], v[132:135]
s_waitcnt lgkmcnt(0)
s_barrier
v_mfma_f32_16x16x32_bf16 v[64:67], v[216:219], v[172:175], v[64:67]
ds_read_b64_tr_b16 v[208:209], v29 offset:16384
v_mfma_f32_16x16x32_bf16 v[68:71], v[220:223], v[172:175], v[68:71]
ds_read_b64_tr_b16 v[210:211], v29 offset:17408
v_mfma_f32_16x16x32_bf16 v[72:75], v[216:219], v[176:179], v[72:75]
ds_read_b64_tr_b16 v[212:213], v30 offset:16384
v_mfma_f32_16x16x32_bf16 v[76:79], v[220:223], v[176:179], v[76:79]
ds_read_b64_tr_b16 v[214:215], v30 offset:17408
v_mfma_f32_16x16x32_bf16 v[80:83], v[216:219], v[180:183], v[80:83]
ds_read_b128 v[136:139], v25 offset:18432
v_mfma_f32_16x16x32_bf16 v[84:87], v[220:223], v[180:183], v[84:87]
ds_read_b128 v[140:143], v25 offset:20480
v_mfma_f32_16x16x32_bf16 v[88:91], v[216:219], v[184:187], v[88:91]
ds_read_b128 v[144:147], v25 offset:22528
v_mfma_f32_16x16x32_bf16 v[92:95], v[220:223], v[184:187], v[92:95]
ds_read_b128 v[148:151], v25 offset:24576
v_mfma_f32_16x16x32_bf16 v[96:99], v[216:219], v[188:191], v[96:99]
ds_read_b128 v[152:155], v25 offset:26624
v_mfma_f32_16x16x32_bf16 v[100:103], v[220:223], v[188:191], v[100:103]
ds_read_b128 v[156:159], v25 offset:28672
v_mfma_f32_16x16x32_bf16 v[104:107], v[216:219], v[192:195], v[104:107]
ds_read_b128 v[160:163], v25 offset:30720
v_mfma_f32_16x16x32_bf16 v[108:111], v[220:223], v[192:195], v[108:111]
ds_read_b128 v[164:167], v25 offset:32768
v_mfma_f32_16x16x32_bf16 v[112:115], v[216:219], v[196:199], v[112:115]
ds_read_b128 v[168:171], v25 offset:34816
v_mfma_f32_16x16x32_bf16 v[116:119], v[220:223], v[196:199], v[116:119]
v_mfma_f32_16x16x32_bf16 v[120:123], v[216:219], v[200:203], v[120:123]
v_mfma_f32_16x16x32_bf16 v[124:127], v[220:223], v[200:203], v[124:127]
v_mfma_f32_16x16x32_bf16 v[128:131], v[216:219], v[204:207], v[128:131]
v_mfma_f32_16x16x32_bf16 v[132:135], v[220:223], v[204:207], v[132:135]
s_waitcnt lgkmcnt(9)
s_waitcnt lgkmcnt(8)
v_mfma_f32_16x16x32_bf16 v[64:67], v[208:211], v[136:139], v[64:67]
ds_read_b64_tr_b16 v[216:217], v29 offset:24576
v_mfma_f32_16x16x32_bf16 v[68:71], v[212:215], v[136:139], v[68:71]
ds_read_b64_tr_b16 v[218:219], v29 offset:25600
s_waitcnt lgkmcnt(9)
v_mfma_f32_16x16x32_bf16 v[72:75], v[208:211], v[140:143], v[72:75]
ds_read_b64_tr_b16 v[220:221], v30 offset:24576
v_mfma_f32_16x16x32_bf16 v[76:79], v[212:215], v[140:143], v[76:79]
ds_read_b64_tr_b16 v[222:223], v30 offset:25600
s_waitcnt lgkmcnt(10)
v_mfma_f32_16x16x32_bf16 v[80:83], v[208:211], v[144:147], v[80:83]
ds_read_b128 v[172:175], v27 offset:18432
v_mfma_f32_16x16x32_bf16 v[84:87], v[212:215], v[144:147], v[84:87]
ds_read_b128 v[176:179], v27 offset:20480
s_waitcnt lgkmcnt(11)
v_mfma_f32_16x16x32_bf16 v[88:91], v[208:211], v[148:151], v[88:91]
ds_read_b128 v[180:183], v27 offset:22528
v_mfma_f32_16x16x32_bf16 v[92:95], v[212:215], v[148:151], v[92:95]
ds_read_b128 v[184:187], v27 offset:24576
s_waitcnt lgkmcnt(12)
v_mfma_f32_16x16x32_bf16 v[96:99], v[208:211], v[152:155], v[96:99]
ds_read_b128 v[188:191], v27 offset:26624
v_mfma_f32_16x16x32_bf16 v[100:103], v[212:215], v[152:155], v[100:103]
ds_read_b128 v[192:195], v27 offset:28672
s_waitcnt lgkmcnt(13)
v_mfma_f32_16x16x32_bf16 v[104:107], v[208:211], v[156:159], v[104:107]
ds_read_b128 v[196:199], v27 offset:30720
v_mfma_f32_16x16x32_bf16 v[108:111], v[212:215], v[156:159], v[108:111]
ds_read_b128 v[200:203], v27 offset:32768
s_waitcnt lgkmcnt(14)
v_mfma_f32_16x16x32_bf16 v[112:115], v[208:211], v[160:163], v[112:115]
ds_read_b128 v[204:207], v27 offset:34816
v_mfma_f32_16x16x32_bf16 v[116:119], v[212:215], v[160:163], v[116:119]
s_waitcnt lgkmcnt(14)
v_mfma_f32_16x16x32_bf16 v[120:123], v[208:211], v[164:167], v[120:123]
v_mfma_f32_16x16x32_bf16 v[124:127], v[212:215], v[164:167], v[124:127]
s_waitcnt lgkmcnt(13)
v_mfma_f32_16x16x32_bf16 v[128:131], v[208:211], v[168:171], v[128:131]
v_mfma_f32_16x16x32_bf16 v[132:135], v[212:215], v[168:171], v[132:135]
s_waitcnt lgkmcnt(9)
s_waitcnt lgkmcnt(8)
v_mfma_f32_16x16x32_bf16 v[64:67], v[216:219], v[172:175], v[64:67]
v_mfma_f32_16x16x32_bf16 v[68:71], v[220:223], v[172:175], v[68:71]
s_waitcnt lgkmcnt(7)
v_mfma_f32_16x16x32_bf16 v[72:75], v[216:219], v[176:179], v[72:75]
v_mfma_f32_16x16x32_bf16 v[76:79], v[220:223], v[176:179], v[76:79]
s_waitcnt lgkmcnt(6)
v_mfma_f32_16x16x32_bf16 v[80:83], v[216:219], v[180:183], v[80:83]
v_mfma_f32_16x16x32_bf16 v[84:87], v[220:223], v[180:183], v[84:87]
s_waitcnt lgkmcnt(5)
v_mfma_f32_16x16x32_bf16 v[88:91], v[216:219], v[184:187], v[88:91]
v_mfma_f32_16x16x32_bf16 v[92:95], v[220:223], v[184:187], v[92:95]
s_waitcnt lgkmcnt(4)
v_mfma_f32_16x16x32_bf16 v[96:99], v[216:219], v[188:191], v[96:99]
v_mfma_f32_16x16x32_bf16 v[100:103], v[220:223], v[188:191], v[100:103]
s_waitcnt lgkmcnt(3)
v_mfma_f32_16x16x32_bf16 v[104:107], v[216:219], v[192:195], v[104:107]
v_mfma_f32_16x16x32_bf16 v[108:111], v[220:223], v[192:195], v[108:111]
s_waitcnt lgkmcnt(2)
v_mfma_f32_16x16x32_bf16 v[112:115], v[216:219], v[196:199], v[112:115]
v_mfma_f32_16x16x32_bf16 v[116:119], v[220:223], v[196:199], v[116:119]
s_waitcnt lgkmcnt(1)
v_mfma_f32_16x16x32_bf16 v[120:123], v[216:219], v[200:203], v[120:123]
v_mfma_f32_16x16x32_bf16 v[124:127], v[220:223], v[200:203], v[124:127]
s_waitcnt lgkmcnt(0)
v_mfma_f32_16x16x32_bf16 v[128:131], v[216:219], v[204:207], v[128:131]
v_mfma_f32_16x16x32_bf16 v[132:135], v[220:223], v[204:207], v[132:135]
s_nop 7
v_mov_b32_dpp v40, v64 row_newbcast:0 row_mask:0xf bank_mask:0xf
v_mov_b32_dpp v41, v65 row_newbcast:0 row_mask:0xf bank_mask:0xf
v_mov_b32_dpp v42, v66 row_newbcast:0 row_mask:0xf bank_mask:0xf
v_mov_b32_dpp v43, v67 row_newbcast:0 row_mask:0xf bank_mask:0xf
v_mov_b32_dpp v44, v68 row_newbcast:0 row_mask:0xf bank_mask:0xf
v_mov_b32_dpp v45, v69 row_newbcast:0 row_mask:0xf bank_mask:0xf
v_mov_b32_dpp v46, v70 row_newbcast:0 row_mask:0xf bank_mask:0xf
v_mov_b32_dpp v47, v71 row_newbcast:0 row_mask:0xf bank_mask:0xf
v_and_b32 v4, 1, v3
v_lshrrev_b32 v5, 1, v3
v_lshl_add_u32 v4, v4, 1, v5
s_lshl_b32 s44, s38, 2
v_add_u32 v4, s44, v4
v_mul_u32_u24 v5, 52, v4
v_lshrrev_b32 v5, 8, v5
v_mul_u32_u24 v6, 768, v5
s_movk_i32 s45, 2304
v_mad_u32_u24 v6, v4, s45, v6
v_lshl_add_u32 v48, v2, 4, v6
s_and_b32 s56, s37, 7
s_lshr_b32 s57, s37, 3
s_lshl_b32 s57, s57, 6
s_and_b32 s58, s38, 1
s_lshl_b32 s58, s58, 5
s_add_u32 s57, s57, s58
s_lshr_b32 s58, s38, 1
s_lshl_b32 s58, s58, 4
s_add_u32 s57, s57, s58
v_add_u32 v52, s57, v2
s_lshl_b32 s58, s36, 7
v_add_u32 v4, s58, v52
v_mul_u32_u24 v4, 1280, v4
v_lshl_add_u32 v53, v3, 3, v4
v_add_u32 v4, 16, v52
v_lshlrev_b32 v54, 4, v4
s_mul_i32 s59, s56, 160
s_lshl_b32 s60, s36, 12
s_add_u32 s60, s60, 8192
s_lshr_b32 s50, s38, 1
s_and_b32 s51, s38, 1
s_lshl_b32 s51, s51, 6
v_add_u32 v17, s51, v1
v_add_u32 v4, 2, v17
v_lshlrev_b32 v4, 4, v4
s_mul_i32 s52, s50, 6912
s_add_u32 s52, s52, 0
v_add_u32 v18, s52, v4
s_lshl_b32 s52, s50, 3
s_add_u32 s52, s52, 4608
v_add_u32 v19, s52, v4
s_mov_b32 s53, 0x3ea52b5c
s_mov_b32 s54, 0x05040100
s_mov_b32 s55, 0x07060302
v_lshlrev_b32 v62, 4, v17
s_lshl_b32 s52, s50, 3
v_add_u32 v63, s52, v62
s_mul_i32 s46, s36, 630784
s_mul_i32 s47, s37, 11520
s_add_u32 s46, s46, s47
s_add_u32 s46, s46, 1048832
s_mul_i32 s47, s50, 6912
s_add_u32 s47, s47, s46
s_add_u32 s48, s46, 4608
s_waitcnt lgkmcnt(0)
v_lshlrev_b32 v10, 3, v2
v_add_u32 v10, 139328, v10
v_mov_b32 v11, 139264
s_barrier
ds_read_b64 v[224:225], v10 offset:0
ds_read_b64 v[228:229], v10 offset:128
ds_read_b64 v[232:233], v10 offset:256
ds_read_b64 v[236:237], v10 offset:384
ds_read_b64 v[240:241], v10 offset:512
ds_read_b64 v[244:245], v10 offset:640
ds_read_b64 v[248:249], v10 offset:768
ds_read_b64 v[32:33], v10 offset:896
ds_read_b64 v[36:37], v10 offset:1024
ds_read_b64 v[12:13], v11
s_waitcnt lgkmcnt(9)
v_pk_fma_f32 v[64:65], v[40:41], v[224:225], v[64:65] op_sel_hi:[1,0,1] neg_lo:[0,1,0] neg_hi:[0,1,0]
v_pk_fma_f32 v[66:67], v[42:43], v[224:225], v[66:67] op_sel_hi:[1,0,1] neg_lo:[0,1,0] neg_hi:[0,1,0]
v_pk_fma_f32 v[68:69], v[44:45], v[224:225], v[68:69] op_sel_hi:[1,0,1] neg_lo:[0,1,0] neg_hi:[0,1,0]
v_pk_fma_f32 v[70:71], v[46:47], v[224:225], v[70:71] op_sel_hi:[1,0,1] neg_lo:[0,1,0] neg_hi:[0,1,0]
v_pk_mul_f32 v[64:65], v[64:65], v[224:225] op_sel:[0,1] op_sel_hi:[1,1]
v_pk_mul_f32 v[66:67], v[66:67], v[224:225] op_sel:[0,1] op_sel_hi:[1,1]
v_pk_mul_f32 v[68:69], v[68:69], v[224:225] op_sel:[0,1] op_sel_hi:[1,1]
v_pk_mul_f32 v[70:71], v[70:71], v[224:225] op_sel:[0,1] op_sel_hi:[1,1]
v_cvt_pk_bf16_f32 v136, v64, v65
v_cvt_pk_bf16_f32 v137, v66, v67
v_cvt_pk_bf16_f32 v138, v68, v69
v_cvt_pk_bf16_f32 v139, v70, v71
s_waitcnt lgkmcnt(8)
v_pk_fma_f32 v[72:73], v[40:41], v[228:229], v[72:73] op_sel_hi:[1,0,1] neg_lo:[0,1,0] neg_hi:[0,1,0]
v_pk_fma_f32 v[74:75], v[42:43], v[228:229], v[74:75] op_sel_hi:[1,0,1] neg_lo:[0,1,0] neg_hi:[0,1,0]
v_pk_fma_f32 v[76:77], v[44:45], v[228:229], v[76:77] op_sel_hi:[1,0,1] neg_lo:[0,1,0] neg_hi:[0,1,0]
v_pk_fma_f32 v[78:79], v[46:47], v[228:229], v[78:79] op_sel_hi:[1,0,1] neg_lo:[0,1,0] neg_hi:[0,1,0]
v_pk_mul_f32 v[72:73], v[72:73], v[228:229] op_sel:[0,1] op_sel_hi:[1,1]
v_pk_mul_f32 v[74:75], v[74:75], v[228:229] op_sel:[0,1] op_sel_hi:[1,1]
v_pk_mul_f32 v[76:77], v[76:77], v[228:229] op_sel:[0,1] op_sel_hi:[1,1]
v_pk_mul_f32 v[78:79], v[78:79], v[228:229] op_sel:[0,1] op_sel_hi:[1,1]
v_cvt_pk_bf16_f32 v140, v72, v73
v_cvt_pk_bf16_f32 v141, v74, v75
v_cvt_pk_bf16_f32 v142, v76, v77
v_cvt_pk_bf16_f32 v143, v78, v79
v_permlane16_swap_b32 v136, v138
v_permlane16_swap_b32 v137, v139
ds_write_b128 v48, v[136:139] offset:0
s_waitcnt lgkmcnt(8)
v_pk_fma_f32 v[80:81], v[40:41], v[232:233], v[80:81] op_sel_hi:[1,0,1] neg_lo:[0,1,0] neg_hi:[0,1,0]
v_pk_fma_f32 v[82:83], v[42:43], v[232:233], v[82:83] op_sel_hi:[1,0,1] neg_lo:[0,1,0] neg_hi:[0,1,0]
v_pk_fma_f32 v[84:85], v[44:45], v[232:233], v[84:85] op_sel_hi:[1,0,1] neg_lo:[0,1,0] neg_hi:[0,1,0]
v_pk_fma_f32 v[86:87], v[46:47], v[232:233], v[86:87] op_sel_hi:[1,0,1] neg_lo:[0,1,0] neg_hi:[0,1,0]
v_pk_mul_f32 v[80:81], v[80:81], v[232:233] op_sel:[0,1] op_sel_hi:[1,1]
v_pk_mul_f32 v[82:83], v[82:83], v[232:233] op_sel:[0,1] op_sel_hi:[1,1]
v_pk_mul_f32 v[84:85], v[84:85], v[232:233] op_sel:[0,1] op_sel_hi:[1,1]
v_pk_mul_f32 v[86:87], v[86:87], v[232:233] op_sel:[0,1] op_sel_hi:[1,1]
v_cvt_pk_bf16_f32 v144, v80, v81
v_cvt_pk_bf16_f32 v145, v82, v83
v_cvt_pk_bf16_f32 v146, v84, v85
v_cvt_pk_bf16_f32 v147, v86, v87
v_permlane16_swap_b32 v140, v142
v_permlane16_swap_b32 v141, v143
ds_write_b128 v48, v[140:143] offset:256
s_waitcnt lgkmcnt(8)
v_pk_fma_f32 v[88:89], v[40:41], v[236:237], v[88:89] op_sel_hi:[1,0,1] neg_lo:[0,1,0] neg_hi:[0,1,0]
v_pk_fma_f32 v[90:91], v[42:43], v[236:237], v[90:91] op_sel_hi:[1,0,1] neg_lo:[0,1,0] neg_hi:[0,1,0]
v_pk_fma_f32 v[92:93], v[44:45], v[236:237], v[92:93] op_sel_hi:[1,0,1] neg_lo:[0,1,0] neg_hi:[0,1,0]
v_pk_fma_f32 v[94:95], v[46:47], v[236:237], v[94:95] op_sel_hi:[1,0,1] neg_lo:[0,1,0] neg_hi:[0,1,0]
v_pk_mul_f32 v[88:89], v[88:89], v[236:237] op_sel:[0,1] op_sel_hi:[1,1]
v_pk_mul_f32 v[90:91], v[90:91], v[236:237] op_sel:[0,1] op_sel_hi:[1,1]
v_pk_mul_f32 v[92:93], v[92:93], v[236:237] op_sel:[0,1] op_sel_hi:[1,1]
v_pk_mul_f32 v[94:95], v[94:95], v[236:237] op_sel:[0,1] op_sel_hi:[1,1]
v_cvt_pk_bf16_f32 v148, v88, v89
v_cvt_pk_bf16_f32 v149, v90, v91
v_cvt_pk_bf16_f32 v150, v92, v93
v_cvt_pk_bf16_f32 v151, v94, v95
v_permlane16_swap_b32 v144, v146
v_permlane16_swap_b32 v145, v147
ds_write_b128 v48, v[144:147] offset:512
s_waitcnt lgkmcnt(8)
v_pk_fma_f32 v[96:97], v[40:41], v[240:241], v[96:97] op_sel_hi:[1,0,1] neg_lo:[0,1,0] neg_hi:[0,1,0]
v_pk_fma_f32 v[98:99], v[42:43], v[240:241], v[98:99] op_sel_hi:[1,0,1] neg_lo:[0,1,0] neg_hi:[0,1,0]
v_pk_fma_f32 v[100:101], v[44:45], v[240:241], v[100:101] op_sel_hi:[1,0,1] neg_lo:[0,1,0] neg_hi:[0,1,0]
v_pk_fma_f32 v[102:103], v[46:47], v[240:241], v[102:103] op_sel_hi:[1,0,1] neg_lo:[0,1,0] neg_hi:[0,1,0]
v_pk_mul_f32 v[96:97], v[96:97], v[240:241] op_sel:[0,1] op_sel_hi:[1,1]
v_pk_mul_f32 v[98:99], v[98:99], v[240:241] op_sel:[0,1] op_sel_hi:[1,1]
v_pk_mul_f32 v[100:101], v[100:101], v[240:241] op_sel:[0,1] op_sel_hi:[1,1]
v_pk_mul_f32 v[102:103], v[102:103], v[240:241] op_sel:[0,1] op_sel_hi:[1,1]
v_cvt_pk_bf16_f32 v152, v96, v97
v_cvt_pk_bf16_f32 v153, v98, v99
v_cvt_pk_bf16_f32 v154, v100, v101
v_cvt_pk_bf16_f32 v155, v102, v103
v_permlane16_swap_b32 v148, v150
v_permlane16_swap_b32 v149, v151
ds_write_b128 v48, v[148:151] offset:768
s_waitcnt lgkmcnt(8)
v_pk_fma_f32 v[104:105], v[40:41], v[244:245], v[104:105] op_sel_hi:[1,0,1] neg_lo:[0,1,0] neg_hi:[0,1,0]
v_pk_fma_f32 v[106:107], v[42:43], v[244:245], v[106:107] op_sel_hi:[1,0,1] neg_lo:[0,1,0] neg_hi:[0,1,0]
v_pk_fma_f32 v[108:109], v[44:45], v[244:245], v[108:109] op_sel_hi:[1,0,1] neg_lo:[0,1,0] neg_hi:[0,1,0]
v_pk_fma_f32 v[110:111], v[46:47], v[244:245], v[110:111] op_sel_hi:[1,0,1] neg_lo:[0,1,0] neg_hi:[0,1,0]
v_pk_mul_f32 v[104:105], v[104:105], v[244:245] op_sel:[0,1] op_sel_hi:[1,1]
v_pk_mul_f32 v[106:107], v[106:107], v[244:245] op_sel:[0,1] op_sel_hi:[1,1]
v_pk_mul_f32 v[108:109], v[108:109], v[244:245] op_sel:[0,1] op_sel_hi:[1,1]
v_pk_mul_f32 v[110:111], v[110:111], v[244:245] op_sel:[0,1] op_sel_hi:[1,1]
v_cvt_pk_bf16_f32 v156, v104, v105
v_cvt_pk_bf16_f32 v157, v106, v107
v_cvt_pk_bf16_f32 v158, v108, v109
v_cvt_pk_bf16_f32 v159, v110, v111
v_permlane16_swap_b32 v152, v154
v_permlane16_swap_b32 v153, v155
ds_write_b128 v48, v[152:155] offset:1024
s_waitcnt lgkmcnt(8)
v_pk_fma_f32 v[112:113], v[40:41], v[248:249], v[112:113] op_sel_hi:[1,0,1] neg_lo:[0,1,0] neg_hi:[0,1,0]
v_pk_fma_f32 v[114:115], v[42:43], v[248:249], v[114:115] op_sel_hi:[1,0,1] neg_lo:[0,1,0] neg_hi:[0,1,0]
v_pk_fma_f32 v[116:117], v[44:45], v[248:249], v[116:117] op_sel_hi:[1,0,1] neg_lo:[0,1,0] neg_hi:[0,1,0]
v_pk_fma_f32 v[118:119], v[46:47], v[248:249], v[118:119] op_sel_hi:[1,0,1] neg_lo:[0,1,0] neg_hi:[0,1,0]
v_pk_mul_f32 v[112:113], v[112:113], v[248:249] op_sel:[0,1] op_sel_hi:[1,1]
v_pk_mul_f32 v[114:115], v[114:115], v[248:249] op_sel:[0,1] op_sel_hi:[1,1]
v_pk_mul_f32 v[116:117], v[116:117], v[248:249] op_sel:[0,1] op_sel_hi:[1,1]
v_pk_mul_f32 v[118:119], v[118:119], v[248:249] op_sel:[0,1] op_sel_hi:[1,1]
v_cvt_pk_bf16_f32 v160, v112, v113
v_cvt_pk_bf16_f32 v161, v114, v115
v_cvt_pk_bf16_f32 v162, v116, v117
v_cvt_pk_bf16_f32 v163, v118, v119
v_permlane16_swap_b32 v156, v158
v_permlane16_swap_b32 v157, v159
ds_write_b128 v48, v[156:159] offset:1280
s_waitcnt lgkmcnt(8)
v_pk_fma_f32 v[120:121], v[40:41], v[32:33], v[120:121] op_sel_hi:[1,0,1] neg_lo:[0,1,0] neg_hi:[0,1,0]
v_pk_fma_f32 v[122:123], v[42:43], v[32:33], v[122:123] op_sel_hi:[1,0,1] neg_lo:[0,1,0] neg_hi:[0,1,0]
v_pk_fma_f32 v[124:125], v[44:45], v[32:33], v[124:125] op_sel_hi:[1,0,1] neg_lo:[0,1,0] neg_hi:[0,1,0]
v_pk_fma_f32 v[126:127], v[46:47], v[32:33], v[126:127] op_sel_hi:[1,0,1] neg_lo:[0,1,0] neg_hi:[0,1,0]
v_pk_mul_f32 v[120:121], v[120:121], v[32:33] op_sel:[0,1] op_sel_hi:[1,1]
v_pk_mul_f32 v[122:123], v[122:123], v[32:33] op_sel:[0,1] op_sel_hi:[1,1]
v_pk_mul_f32 v[124:125], v[124:125], v[32:33] op_sel:[0,1] op_sel_hi:[1,1]
v_pk_mul_f32 v[126:127], v[126:127], v[32:33] op_sel:[0,1] op_sel_hi:[1,1]
v_cvt_pk_bf16_f32 v164, v120, v121
v_cvt_pk_bf16_f32 v165, v122, v123
v_cvt_pk_bf16_f32 v166, v124, v125
v_cvt_pk_bf16_f32 v167, v126, v127
v_permlane16_swap_b32 v160, v162
v_permlane16_swap_b32 v161, v163
ds_write_b128 v48, v[160:163] offset:1536
s_waitcnt lgkmcnt(8)
v_pk_fma_f32 v[128:129], v[40:41], v[36:37], v[128:129] op_sel_hi:[1,0,1] neg_lo:[0,1,0] neg_hi:[0,1,0]
v_pk_fma_f32 v[130:131], v[42:43], v[36:37], v[130:131] op_sel_hi:[1,0,1] neg_lo:[0,1,0] neg_hi:[0,1,0]
v_pk_fma_f32 v[132:133], v[44:45], v[36:37], v[132:133] op_sel_hi:[1,0,1] neg_lo:[0,1,0] neg_hi:[0,1,0]
v_pk_fma_f32 v[134:135], v[46:47], v[36:37], v[134:135] op_sel_hi:[1,0,1] neg_lo:[0,1,0] neg_hi:[0,1,0]
v_pk_mul_f32 v[128:129], v[128:129], v[36:37] op_sel:[0,1] op_sel_hi:[1,1]
v_pk_mul_f32 v[130:131], v[130:131], v[36:37] op_sel:[0,1] op_sel_hi:[1,1]
v_pk_mul_f32 v[132:133], v[132:133], v[36:37] op_sel:[0,1] op_sel_hi:[1,1]
v_pk_mul_f32 v[134:135], v[134:135], v[36:37] op_sel:[0,1] op_sel_hi:[1,1]
v_cvt_pk_bf16_f32 v168, v128, v129
v_cvt_pk_bf16_f32 v169, v130, v131
v_cvt_pk_bf16_f32 v170, v132, v133
v_cvt_pk_bf16_f32 v171, v134, v135
v_permlane16_swap_b32 v164, v166
v_permlane16_swap_b32 v165, v167
ds_write_b128 v48, v[164:167] offset:1792
s_waitcnt lgkmcnt(8)
v_readfirstlane_b32 s40, v13
s_nop 0
v_permlane16_swap_b32 v168, v170
v_permlane16_swap_b32 v169, v171
ds_write_b128 v48, v[168:171] offset:2048
s_waitcnt lgkmcnt(0)
s_barrier
ds_read_b128 v[64:67], v18 offset:224
ds_read_b128 v[68:71], v18 offset:2528
ds_read_b64 v[72:73], v19 offset:224
ds_read_b128 v[80:83], v18 offset:12512
ds_read_b128 v[84:87], v18 offset:14816
ds_read_b64 v[88:89], v19 offset:12512
ds_read_b128 v[90:93], v18 offset:12480
ds_read_b128 v[94:97], v18 offset:14784
ds_read_b64 v[98:99], v19 offset:12480
ds_read_b128 v[100:103], v18 offset:12448
ds_read_b128 v[104:107], v18 offset:14752
ds_read_b64 v[108:109], v19 offset:12448
ds_read_b128 v[110:113], v18 offset:12416
ds_read_b128 v[114:117], v18 offset:14720
ds_read_b64 v[118:119], v19 offset:12416
ds_read_b128 v[120:123], v18 offset:12384
ds_read_b128 v[124:127], v18 offset:14688
ds_read_b64 v[128:129], v19 offset:12384
ds_read_b128 v[130:133], v18 offset:12352
ds_read_b128 v[134:137], v18 offset:14656
ds_read_b64 v[138:139], v19 offset:12352
ds_read_b128 v[140:143], v18 offset:12320
ds_read_b128 v[144:147], v18 offset:14624
ds_read_b64 v[148:149], v19 offset:12320
ds_read_b128 v[150:153], v18 offset:12288
ds_read_b128 v[154:157], v18 offset:14592
ds_read_b64 v[158:159], v19 offset:12288
s_waitcnt lgkmcnt(15)
v_dot2_f32_bf16 v20, v64, v80, 0
v_dot2_f32_bf16 v21, v64, v90, 0
v_dot2_f32_bf16 v20, v65, v81, v20
v_dot2_f32_bf16 v21, v65, v91, v21
v_dot2_f32_bf16 v20, v66, v82, v20
v_dot2_f32_bf16 v21, v66, v92, v21
v_dot2_f32_bf16 v20, v67, v83, v20
v_dot2_f32_bf16 v21, v67, v93, v21
v_dot2_f32_bf16 v20, v68, v84, v20
v_dot2_f32_bf16 v21, v68, v94, v21
v_dot2_f32_bf16 v20, v69, v85, v20
v_dot2_f32_bf16 v21, v69, v95, v21
v_dot2_f32_bf16 v20, v70, v86, v20
v_dot2_f32_bf16 v21, v70, v96, v21
v_dot2_f32_bf16 v20, v71, v87, v20
v_dot2_f32_bf16 v21, v71, v97, v21
v_dot2_f32_bf16 v20, v72, v88, v20
v_dot2_f32_bf16 v21, v72, v98, v21
v_dot2_f32_bf16 v20, v73, v89, v20
v_dot2_f32_bf16 v21, v73, v99, v21
ds_read_b128 v[160:163], v18 offset:24800
ds_read_b128 v[164:167], v18 offset:27104
ds_read_b64 v[168:169], v19 offset:24800
ds_read_b128 v[170:173], v18 offset:24768
ds_read_b128 v[174:177], v18 offset:27072
ds_read_b64 v[178:179], v19 offset:24768
s_waitcnt lgkmcnt(15)
v_dot2_f32_bf16 v22, v64, v100, 0
v_dot2_f32_bf16 v23, v64, v110, 0
v_dot2_f32_bf16 v22, v65, v101, v22
v_dot2_f32_bf16 v23, v65, v111, v23
v_dot2_f32_bf16 v22, v66, v102, v22
v_dot2_f32_bf16 v23, v66, v112, v23
v_dot2_f32_bf16 v22, v67, v103, v22
v_dot2_f32_bf16 v23, v67, v113, v23
v_dot2_f32_bf16 v22, v68, v104, v22
v_dot2_f32_bf16 v23, v68, v114, v23
v_dot2_f32_bf16 v22, v69, v105, v22
v_dot2_f32_bf16 v23, v69, v115, v23
v_dot2_f32_bf16 v22, v70, v106, v22
v_dot2_f32_bf16 v23, v70, v116, v23
v_dot2_f32_bf16 v22, v71, v107, v22
v_dot2_f32_bf16 v23, v71, v117, v23
v_dot2_f32_bf16 v22, v72, v108, v22
v_dot2_f32_bf16 v23, v72, v118, v23
v_dot2_f32_bf16 v22, v73, v109, v22
v_dot2_f32_bf16 v23, v73, v119, v23
ds_read_b128 v[180:183], v18 offset:24736
ds_read_b128 v[184:187], v18 offset:27040
ds_read_b64 v[188:189], v19 offset:24736
ds_read_b128 v[190:193], v18 offset:24704
ds_read_b128 v[194:197], v18 offset:27008
ds_read_b64 v[198:199], v19 offset:24704
s_waitcnt lgkmcnt(15)
v_dot2_f32_bf16 v24, v64, v120, 0
v_dot2_f32_bf16 v25, v64, v130, 0
v_dot2_f32_bf16 v24, v65, v121, v24
v_dot2_f32_bf16 v25, v65, v131, v25
v_dot2_f32_bf16 v24, v66, v122, v24
v_dot2_f32_bf16 v25, v66, v132, v25
v_dot2_f32_bf16 v24, v67, v123, v24
v_dot2_f32_bf16 v25, v67, v133, v25
v_dot2_f32_bf16 v24, v68, v124, v24
v_dot2_f32_bf16 v25, v68, v134, v25
v_dot2_f32_bf16 v24, v69, v125, v24
v_dot2_f32_bf16 v25, v69, v135, v25
v_dot2_f32_bf16 v24, v70, v126, v24
v_dot2_f32_bf16 v25, v70, v136, v25
v_dot2_f32_bf16 v24, v71, v127, v24
v_dot2_f32_bf16 v25, v71, v137, v25
v_dot2_f32_bf16 v24, v72, v128, v24
v_dot2_f32_bf16 v25, v72, v138, v25
v_dot2_f32_bf16 v24, v73, v129, v24
v_dot2_f32_bf16 v25, v73, v139, v25
ds_read_b128 v[200:203], v18 offset:24672
ds_read_b128 v[204:207], v18 offset:26976
ds_read_b64 v[208:209], v19 offset:24672
ds_read_b128 v[210:213], v18 offset:24640
ds_read_b128 v[214:217], v18 offset:26944
ds_read_b64 v[218:219], v19 offset:24640
s_waitcnt lgkmcnt(15)
v_dot2_f32_bf16 v26, v64, v140, 0
v_dot2_f32_bf16 v27, v64, v150, 0
v_dot2_f32_bf16 v26, v65, v141, v26
v_dot2_f32_bf16 v27, v65, v151, v27
v_dot2_f32_bf16 v26, v66, v142, v26
v_dot2_f32_bf16 v27, v66, v152, v27
v_dot2_f32_bf16 v26, v67, v143, v26
v_dot2_f32_bf16 v27, v67, v153, v27
v_dot2_f32_bf16 v26, v68, v144, v26
v_dot2_f32_bf16 v27, v68, v154, v27
v_dot2_f32_bf16 v26, v69, v145, v26
v_dot2_f32_bf16 v27, v69, v155, v27
v_dot2_f32_bf16 v26, v70, v146, v26
v_dot2_f32_bf16 v27, v70, v156, v27
v_dot2_f32_bf16 v26, v71, v147, v26
v_dot2_f32_bf16 v27, v71, v157, v27
v_dot2_f32_bf16 v26, v72, v148, v26
v_dot2_f32_bf16 v27, v72, v158, v27
v_dot2_f32_bf16 v26, v73, v149, v26
v_dot2_f32_bf16 v27, v73, v159, v27
ds_read_b128 v[220:223], v18 offset:24608
ds_read_b128 v[224:227], v18 offset:26912
ds_read_b64 v[228:229], v19 offset:24608
ds_read_b128 v[230:233], v18 offset:24576
ds_read_b128 v[234:237], v18 offset:26880
ds_read_b64 v[238:239], v19 offset:24576
s_nop 2
s_cmp_lg_u32 s36, 0
s_cbranch_scc1 L_nomask_1
v_mov_b32 v4, 0xf149f2ca
v_cmp_le_u32 vcc, 2, v17
s_nop 1
v_cndmask_b32 v21, v4, v21, vcc
v_cmp_le_u32 vcc, 4, v17
s_nop 1
v_cndmask_b32 v22, v4, v22, vcc
v_cmp_le_u32 vcc, 6, v17
s_nop 1
v_cndmask_b32 v23, v4, v23, vcc
v_cmp_le_u32 vcc, 8, v17
s_nop 1
v_cndmask_b32 v24, v4, v24, vcc
v_cmp_le_u32 vcc, 10, v17
s_nop 1
v_cndmask_b32 v25, v4, v25, vcc
v_cmp_le_u32 vcc, 12, v17
s_nop 1
v_cndmask_b32 v26, v4, v26, vcc
v_cmp_le_u32 vcc, 14, v17
s_nop 1
v_cndmask_b32 v27, v4, v27, vcc
L_nomask_1:
v_max3_f32 v4, v20, v21, v22
v_max3_f32 v5, v23, v24, v25
v_max3_f32 v4, v4, v26, v27
v_max_f32 v4, v4, v5
v_mul_f32 v4, s53, v4
v_fma_f32 v20, v20, s53, -v4
v_fma_f32 v21, v21, s53, -v4
v_fma_f32 v22, v22, s53, -v4
v_fma_f32 v23, v23, s53, -v4
v_fma_f32 v24, v24, s53, -v4
v_fma_f32 v25, v25, s53, -v4
v_fma_f32 v26, v26, s53, -v4
v_fma_f32 v27, v27, s53, -v4
v_exp_f32 v20, v20
v_exp_f32 v21, v21
v_exp_f32 v22, v22
v_exp_f32 v23, v23
v_exp_f32 v24, v24
v_exp_f32 v25, v25
v_exp_f32 v26, v26
v_exp_f32 v27, v27
s_nop 0
v_add_f32 v4, v20, v21
v_add_f32 v5, v22, v23
v_add_f32 v6, v24, v25
v_add_f32 v7, v26, v27
v_add_f32 v4, v4, v5
v_add_f32 v6, v6, v7
v_add_f32 v4, v4, v6
v_rcp_f32 v4, v4
s_nop 0
v_mul_f32 v20, v20, v4
v_mul_f32 v21, v21, v4
v_mul_f32 v22, v22, v4
v_mul_f32 v23, v23, v4
v_mul_f32 v24, v24, v4
v_mul_f32 v25, v25, v4
v_mul_f32 v26, v26, v4
v_mul_f32 v27, v27, v4
v_cvt_pk_bf16_f32 v28, v20, v21
v_cvt_pk_bf16_f32 v29, v22, v23
v_cvt_pk_bf16_f32 v30, v24, v25
v_cvt_pk_bf16_f32 v31, v26, v27
s_waitcnt lgkmcnt(15)
v_perm_b32 v8, v170, v160, s54
v_perm_b32 v9, v170, v160, s55
v_perm_b32 v10, v171, v161, s54
v_perm_b32 v11, v171, v161, s55
v_dot2_f32_bf16 v32, v8, v28, 0
v_dot2_f32_bf16 v33, v9, v28, 0
v_dot2_f32_bf16 v34, v10, v28, 0
v_dot2_f32_bf16 v35, v11, v28, 0
v_perm_b32 v12, v172, v162, s54
v_perm_b32 v13, v172, v162, s55
v_perm_b32 v14, v173, v163, s54
v_perm_b32 v15, v173, v163, s55
v_dot2_f32_bf16 v36, v12, v28, 0
v_dot2_f32_bf16 v37, v13, v28, 0
v_dot2_f32_bf16 v38, v14, v28, 0
v_dot2_f32_bf16 v39, v15, v28, 0
v_perm_b32 v8, v174, v164, s54
v_perm_b32 v9, v174, v164, s55
v_perm_b32 v10, v175, v165, s54
v_perm_b32 v11, v175, v165, s55
v_dot2_f32_bf16 v40, v8, v28, 0
v_dot2_f32_bf16 v41, v9, v28, 0
v_dot2_f32_bf16 v42, v10, v28, 0
v_dot2_f32_bf16 v43, v11, v28, 0
v_perm_b32 v12, v176, v166, s54
v_perm_b32 v13, v176, v166, s55
v_perm_b32 v14, v177, v167, s54
v_perm_b32 v15, v177, v167, s55
v_dot2_f32_bf16 v44, v12, v28, 0
v_dot2_f32_bf16 v45, v13, v28, 0
v_dot2_f32_bf16 v46, v14, v28, 0
v_dot2_f32_bf16 v47, v15, v28, 0
v_perm_b32 v8, v178, v168, s54
v_perm_b32 v9, v178, v168, s55
v_perm_b32 v10, v179, v169, s54
v_perm_b32 v11, v179, v169, s55
v_dot2_f32_bf16 v48, v8, v28, 0
v_dot2_f32_bf16 v49, v9, v28, 0
v_dot2_f32_bf16 v50, v10, v28, 0
v_dot2_f32_bf16 v51, v11, v28, 0
s_waitcnt lgkmcnt(12)
v_perm_b32 v12, v190, v180, s54
v_perm_b32 v13, v190, v180, s55
v_perm_b32 v14, v191, v181, s54
v_perm_b32 v15, v191, v181, s55
v_dot2_f32_bf16 v32, v12, v29, v32
v_dot2_f32_bf16 v33, v13, v29, v33
v_dot2_f32_bf16 v34, v14, v29, v34
v_dot2_f32_bf16 v35, v15, v29, v35
v_perm_b32 v8, v192, v182, s54
v_perm_b32 v9, v192, v182, s55
v_perm_b32 v10, v193, v183, s54
v_perm_b32 v11, v193, v183, s55
v_dot2_f32_bf16 v36, v8, v29, v36
v_dot2_f32_bf16 v37, v9, v29, v37
v_dot2_f32_bf16 v38, v10, v29, v38
v_dot2_f32_bf16 v39, v11, v29, v39
v_perm_b32 v12, v194, v184, s54
v_perm_b32 v13, v194, v184, s55
v_perm_b32 v14, v195, v185, s54
v_perm_b32 v15, v195, v185, s55
v_dot2_f32_bf16 v40, v12, v29, v40
v_dot2_f32_bf16 v41, v13, v29, v41
v_dot2_f32_bf16 v42, v14, v29, v42
v_dot2_f32_bf16 v43, v15, v29, v43
v_perm_b32 v8, v196, v186, s54
v_perm_b32 v9, v196, v186, s55
v_perm_b32 v10, v197, v187, s54
v_perm_b32 v11, v197, v187, s55
v_dot2_f32_bf16 v44, v8, v29, v44
v_dot2_f32_bf16 v45, v9, v29, v45
v_dot2_f32_bf16 v46, v10, v29, v46
v_dot2_f32_bf16 v47, v11, v29, v47
v_perm_b32 v12, v198, v188, s54
v_perm_b32 v13, v198, v188, s55
v_perm_b32 v14, v199, v189, s54
v_perm_b32 v15, v199, v189, s55
v_dot2_f32_bf16 v48, v12, v29, v48
v_dot2_f32_bf16 v49, v13, v29, v49
v_dot2_f32_bf16 v50, v14, v29, v50
v_dot2_f32_bf16 v51, v15, v29, v51
s_waitcnt lgkmcnt(6)
v_perm_b32 v8, v210, v200, s54
v_perm_b32 v9, v210, v200, s55
v_perm_b32 v10, v211, v201, s54
v_perm_b32 v11, v211, v201, s55
v_dot2_f32_bf16 v32, v8, v30, v32
v_dot2_f32_bf16 v33, v9, v30, v33
v_dot2_f32_bf16 v34, v10, v30, v34
v_dot2_f32_bf16 v35, v11, v30, v35
v_perm_b32 v12, v212, v202, s54
v_perm_b32 v13, v212, v202, s55
v_perm_b32 v14, v213, v203, s54
v_perm_b32 v15, v213, v203, s55
v_dot2_f32_bf16 v36, v12, v30, v36
v_dot2_f32_bf16 v37, v13, v30, v37
v_dot2_f32_bf16 v38, v14, v30, v38
v_dot2_f32_bf16 v39, v15, v30, v39
v_perm_b32 v8, v214, v204, s54
v_perm_b32 v9, v214, v204, s55
v_perm_b32 v10, v215, v205, s54
v_perm_b32 v11, v215, v205, s55
v_dot2_f32_bf16 v40, v8, v30, v40
v_dot2_f32_bf16 v41, v9, v30, v41
v_dot2_f32_bf16 v42, v10, v30, v42
v_dot2_f32_bf16 v43, v11, v30, v43
v_perm_b32 v12, v216, v206, s54
v_perm_b32 v13, v216, v206, s55
v_perm_b32 v14, v217, v207, s54
v_perm_b32 v15, v217, v207, s55
v_dot2_f32_bf16 v44, v12, v30, v44
v_dot2_f32_bf16 v45, v13, v30, v45
v_dot2_f32_bf16 v46, v14, v30, v46
v_dot2_f32_bf16 v47, v15, v30, v47
v_perm_b32 v8, v218, v208, s54
v_perm_b32 v9, v218, v208, s55
v_perm_b32 v10, v219, v209, s54
v_perm_b32 v11, v219, v209, s55
v_dot2_f32_bf16 v48, v8, v30, v48
v_dot2_f32_bf16 v49, v9, v30, v49
v_dot2_f32_bf16 v50, v10, v30, v50
v_dot2_f32_bf16 v51, v11, v30, v51
s_waitcnt lgkmcnt(0)
v_perm_b32 v12, v230, v220, s54
v_perm_b32 v13, v230, v220, s55
v_perm_b32 v14, v231, v221, s54
v_perm_b32 v15, v231, v221, s55
v_dot2_f32_bf16 v32, v12, v31, v32
v_dot2_f32_bf16 v33, v13, v31, v33
v_dot2_f32_bf16 v34, v14, v31, v34
v_dot2_f32_bf16 v35, v15, v31, v35
v_perm_b32 v8, v232, v222, s54
v_perm_b32 v9, v232, v222, s55
v_perm_b32 v10, v233, v223, s54
v_perm_b32 v11, v233, v223, s55
v_dot2_f32_bf16 v36, v8, v31, v36
v_dot2_f32_bf16 v37, v9, v31, v37
v_dot2_f32_bf16 v38, v10, v31, v38
v_dot2_f32_bf16 v39, v11, v31, v39
v_perm_b32 v12, v234, v224, s54
v_perm_b32 v13, v234, v224, s55
v_perm_b32 v14, v235, v225, s54
v_perm_b32 v15, v235, v225, s55
v_dot2_f32_bf16 v40, v12, v31, v40
v_dot2_f32_bf16 v41, v13, v31, v41
v_dot2_f32_bf16 v42, v14, v31, v42
v_dot2_f32_bf16 v43, v15, v31, v43
v_perm_b32 v8, v236, v226, s54
v_perm_b32 v9, v236, v226, s55
v_perm_b32 v10, v237, v227, s54
v_perm_b32 v11, v237, v227, s55
v_dot2_f32_bf16 v44, v8, v31, v44
v_dot2_f32_bf16 v45, v9, v31, v45
v_dot2_f32_bf16 v46, v10, v31, v46
v_dot2_f32_bf16 v47, v11, v31, v47
v_perm_b32 v12, v238, v228, s54
v_perm_b32 v13, v238, v228, s55
v_perm_b32 v14, v239, v229, s54
v_perm_b32 v15, v239, v229, s55
v_dot2_f32_bf16 v48, v12, v31, v48
v_dot2_f32_bf16 v49, v13, v31, v49
v_dot2_f32_bf16 v50, v14, v31, v50
v_dot2_f32_bf16 v51, v15, v31, v51
s_nop 2
v_cvt_pk_bf16_f32 v64, v32, v33
v_cvt_pk_bf16_f32 v65, v34, v35
v_cvt_pk_bf16_f32 v66, v36, v37
v_cvt_pk_bf16_f32 v67, v38, v39
v_cvt_pk_bf16_f32 v68, v40, v41
v_cvt_pk_bf16_f32 v69, v42, v43
v_cvt_pk_bf16_f32 v70, v44, v45
v_cvt_pk_bf16_f32 v71, v46, v47
v_cvt_pk_bf16_f32 v72, v48, v49
v_cvt_pk_bf16_f32 v73, v50, v51
s_cmp_eq_u32 s40, 0
s_cbranch_scc1 L_stsafe_2
buffer_store_dwordx4 v[64:67], v62, s[12:15], s47 offen
buffer_store_dwordx4 v[68:71], v62, s[12:15], s47 offen offset:2304
buffer_store_dwordx2 v[72:73], v63, s[12:15], s48 offen
s_branch L_stdone_3
L_stsafe_2:
buffer_store_dwordx4 v[64:67], v62, s[12:15], s47 offen sc1
buffer_store_dwordx4 v[68:71], v62, s[12:15], s47 offen offset:2304 sc1
buffer_store_dwordx2 v[72:73], v63, s[12:15], s48 offen sc1
L_stdone_3:
s_waitcnt vmcnt(0)
s_waitcnt lgkmcnt(0)
s_barrier
s_barrier
s_barrier
s_and_b32 s46, s37, 7
s_lshr_b32 s47, s37, 3
s_lshr_b32 s48, s38, 1
s_and_b32 s49, s38, 1
s_lshl_b32 s52, s47, 6
s_lshl_b32 s53, s49, 5
s_add_u32 s52, s52, s53
v_mul_u32_u24 v22, 2304, v3
v_add_u32 v4, s52, v2
v_lshl_add_u32 v22, v4, 4, v22
s_mul_i32 s54, s36, 630784
s_mul_i32 s55, s48, 92160
s_add_u32 s54, s54, s55
s_add_u32 s54, s54, 1048832
buffer_load_dwordx4 v[160:163], v22, s[12:15], s54 offen offset:0 sc1
buffer_load_dwordx4 v[164:167], v22, s[12:15], s54 offen offset:256 sc1
s_add_u32 s54, s54, 9216
buffer_load_dwordx4 v[168:171], v22, s[12:15], s54 offen offset:0 sc1
buffer_load_dwordx4 v[172:175], v22, s[12:15], s54 offen offset:256 sc1
s_add_u32 s54, s54, 9216
s_lshl_b32 s53, s48, 4
s_add_u32 s57, s52, s53
v_add_u32 v24, s57, v2
v_lshrrev_b32 v4, 2, v2
v_and_b32 v5, 1, v3
v_lshl_add_u32 v4, v5, 2, v4
v_lshrrev_b32 v5, 1, v3
v_lshl_add_u32 v4, v5, 4, v4
v_mul_u32_u24 v4, 160, v4
v_and_b32 v5, 3, v2
v_lshl_add_u32 v4, v5, 3, v4
s_mul_i32 s53, s48, 51200
s_add_u32 s53, s53, 61440
v_add_u32 v21, s53, v4
s_mul_i32 s53, s48, 640
s_add_u32 s53, s53, 49152
v_lshlrev_b32 v4, 4, v3
v_add_u32 v23, s53, v4
ds_read_b64_tr_b16 v[112:113], v21 offset:0
ds_read_b64_tr_b16 v[114:115], v21 offset:1280
ds_read_b64_tr_b16 v[116:117], v21 offset:32
ds_read_b64_tr_b16 v[118:119], v21 offset:1312
ds_read_b64_tr_b16 v[120:121], v21 offset:64
ds_read_b64_tr_b16 v[122:123], v21 offset:1344
ds_read_b64_tr_b16 v[124:125], v21 offset:96
ds_read_b64_tr_b16 v[126:127], v21 offset:1376
ds_read_b64_tr_b16 v[128:129], v21 offset:128
ds_read_b64_tr_b16 v[130:131], v21 offset:1408
ds_read_b128 v[152:155], v23 offset:0
s_waitcnt vmcnt(2)
s_waitcnt lgkmcnt(9)
v_mfma_f32_16x16x32_bf16 v[64:67], v[112:115], v[160:163], 0
ds_read_b64_tr_b16 v[132:133], v21 offset:5120
v_mfma_f32_16x16x32_bf16 v[68:71], v[112:115], v[164:167], 0
ds_read_b64_tr_b16 v[134:135], v21 offset:6400
s_waitcnt lgkmcnt(9)
v_mfma_f32_16x16x32_bf16 v[72:75], v[116:119], v[160:163], 0
buffer_load_dwordx4 v[176:179], v22, s[12:15], s54 offen offset:0 sc1
buffer_load_dwordx4 v[180:183], v22, s[12:15], s54 offen offset:256 sc1
s_add_u32 s54, s54, 9216
ds_read_b64_tr_b16 v[136:137], v21 offset:5152
v_mfma_f32_16x16x32_bf16 v[76:79], v[116:119], v[164:167], 0
ds_read_b64_tr_b16 v[138:139], v21 offset:6432
s_waitcnt lgkmcnt(9)
v_mfma_f32_16x16x32_bf16 v[80:83], v[120:123], v[160:163], 0
buffer_load_dwordx4 v[184:187], v22, s[12:15], s54 offen offset:0 sc1
buffer_load_dwordx4 v[188:191], v22, s[12:15], s54 offen offset:256 sc1
s_add_u32 s54, s54, 9216
ds_read_b64_tr_b16 v[140:141], v21 offset:5184
v_mfma_f32_16x16x32_bf16 v[84:87], v[120:123], v[164:167], 0
ds_read_b64_tr_b16 v[142:143], v21 offset:6464
s_waitcnt lgkmcnt(9)
v_mfma_f32_16x16x32_bf16 v[88:91], v[124:127], v[160:163], 0
ds_read_b64_tr_b16 v[144:145], v21 offset:5216
v_mfma_f32_16x16x32_bf16 v[92:95], v[124:127], v[164:167], 0
ds_read_b64_tr_b16 v[146:147], v21 offset:6496
s_waitcnt lgkmcnt(9)
v_mfma_f32_16x16x32_bf16 v[96:99], v[128:131], v[160:163], 0
ds_read_b64_tr_b16 v[148:149], v21 offset:5248
v_mfma_f32_16x16x32_bf16 v[100:103], v[128:131], v[164:167], 0
ds_read_b64_tr_b16 v[150:151], v21 offset:6528
s_waitcnt lgkmcnt(10)
v_mfma_f32_16x16x32_bf16 v[104:107], v[152:155], v[160:163], 0
ds_read_b128 v[156:159], v23 offset:64
v_mfma_f32_16x16x32_bf16 v[108:111], v[152:155], v[164:167], 0
s_waitcnt vmcnt(4)
s_waitcnt lgkmcnt(9)
v_mfma_f32_16x16x32_bf16 v[64:67], v[132:135], v[168:171], v[64:67]
ds_read_b64_tr_b16 v[112:113], v21 offset:10240
v_mfma_f32_16x16x32_bf16 v[68:71], v[132:135], v[172:175], v[68:71]
ds_read_b64_tr_b16 v[114:115], v21 offset:11520
s_waitcnt lgkmcnt(9)
v_mfma_f32_16x16x32_bf16 v[72:75], v[136:139], v[168:171], v[72:75]
buffer_load_dwordx4 v[192:195], v22, s[12:15], s54 offen offset:0 sc1
buffer_load_dwordx4 v[196:199], v22, s[12:15], s54 offen offset:256 sc1
s_add_u32 s54, s54, 9216
ds_read_b64_tr_b16 v[116:117], v21 offset:10272
v_mfma_f32_16x16x32_bf16 v[76:79], v[136:139], v[172:175], v[76:79]
ds_read_b64_tr_b16 v[118:119], v21 offset:11552
s_waitcnt lgkmcnt(9)
v_mfma_f32_16x16x32_bf16 v[80:83], v[140:143], v[168:171], v[80:83]
buffer_load_dwordx4 v[200:203], v22, s[12:15], s54 offen offset:0 sc1
buffer_load_dwordx4 v[204:207], v22, s[12:15], s54 offen offset:256 sc1
s_add_u32 s54, s54, 9216
ds_read_b64_tr_b16 v[120:121], v21 offset:10304
v_mfma_f32_16x16x32_bf16 v[84:87], v[140:143], v[172:175], v[84:87]
ds_read_b64_tr_b16 v[122:123], v21 offset:11584
s_waitcnt lgkmcnt(9)
v_mfma_f32_16x16x32_bf16 v[88:91], v[144:147], v[168:171], v[88:91]
ds_read_b64_tr_b16 v[124:125], v21 offset:10336
v_mfma_f32_16x16x32_bf16 v[92:95], v[144:147], v[172:175], v[92:95]
ds_read_b64_tr_b16 v[126:127], v21 offset:11616
s_waitcnt lgkmcnt(9)
v_mfma_f32_16x16x32_bf16 v[96:99], v[148:151], v[168:171], v[96:99]
ds_read_b64_tr_b16 v[128:129], v21 offset:10368
v_mfma_f32_16x16x32_bf16 v[100:103], v[148:151], v[172:175], v[100:103]
ds_read_b64_tr_b16 v[130:131], v21 offset:11648
s_waitcnt lgkmcnt(10)
v_mfma_f32_16x16x32_bf16 v[104:107], v[156:159], v[168:171], v[104:107]
ds_read_b128 v[152:155], v23 offset:128
v_mfma_f32_16x16x32_bf16 v[108:111], v[156:159], v[172:175], v[108:111]
s_waitcnt vmcnt(6)
s_waitcnt lgkmcnt(9)
v_mfma_f32_16x16x32_bf16 v[64:67], v[112:115], v[176:179], v[64:67]
ds_read_b64_tr_b16 v[132:133], v21 offset:15360
v_mfma_f32_16x16x32_bf16 v[68:71], v[112:115], v[180:183], v[68:71]
ds_read_b64_tr_b16 v[134:135], v21 offset:16640
s_waitcnt lgkmcnt(9)
v_mfma_f32_16x16x32_bf16 v[72:75], v[116:119], v[176:179], v[72:75]
buffer_load_dwordx4 v[208:211], v22, s[12:15], s54 offen offset:0 sc1
buffer_load_dwordx4 v[212:215], v22, s[12:15], s54 offen offset:256 sc1
s_add_u32 s54, s54, 9216
ds_read_b64_tr_b16 v[136:137], v21 offset:15392
v_mfma_f32_16x16x32_bf16 v[76:79], v[116:119], v[180:183], v[76:79]
ds_read_b64_tr_b16 v[138:139], v21 offset:16672
s_waitcnt lgkmcnt(9)
v_mfma_f32_16x16x32_bf16 v[80:83], v[120:123], v[176:179], v[80:83]
buffer_load_dwordx4 v[216:219], v22, s[12:15], s54 offen offset:0 sc1
buffer_load_dwordx4 v[220:223], v22, s[12:15], s54 offen offset:256 sc1
s_add_u32 s54, s54, 9216
ds_read_b64_tr_b16 v[140:141], v21 offset:15424
v_mfma_f32_16x16x32_bf16 v[84:87], v[120:123], v[180:183], v[84:87]
ds_read_b64_tr_b16 v[142:143], v21 offset:16704
s_waitcnt lgkmcnt(9)
v_mfma_f32_16x16x32_bf16 v[88:91], v[124:127], v[176:179], v[88:91]
ds_read_b64_tr_b16 v[144:145], v21 offset:15456
v_mfma_f32_16x16x32_bf16 v[92:95], v[124:127], v[180:183], v[92:95]
ds_read_b64_tr_b16 v[146:147], v21 offset:16736
s_waitcnt lgkmcnt(9)
v_mfma_f32_16x16x32_bf16 v[96:99], v[128:131], v[176:179], v[96:99]
ds_read_b64_tr_b16 v[148:149], v21 offset:15488
v_mfma_f32_16x16x32_bf16 v[100:103], v[128:131], v[180:183], v[100:103]
ds_read_b64_tr_b16 v[150:151], v21 offset:16768
s_waitcnt lgkmcnt(10)
v_mfma_f32_16x16x32_bf16 v[104:107], v[152:155], v[176:179], v[104:107]
ds_read_b128 v[156:159], v23 offset:192
v_mfma_f32_16x16x32_bf16 v[108:111], v[152:155], v[180:183], v[108:111]
s_waitcnt vmcnt(8)
s_waitcnt lgkmcnt(9)
v_mfma_f32_16x16x32_bf16 v[64:67], v[132:135], v[184:187], v[64:67]
ds_read_b64_tr_b16 v[112:113], v21 offset:20480
v_mfma_f32_16x16x32_bf16 v[68:71], v[132:135], v[188:191], v[68:71]
ds_read_b64_tr_b16 v[114:115], v21 offset:21760
s_waitcnt lgkmcnt(9)
v_mfma_f32_16x16x32_bf16 v[72:75], v[136:139], v[184:187], v[72:75]
buffer_load_dwordx4 v[224:227], v22, s[12:15], s54 offen offset:0 sc1
buffer_load_dwordx4 v[228:231], v22, s[12:15], s54 offen offset:256 sc1
s_add_u32 s54, s54, 9216
ds_read_b64_tr_b16 v[116:117], v21 offset:20512
v_mfma_f32_16x16x32_bf16 v[76:79], v[136:139], v[188:191], v[76:79]
ds_read_b64_tr_b16 v[118:119], v21 offset:21792
s_waitcnt lgkmcnt(9)
v_mfma_f32_16x16x32_bf16 v[80:83], v[140:143], v[184:187], v[80:83]
ds_read_b64_tr_b16 v[120:121], v21 offset:20544
v_mfma_f32_16x16x32_bf16 v[84:87], v[140:143], v[188:191], v[84:87]
ds_read_b64_tr_b16 v[122:123], v21 offset:21824
s_waitcnt lgkmcnt(9)
v_mfma_f32_16x16x32_bf16 v[88:91], v[144:147], v[184:187], v[88:91]
ds_read_b64_tr_b16 v[124:125], v21 offset:20576
v_mfma_f32_16x16x32_bf16 v[92:95], v[144:147], v[188:191], v[92:95]
ds_read_b64_tr_b16 v[126:127], v21 offset:21856
s_waitcnt lgkmcnt(9)
v_mfma_f32_16x16x32_bf16 v[96:99], v[148:151], v[184:187], v[96:99]
ds_read_b64_tr_b16 v[128:129], v21 offset:20608
v_mfma_f32_16x16x32_bf16 v[100:103], v[148:151], v[188:191], v[100:103]
ds_read_b64_tr_b16 v[130:131], v21 offset:21888
s_waitcnt lgkmcnt(10)
v_mfma_f32_16x16x32_bf16 v[104:107], v[156:159], v[184:187], v[104:107]
ds_read_b128 v[152:155], v23 offset:256
v_mfma_f32_16x16x32_bf16 v[108:111], v[156:159], v[188:191], v[108:111]
s_waitcnt vmcnt(8)
s_waitcnt lgkmcnt(9)
v_mfma_f32_16x16x32_bf16 v[64:67], v[112:115], v[192:195], v[64:67]
ds_read_b64_tr_b16 v[132:133], v21 offset:25600
v_mfma_f32_16x16x32_bf16 v[68:71], v[112:115], v[196:199], v[68:71]
ds_read_b64_tr_b16 v[134:135], v21 offset:26880
s_waitcnt lgkmcnt(9)
v_mfma_f32_16x16x32_bf16 v[72:75], v[116:119], v[192:195], v[72:75]
buffer_load_dwordx4 v[232:235], v22, s[12:15], s54 offen offset:0 sc1
buffer_load_dwordx4 v[236:239], v22, s[12:15], s54 offen offset:256 sc1
ds_read_b64_tr_b16 v[136:137], v21 offset:25632
v_mfma_f32_16x16x32_bf16 v[76:79], v[116:119], v[196:199], v[76:79]
ds_read_b64_tr_b16 v[138:139], v21 offset:26912
s_waitcnt lgkmcnt(9)
v_mfma_f32_16x16x32_bf16 v[80:83], v[120:123], v[192:195], v[80:83]
ds_read_b64_tr_b16 v[140:141], v21 offset:25664
v_mfma_f32_16x16x32_bf16 v[84:87], v[120:123], v[196:199], v[84:87]
ds_read_b64_tr_b16 v[142:143], v21 offset:26944
s_waitcnt lgkmcnt(9)
v_mfma_f32_16x16x32_bf16 v[88:91], v[124:127], v[192:195], v[88:91]
ds_read_b64_tr_b16 v[144:145], v21 offset:25696
v_mfma_f32_16x16x32_bf16 v[92:95], v[124:127], v[196:199], v[92:95]
ds_read_b64_tr_b16 v[146:147], v21 offset:26976
s_waitcnt lgkmcnt(9)
v_mfma_f32_16x16x32_bf16 v[96:99], v[128:131], v[192:195], v[96:99]
ds_read_b64_tr_b16 v[148:149], v21 offset:25728
v_mfma_f32_16x16x32_bf16 v[100:103], v[128:131], v[196:199], v[100:103]
ds_read_b64_tr_b16 v[150:151], v21 offset:27008
s_waitcnt lgkmcnt(10)
v_mfma_f32_16x16x32_bf16 v[104:107], v[152:155], v[192:195], v[104:107]
ds_read_b128 v[156:159], v23 offset:320
v_mfma_f32_16x16x32_bf16 v[108:111], v[152:155], v[196:199], v[108:111]
s_barrier
s_waitcnt vmcnt(8)
s_waitcnt lgkmcnt(9)
v_mfma_f32_16x16x32_bf16 v[64:67], v[132:135], v[200:203], v[64:67]
ds_read_b64_tr_b16 v[112:113], v21 offset:30720
v_mfma_f32_16x16x32_bf16 v[68:71], v[132:135], v[204:207], v[68:71]
ds_read_b64_tr_b16 v[114:115], v21 offset:32000
s_waitcnt lgkmcnt(9)
v_mfma_f32_16x16x32_bf16 v[72:75], v[136:139], v[200:203], v[72:75]
buffer_load_dwordx2 v[240:241], v53, s[4:7], s59 offen offset:0
buffer_load_dwordx2 v[242:243], v53, s[4:7], s59 offen offset:32
buffer_load_dwordx2 v[244:245], v53, s[4:7], s59 offen offset:64
buffer_load_dwordx2 v[246:247], v53, s[4:7], s59 offen offset:96
buffer_load_dwordx2 v[248:249], v53, s[4:7], s59 offen offset:128
buffer_load_dword v55, v54, s[12:15], s60 offen sc1
ds_read_b64_tr_b16 v[116:117], v21 offset:30752
v_mfma_f32_16x16x32_bf16 v[76:79], v[136:139], v[204:207], v[76:79]
ds_read_b64_tr_b16 v[118:119], v21 offset:32032
s_waitcnt lgkmcnt(9)
v_mfma_f32_16x16x32_bf16 v[80:83], v[140:143], v[200:203], v[80:83]
ds_read_b64_tr_b16 v[120:121], v21 offset:30784
v_mfma_f32_16x16x32_bf16 v[84:87], v[140:143], v[204:207], v[84:87]
ds_read_b64_tr_b16 v[122:123], v21 offset:32064
s_waitcnt lgkmcnt(9)
v_mfma_f32_16x16x32_bf16 v[88:91], v[144:147], v[200:203], v[88:91]
ds_read_b64_tr_b16 v[124:125], v21 offset:30816
v_mfma_f32_16x16x32_bf16 v[92:95], v[144:147], v[204:207], v[92:95]
ds_read_b64_tr_b16 v[126:127], v21 offset:32096
s_waitcnt lgkmcnt(9)
v_mfma_f32_16x16x32_bf16 v[96:99], v[148:151], v[200:203], v[96:99]
ds_read_b64_tr_b16 v[128:129], v21 offset:30848
v_mfma_f32_16x16x32_bf16 v[100:103], v[148:151], v[204:207], v[100:103]
ds_read_b64_tr_b16 v[130:131], v21 offset:32128
s_waitcnt lgkmcnt(10)
v_mfma_f32_16x16x32_bf16 v[104:107], v[156:159], v[200:203], v[104:107]
ds_read_b128 v[152:155], v23 offset:384
v_mfma_f32_16x16x32_bf16 v[108:111], v[156:159], v[204:207], v[108:111]
s_waitcnt vmcnt(12)
s_waitcnt lgkmcnt(9)
v_mfma_f32_16x16x32_bf16 v[64:67], v[112:115], v[208:211], v[64:67]
ds_read_b64_tr_b16 v[132:133], v21 offset:35840
v_mfma_f32_16x16x32_bf16 v[68:71], v[112:115], v[212:215], v[68:71]
s_mul_i32 s65, s38, 5376
ds_read_b64_tr_b16 v[134:135], v21 offset:37120
s_waitcnt lgkmcnt(9)
v_mfma_f32_16x16x32_bf16 v[72:75], v[116:119], v[208:211], v[72:75]
s_add_u32 s65, s65, 142336
ds_read_b64_tr_b16 v[136:137], v21 offset:35872
v_mfma_f32_16x16x32_bf16 v[76:79], v[116:119], v[212:215], v[76:79]
v_lshlrev_b32 v26, 4, v1
ds_read_b64_tr_b16 v[138:139], v21 offset:37152
s_waitcnt lgkmcnt(9)
v_mfma_f32_16x16x32_bf16 v[80:83], v[120:123], v[208:211], v[80:83]
v_add_u32 v26, s65, v26
ds_read_b64_tr_b16 v[140:141], v21 offset:35904
v_mfma_f32_16x16x32_bf16 v[84:87], v[120:123], v[212:215], v[84:87]
v_lshlrev_b32 v27, 2, v1
ds_read_b64_tr_b16 v[142:143], v21 offset:37184
s_waitcnt lgkmcnt(9)
v_mfma_f32_16x16x32_bf16 v[88:91], v[124:127], v[208:211], v[88:91]
v_add_u32 v27, s65, v27
ds_read_b64_tr_b16 v[144:145], v21 offset:35936
v_mfma_f32_16x16x32_bf16 v[92:95], v[124:127], v[212:215], v[92:95]
s_xor_b32 s65, s38, 2
ds_read_b64_tr_b16 v[146:147], v21 offset:37216
s_waitcnt lgkmcnt(9)
v_mfma_f32_16x16x32_bf16 v[96:99], v[128:131], v[208:211], v[96:99]
s_mul_i32 s65, s65, 5376
ds_read_b64_tr_b16 v[148:149], v21 offset:35968
v_mfma_f32_16x16x32_bf16 v[100:103], v[128:131], v[212:215], v[100:103]
s_add_u32 s65, s65, 142336
ds_read_b64_tr_b16 v[150:151], v21 offset:37248
s_waitcnt lgkmcnt(10)
v_mfma_f32_16x16x32_bf16 v[104:107], v[152:155], v[208:211], v[104:107]
ds_read_b128 v[156:159], v23 offset:448
v_mfma_f32_16x16x32_bf16 v[108:111], v[152:155], v[212:215], v[108:111]
s_waitcnt vmcnt(10)
s_waitcnt lgkmcnt(9)
v_mfma_f32_16x16x32_bf16 v[64:67], v[132:135], v[216:219], v[64:67]
ds_read_b64_tr_b16 v[112:113], v21 offset:40960
v_mfma_f32_16x16x32_bf16 v[68:71], v[132:135], v[220:223], v[68:71]
v_lshlrev_b32 v28, 4, v1
ds_read_b64_tr_b16 v[114:115], v21 offset:42240
s_waitcnt lgkmcnt(9)
v_mfma_f32_16x16x32_bf16 v[72:75], v[136:139], v[216:219], v[72:75]
v_add_u32 v28, s65, v28
ds_read_b64_tr_b16 v[116:117], v21 offset:40992
v_mfma_f32_16x16x32_bf16 v[76:79], v[136:139], v[220:223], v[76:79]
v_lshlrev_b32 v29, 2, v1
ds_read_b64_tr_b16 v[118:119], v21 offset:42272
s_waitcnt lgkmcnt(9)
v_mfma_f32_16x16x32_bf16 v[80:83], v[140:143], v[216:219], v[80:83]
v_add_u32 v29, s65, v29
ds_read_b64_tr_b16 v[120:121], v21 offset:41024
v_mfma_f32_16x16x32_bf16 v[84:87], v[140:143], v[220:223], v[84:87]
v_and_b32 v4, 1, v3
ds_read_b64_tr_b16 v[122:123], v21 offset:42304
s_waitcnt lgkmcnt(9)
v_mfma_f32_16x16x32_bf16 v[88:91], v[144:147], v[216:219], v[88:91]
v_lshrrev_b32 v5, 1, v3
ds_read_b64_tr_b16 v[124:125], v21 offset:41056
v_mfma_f32_16x16x32_bf16 v[92:95], v[144:147], v[220:223], v[92:95]
v_lshl_add_u32 v4, v4, 1, v5
ds_read_b64_tr_b16 v[126:127], v21 offset:42336
s_waitcnt lgkmcnt(9)
v_mfma_f32_16x16x32_bf16 v[96:99], v[148:151], v[216:219], v[96:99]
v_mul_u32_u24 v4, 2304, v4
ds_read_b64_tr_b16 v[128:129], v21 offset:41088
v_mfma_f32_16x16x32_bf16 v[100:103], v[148:151], v[220:223], v[100:103]
v_lshl_add_u32 v8, v24, 4, v4
ds_read_b64_tr_b16 v[130:131], v21 offset:42368
s_waitcnt lgkmcnt(10)
v_mfma_f32_16x16x32_bf16 v[104:107], v[156:159], v[216:219], v[104:107]
ds_read_b128 v[152:155], v23 offset:512
v_mfma_f32_16x16x32_bf16 v[108:111], v[156:159], v[220:223], v[108:111]
s_waitcnt vmcnt(8)
s_waitcnt lgkmcnt(9)
v_mfma_f32_16x16x32_bf16 v[64:67], v[112:115], v[224:227], v[64:67]
ds_read_b64_tr_b16 v[132:133], v21 offset:46080
v_mfma_f32_16x16x32_bf16 v[68:71], v[112:115], v[228:231], v[68:71]
v_mul_u32_u24 v5, 2304, v5
ds_read_b64_tr_b16 v[134:135], v21 offset:47360
s_waitcnt lgkmcnt(9)
v_mfma_f32_16x16x32_bf16 v[72:75], v[116:119], v[224:227], v[72:75]
v_lshl_add_u32 v9, v24, 4, v5
ds_read_b64_tr_b16 v[136:137], v21 offset:46112
v_mfma_f32_16x16x32_bf16 v[76:79], v[116:119], v[228:231], v[76:79]
v_lshlrev_b32 v10, 2, v24
ds_read_b64_tr_b16 v[138:139], v21 offset:47392
s_waitcnt lgkmcnt(9)
v_mfma_f32_16x16x32_bf16 v[80:83], v[120:123], v[224:227], v[80:83]
s_mul_i32 s61, s36, 630784
ds_read_b64_tr_b16 v[140:141], v21 offset:46144
v_mfma_f32_16x16x32_bf16 v[84:87], v[120:123], v[228:231], v[84:87]
s_mul_i32 s62, s46, 23040
ds_read_b64_tr_b16 v[142:143], v21 offset:47424
s_waitcnt lgkmcnt(9)
v_mfma_f32_16x16x32_bf16 v[88:91], v[124:127], v[224:227], v[88:91]
s_add_u32 s61, s61, s62
ds_read_b64_tr_b16 v[144:145], v21 offset:46176
v_mfma_f32_16x16x32_bf16 v[92:95], v[124:127], v[228:231], v[92:95]
s_add_u32 s61, s61, 1233152
ds_read_b64_tr_b16 v[146:147], v21 offset:47456
s_waitcnt lgkmcnt(9)
v_mfma_f32_16x16x32_bf16 v[96:99], v[128:131], v[224:227], v[96:99]
s_add_u32 s62, s61, 9216
ds_read_b64_tr_b16 v[148:149], v21 offset:46208
v_mfma_f32_16x16x32_bf16 v[100:103], v[128:131], v[228:231], v[100:103]
s_add_u32 s63, s61, 18432
ds_read_b64_tr_b16 v[150:151], v21 offset:47488
s_waitcnt lgkmcnt(10)
v_mfma_f32_16x16x32_bf16 v[104:107], v[152:155], v[224:227], v[104:107]
ds_read_b128 v[156:159], v23 offset:576
v_mfma_f32_16x16x32_bf16 v[108:111], v[152:155], v[228:231], v[108:111]
s_waitcnt vmcnt(6)
s_waitcnt lgkmcnt(9)
v_mfma_f32_16x16x32_bf16 v[64:67], v[132:135], v[232:235], v[64:67]
v_mfma_f32_16x16x32_bf16 v[68:71], v[132:135], v[236:239], v[68:71]
s_waitcnt lgkmcnt(7)
v_mfma_f32_16x16x32_bf16 v[72:75], v[136:139], v[232:235], v[72:75]
s_lshl_b32 s64, s36, 12
v_mfma_f32_16x16x32_bf16 v[76:79], v[136:139], v[236:239], v[76:79]
s_waitcnt lgkmcnt(5)
v_mfma_f32_16x16x32_bf16 v[80:83], v[140:143], v[232:235], v[80:83]
s_lshl_b32 s66, s46, 9
v_mfma_f32_16x16x32_bf16 v[84:87], v[140:143], v[236:239], v[84:87]
s_waitcnt lgkmcnt(3)
v_mfma_f32_16x16x32_bf16 v[88:91], v[144:147], v[232:235], v[88:91]
s_add_u32 s64, s64, s66
v_mfma_f32_16x16x32_bf16 v[92:95], v[144:147], v[236:239], v[92:95]
s_waitcnt lgkmcnt(1)
v_mfma_f32_16x16x32_bf16 v[96:99], v[148:151], v[232:235], v[96:99]
s_add_u32 s64, s64, 131072
v_mfma_f32_16x16x32_bf16 v[100:103], v[148:151], v[236:239], v[100:103]
s_waitcnt lgkmcnt(0)
v_mfma_f32_16x16x32_bf16 v[104:107], v[156:159], v[232:235], v[104:107]
v_mfma_f32_16x16x32_bf16 v[108:111], v[156:159], v[236:239], v[108:111]
s_waitcnt lgkmcnt(0)
s_barrier
s_nop 5
s_cmp_lg_u32 s48, 0
s_cbranch_scc1 L_keep1_4
ds_write_b128 v26, v[68:71] offset:0
ds_write_b128 v26, v[76:79] offset:1024
ds_write_b128 v26, v[84:87] offset:2048
ds_write_b128 v26, v[92:95] offset:3072
ds_write_b128 v26, v[100:103] offset:4096
ds_write_b32 v27, v108 offset:5120
s_branch L_kdone_5
L_keep1_4:
ds_write_b128 v26, v[64:67] offset:0
ds_write_b128 v26, v[72:75] offset:1024
ds_write_b128 v26, v[80:83] offset:2048
ds_write_b128 v26, v[88:91] offset:3072
ds_write_b128 v26, v[96:99] offset:4096
ds_write_b32 v27, v104 offset:5120
s_waitcnt lgkmcnt(0)
v_mov_b32 v64, v68
v_mov_b32 v65, v69
v_mov_b32 v66, v70
v_mov_b32 v67, v71
v_mov_b32 v72, v76
v_mov_b32 v73, v77
v_mov_b32 v74, v78
v_mov_b32 v75, v79
v_mov_b32 v80, v84
v_mov_b32 v81, v85
v_mov_b32 v82, v86
v_mov_b32 v83, v87
v_mov_b32 v88, v92
v_mov_b32 v89, v93
v_mov_b32 v90, v94
v_mov_b32 v91, v95
v_mov_b32 v96, v100
v_mov_b32 v97, v101
v_mov_b32 v98, v102
v_mov_b32 v99, v103
v_mov_b32 v104, v108
L_kdone_5:
s_waitcnt lgkmcnt(0)
s_barrier
ds_read_b128 v[68:71], v28 offset:0
ds_read_b128 v[76:79], v28 offset:1024
ds_read_b128 v[84:87], v28 offset:2048
ds_read_b128 v[92:95], v28 offset:3072
ds_read_b128 v[100:103], v28 offset:4096
ds_read_b32 v108, v29 offset:5120
s_waitcnt vmcnt(0)
s_waitcnt lgkmcnt(0)
v_pk_add_f32 v[64:65], v[64:65], v[68:69]
v_pk_add_f32 v[66:67], v[66:67], v[70:71]
v_pk_add_f32 v[72:73], v[72:73], v[76:77]
v_pk_add_f32 v[74:75], v[74:75], v[78:79]
v_pk_add_f32 v[80:81], v[80:81], v[84:85]
v_pk_add_f32 v[82:83], v[82:83], v[86:87]
v_pk_add_f32 v[88:89], v[88:89], v[92:93]
v_pk_add_f32 v[90:91], v[90:91], v[94:95]
v_pk_add_f32 v[96:97], v[96:97], v[100:101]
v_pk_add_f32 v[98:99], v[98:99], v[102:103]
v_add_f32 v104, v104, v108
v_add_f32 v104, v104, v55
v_lshlrev_b32 v4, 16, v240
v_and_b32 v5, 0xffff0000, v240
v_pk_add_f32 v[64:65], v[64:65], v[4:5]
v_lshlrev_b32 v4, 16, v241
v_and_b32 v5, 0xffff0000, v241
v_pk_add_f32 v[66:67], v[66:67], v[4:5]
v_lshlrev_b32 v4, 16, v242
v_and_b32 v5, 0xffff0000, v242
v_pk_add_f32 v[72:73], v[72:73], v[4:5]
v_lshlrev_b32 v4, 16, v243
v_and_b32 v5, 0xffff0000, v243
v_pk_add_f32 v[74:75], v[74:75], v[4:5]
v_lshlrev_b32 v4, 16, v244
v_and_b32 v5, 0xffff0000, v244
v_pk_add_f32 v[80:81], v[80:81], v[4:5]
v_lshlrev_b32 v4, 16, v245
v_and_b32 v5, 0xffff0000, v245
v_pk_add_f32 v[82:83], v[82:83], v[4:5]
v_lshlrev_b32 v4, 16, v246
v_and_b32 v5, 0xffff0000, v246
v_pk_add_f32 v[88:89], v[88:89], v[4:5]
v_lshlrev_b32 v4, 16, v247
v_and_b32 v5, 0xffff0000, v247
v_pk_add_f32 v[90:91], v[90:91], v[4:5]
v_lshlrev_b32 v4, 16, v248
v_and_b32 v5, 0xffff0000, v248
v_pk_add_f32 v[96:97], v[96:97], v[4:5]
v_lshlrev_b32 v4, 16, v249
v_and_b32 v5, 0xffff0000, v249
v_pk_add_f32 v[98:99], v[98:99], v[4:5]
v_cvt_pk_bf16_f32 v240, v64, v65
v_cvt_pk_bf16_f32 v241, v66, v67
v_cvt_pk_bf16_f32 v242, v72, v73
v_cvt_pk_bf16_f32 v243, v74, v75
v_cvt_pk_bf16_f32 v244, v80, v81
v_cvt_pk_bf16_f32 v245, v82, v83
v_cvt_pk_bf16_f32 v246, v88, v89
v_cvt_pk_bf16_f32 v247, v90, v91
v_cvt_pk_bf16_f32 v248, v96, v97
v_cvt_pk_bf16_f32 v249, v98, v99
v_pk_add_f32 v[64:65], v[64:65], v[104:105] op_sel_hi:[1,0] neg_lo:[0,1] neg_hi:[0,1]
v_pk_add_f32 v[66:67], v[66:67], v[104:105] op_sel_hi:[1,0] neg_lo:[0,1] neg_hi:[0,1]
v_pk_add_f32 v[72:73], v[72:73], v[104:105] op_sel_hi:[1,0] neg_lo:[0,1] neg_hi:[0,1]
v_pk_add_f32 v[74:75], v[74:75], v[104:105] op_sel_hi:[1,0] neg_lo:[0,1] neg_hi:[0,1]
v_pk_add_f32 v[80:81], v[80:81], v[104:105] op_sel_hi:[1,0] neg_lo:[0,1] neg_hi:[0,1]
v_pk_add_f32 v[82:83], v[82:83], v[104:105] op_sel_hi:[1,0] neg_lo:[0,1] neg_hi:[0,1]
v_pk_add_f32 v[88:89], v[88:89], v[104:105] op_sel_hi:[1,0] neg_lo:[0,1] neg_hi:[0,1]
v_pk_add_f32 v[90:91], v[90:91], v[104:105] op_sel_hi:[1,0] neg_lo:[0,1] neg_hi:[0,1]
v_pk_add_f32 v[96:97], v[96:97], v[104:105] op_sel_hi:[1,0] neg_lo:[0,1] neg_hi:[0,1]
v_pk_add_f32 v[98:99], v[98:99], v[104:105] op_sel_hi:[1,0] neg_lo:[0,1] neg_hi:[0,1]
v_cvt_pk_bf16_f32 v112, v64, v65
v_cvt_pk_bf16_f32 v113, v66, v67
v_cvt_pk_bf16_f32 v114, v72, v73
v_cvt_pk_bf16_f32 v115, v74, v75
v_cvt_pk_bf16_f32 v116, v80, v81
v_cvt_pk_bf16_f32 v117, v82, v83
v_cvt_pk_bf16_f32 v118, v88, v89
v_cvt_pk_bf16_f32 v119, v90, v91
v_cvt_pk_bf16_f32 v120, v96, v97
v_cvt_pk_bf16_f32 v121, v98, v99
s_nop 0
v_mov_b32 v122, v120
v_mov_b32 v123, v121
s_nop 1
v_permlane16_swap_b32 v112, v114
v_permlane16_swap_b32 v113, v115
v_permlane16_swap_b32 v116, v118
v_permlane16_swap_b32 v117, v119
v_permlane16_swap_b32 v120, v122
v_permlane16_swap_b32 v121, v123
v_mov_b32 v6, 0
v_mov_b32 v7, 0
v_pk_fma_f32 v[6:7], v[64:65], v[64:65], v[6:7]
v_pk_fma_f32 v[6:7], v[66:67], v[66:67], v[6:7]
v_pk_fma_f32 v[6:7], v[72:73], v[72:73], v[6:7]
v_pk_fma_f32 v[6:7], v[74:75], v[74:75], v[6:7]
v_pk_fma_f32 v[6:7], v[80:81], v[80:81], v[6:7]
v_pk_fma_f32 v[6:7], v[82:83], v[82:83], v[6:7]
v_pk_fma_f32 v[6:7], v[88:89], v[88:89], v[6:7]
v_pk_fma_f32 v[6:7], v[90:91], v[90:91], v[6:7]
v_pk_fma_f32 v[6:7], v[96:97], v[96:97], v[6:7]
v_pk_fma_f32 v[6:7], v[98:99], v[98:99], v[6:7]
v_add_f32 v6, v6, v7
v_mov_b32 v7, v6
s_nop 1
v_permlane32_swap_b32 v6, v7
s_nop 0
v_add_f32 v6, v6, v7
v_mov_b32 v7, v6
s_nop 1
v_permlane16_swap_b32 v6, v7
s_nop 0
v_add_f32 v6, v6, v7
s_cmp_eq_u32 s40, 0
s_cbranch_scc1 L_stsafe_6
buffer_store_dwordx4 v[112:115], v8, s[12:15], s61 offen
buffer_store_dwordx4 v[116:119], v8, s[12:15], s62 offen
buffer_store_dwordx4 v[120:123], v9, s[12:15], s63 offen
buffer_store_dword v6, v10, s[12:15], s64 offen
s_branch L_stdone_7
L_stsafe_6:
buffer_store_dwordx4 v[112:115], v8, s[12:15], s61 offen sc1
buffer_store_dwordx4 v[116:119], v8, s[12:15], s62 offen sc1
buffer_store_dwordx4 v[120:123], v9, s[12:15], s63 offen sc1
buffer_store_dword v6, v10, s[12:15], s64 offen sc1
L_stdone_7:
s_waitcnt vmcnt(0)
s_waitcnt lgkmcnt(0)
s_barrier
s_barrier
s_barrier
v_and_b32 v25, 31, v1
s_lshl_b32 s51, s38, 5
v_add_u32 v25, s51, v25
v_lshrrev_b32 v26, 5, v1
v_mul_u32_u24 v24, 2304, v26
v_lshl_add_u32 v24, v25, 4, v24
s_mul_i32 s52, s36, 630784
s_add_u32 s52, s52, 1233152
s_mov_b32 s42, 0
s_mul_i32 s43, s42, 92160
s_add_u32 s52, s52, s43
s_mul_i32 s43, s42, 184320
s_sub_u32 s60, 4608, s43
buffer_load_dwordx4 v[208:211], v24, s[12:15], s52 offen sc1
s_add_u32 s52, s52, 4608
buffer_load_dwordx4 v[212:215], v24, s[12:15], s52 offen sc1
s_add_u32 s52, s52, 4608
buffer_load_dwordx4 v[216:219], v24, s[12:15], s52 offen sc1
s_add_u32 s52, s52, 4608
v_lshlrev_b32 v4, 2, v25
v_mul_u32_u24 v5, 2048, v26
v_add_u32 v4, v4, v5
s_lshl_b32 s59, s36, 12
s_add_u32 s59, s59, 131072
buffer_load_dword v28, v4, s[12:15], s59 offen offset:0 sc1
buffer_load_dword v29, v4, s[12:15], s59 offen offset:512 sc1
buffer_load_dword v30, v4, s[12:15], s59 offen offset:1024 sc1
buffer_load_dword v31, v4, s[12:15], s59 offen offset:1536 sc1
v_lshrrev_b32 v4, 2, v2
v_lshrrev_b32 v5, 1, v3
v_lshl_add_u32 v4, v5, 3, v4
v_mul_u32_u24 v4, 192, v4
v_and_b32 v5, 1, v3
v_lshl_add_u32 v4, v5, 5, v4
v_and_b32 v5, 3, v2
v_lshl_add_u32 v20, v5, 3, v4
v_add_u32 v21, 49152, v20
v_add_u32 v22, 98304, v20
ds_read_b64_tr_b16 v[160:161], v20 offset:0
ds_read_b64_tr_b16 v[162:163], v20 offset:768
ds_read_b64_tr_b16 v[164:165], v20 offset:64
ds_read_b64_tr_b16 v[166:167], v20 offset:832
ds_read_b64_tr_b16 v[168:169], v20 offset:128
ds_read_b64_tr_b16 v[170:171], v20 offset:896
ds_read_b64_tr_b16 v[172:173], v20 offset:6144
ds_read_b64_tr_b16 v[174:175], v20 offset:6912
ds_read_b64_tr_b16 v[176:177], v20 offset:6208
ds_read_b64_tr_b16 v[178:179], v20 offset:6976
ds_read_b64_tr_b16 v[180:181], v20 offset:6272
ds_read_b64_tr_b16 v[182:183], v20 offset:7040
s_waitcnt vmcnt(6)
s_waitcnt lgkmcnt(10)
v_mfma_f32_32x32x16_bf16 v[64:79], v[160:163], v[208:211], 0
ds_read_b64_tr_b16 v[184:185], v20 offset:3072
ds_read_b64_tr_b16 v[186:187], v20 offset:3840
s_waitcnt lgkmcnt(10)
v_mfma_f32_32x32x16_bf16 v[80:95], v[164:167], v[208:211], 0
ds_read_b64_tr_b16 v[188:189], v20 offset:3136
ds_read_b64_tr_b16 v[190:191], v20 offset:3904
buffer_load_dwordx4 v[220:223], v24, s[12:15], s52 offen sc1
s_add_u32 s52, s52, 4608
s_waitcnt lgkmcnt(10)
v_mfma_f32_32x32x16_bf16 v[96:111], v[168:171], v[208:211], 0
ds_read_b64_tr_b16 v[192:193], v20 offset:3200
ds_read_b64_tr_b16 v[194:195], v20 offset:3968
s_waitcnt lgkmcnt(10)
v_mfma_f32_32x32x16_bf16 v[112:127], v[172:175], v[208:211], 0
buffer_load_dwordx4 v[224:227], v24, s[12:15], s52 offen sc1
s_add_u32 s52, s52, 4608
ds_read_b64_tr_b16 v[196:197], v20 offset:9216
ds_read_b64_tr_b16 v[198:199], v20 offset:9984
s_waitcnt lgkmcnt(10)
v_mfma_f32_32x32x16_bf16 v[128:143], v[176:179], v[208:211], 0
ds_read_b64_tr_b16 v[200:201], v20 offset:9280
ds_read_b64_tr_b16 v[202:203], v20 offset:10048
s_waitcnt lgkmcnt(10)
v_mfma_f32_32x32x16_bf16 v[144:159], v[180:183], v[208:211], 0
ds_read_b64_tr_b16 v[204:205], v20 offset:9344
ds_read_b64_tr_b16 v[206:207], v20 offset:10112
s_waitcnt vmcnt(7)
s_waitcnt lgkmcnt(10)
v_mfma_f32_32x32x16_bf16 v[64:79], v[184:187], v[212:215], v[64:79]
ds_read_b64_tr_b16 v[160:161], v20 offset:12288
ds_read_b64_tr_b16 v[162:163], v20 offset:13056
s_waitcnt lgkmcnt(10)
v_mfma_f32_32x32x16_bf16 v[80:95], v[188:191], v[212:215], v[80:95]
ds_read_b64_tr_b16 v[164:165], v20 offset:12352
ds_read_b64_tr_b16 v[166:167], v20 offset:13120
buffer_load_dwordx4 v[228:231], v24, s[12:15], s52 offen sc1
s_add_u32 s52, s52, 4608
s_waitcnt lgkmcnt(10)
v_mfma_f32_32x32x16_bf16 v[96:111], v[192:195], v[212:215], v[96:111]
ds_read_b64_tr_b16 v[168:169], v20 offset:12416
ds_read_b64_tr_b16 v[170:171], v20 offset:13184
s_waitcnt lgkmcnt(10)
v_mfma_f32_32x32x16_bf16 v[112:127], v[196:199], v[212:215], v[112:127]
buffer_load_dwordx4 v[232:235], v24, s[12:15], s52 offen sc1
s_add_u32 s52, s52, 4608
ds_read_b64_tr_b16 v[172:173], v20 offset:18432
ds_read_b64_tr_b16 v[174:175], v20 offset:19200
s_waitcnt lgkmcnt(10)
v_mfma_f32_32x32x16_bf16 v[128:143], v[200:203], v[212:215], v[128:143]
ds_read_b64_tr_b16 v[176:177], v20 offset:18496
ds_read_b64_tr_b16 v[178:179], v20 offset:19264
s_waitcnt lgkmcnt(10)
v_mfma_f32_32x32x16_bf16 v[144:159], v[204:207], v[212:215], v[144:159]
ds_read_b64_tr_b16 v[180:181], v20 offset:18560
ds_read_b64_tr_b16 v[182:183], v20 offset:19328
s_waitcnt vmcnt(8)
s_waitcnt lgkmcnt(10)
v_mfma_f32_32x32x16_bf16 v[64:79], v[160:163], v[216:219], v[64:79]
ds_read_b64_tr_b16 v[184:185], v20 offset:15360
ds_read_b64_tr_b16 v[186:187], v20 offset:16128
s_waitcnt lgkmcnt(10)
v_mfma_f32_32x32x16_bf16 v[80:95], v[164:167], v[216:219], v[80:95]
ds_read_b64_tr_b16 v[188:189], v20 offset:15424
ds_read_b64_tr_b16 v[190:191], v20 offset:16192
buffer_load_dwordx4 v[236:239], v24, s[12:15], s52 offen sc1
s_add_u32 s52, s52, 4608
s_waitcnt lgkmcnt(10)
v_mfma_f32_32x32x16_bf16 v[96:111], v[168:171], v[216:219], v[96:111]
ds_read_b64_tr_b16 v[192:193], v20 offset:15488
ds_read_b64_tr_b16 v[194:195], v20 offset:16256
s_waitcnt lgkmcnt(10)
v_mfma_f32_32x32x16_bf16 v[112:127], v[172:175], v[216:219], v[112:127]
buffer_load_dwordx4 v[32:35], v24, s[12:15], s52 offen sc1
s_add_u32 s52, s52, 4608
ds_read_b64_tr_b16 v[196:197], v20 offset:21504
ds_read_b64_tr_b16 v[198:199], v20 offset:22272
s_waitcnt lgkmcnt(10)
v_mfma_f32_32x32x16_bf16 v[128:143], v[176:179], v[216:219], v[128:143]
ds_read_b64_tr_b16 v[200:201], v20 offset:21568
ds_read_b64_tr_b16 v[202:203], v20 offset:22336
s_waitcnt lgkmcnt(10)
v_mfma_f32_32x32x16_bf16 v[144:159], v[180:183], v[216:219], v[144:159]
ds_read_b64_tr_b16 v[204:205], v20 offset:21632
ds_read_b64_tr_b16 v[206:207], v20 offset:22400
s_waitcnt lgkmcnt(0)
s_barrier
s_waitcnt vmcnt(5)
v_mfma_f32_32x32x16_bf16 v[64:79], v[184:187], v[220:223], v[64:79]
ds_read_b64_tr_b16 v[160:161], v20 offset:24576
ds_read_b64_tr_b16 v[162:163], v20 offset:25344
v_mfma_f32_32x32x16_bf16 v[80:95], v[188:191], v[220:223], v[80:95]
ds_read_b64_tr_b16 v[164:165], v20 offset:24640
ds_read_b64_tr_b16 v[166:167], v20 offset:25408
buffer_load_dwordx4 v[36:39], v24, s[12:15], s52 offen sc1
s_add_u32 s52, s52, 4608
v_mfma_f32_32x32x16_bf16 v[96:111], v[192:195], v[220:223], v[96:111]
ds_read_b64_tr_b16 v[168:169], v20 offset:24704
ds_read_b64_tr_b16 v[170:171], v20 offset:25472
v_mfma_f32_32x32x16_bf16 v[112:127], v[196:199], v[220:223], v[112:127]
buffer_load_dwordx4 v[40:43], v24, s[12:15], s52 offen sc1
s_add_u32 s52, s52, 4608
ds_read_b64_tr_b16 v[172:173], v20 offset:30720
ds_read_b64_tr_b16 v[174:175], v20 offset:31488
v_mfma_f32_32x32x16_bf16 v[128:143], v[200:203], v[220:223], v[128:143]
ds_read_b64_tr_b16 v[176:177], v20 offset:30784
ds_read_b64_tr_b16 v[178:179], v20 offset:31552
v_mfma_f32_32x32x16_bf16 v[144:159], v[204:207], v[220:223], v[144:159]
ds_read_b64_tr_b16 v[180:181], v20 offset:30848
ds_read_b64_tr_b16 v[182:183], v20 offset:31616
s_waitcnt vmcnt(6)
s_waitcnt lgkmcnt(10)
v_mfma_f32_32x32x16_bf16 v[64:79], v[160:163], v[224:227], v[64:79]
ds_read_b64_tr_b16 v[184:185], v20 offset:27648
ds_read_b64_tr_b16 v[186:187], v20 offset:28416
s_waitcnt lgkmcnt(10)
v_mfma_f32_32x32x16_bf16 v[80:95], v[164:167], v[224:227], v[80:95]
ds_read_b64_tr_b16 v[188:189], v20 offset:27712
ds_read_b64_tr_b16 v[190:191], v20 offset:28480
buffer_load_dwordx4 v[44:47], v24, s[12:15], s52 offen sc1
s_add_u32 s52, s52, 4608
s_waitcnt lgkmcnt(10)
v_mfma_f32_32x32x16_bf16 v[96:111], v[168:171], v[224:227], v[96:111]
ds_read_b64_tr_b16 v[192:193], v20 offset:27776
ds_read_b64_tr_b16 v[194:195], v20 offset:28544
s_waitcnt lgkmcnt(10)
v_mfma_f32_32x32x16_bf16 v[112:127], v[172:175], v[224:227], v[112:127]
buffer_load_dwordx4 v[48:51], v24, s[12:15], s52 offen sc1
s_add_u32 s52, s52, 4608
ds_read_b64_tr_b16 v[196:197], v20 offset:33792
ds_read_b64_tr_b16 v[198:199], v20 offset:34560
s_waitcnt lgkmcnt(10)
v_mfma_f32_32x32x16_bf16 v[128:143], v[176:179], v[224:227], v[128:143]
ds_read_b64_tr_b16 v[200:201], v20 offset:33856
ds_read_b64_tr_b16 v[202:203], v20 offset:34624
s_waitcnt lgkmcnt(10)
v_mfma_f32_32x32x16_bf16 v[144:159], v[180:183], v[224:227], v[144:159]
ds_read_b64_tr_b16 v[204:205], v20 offset:33920
ds_read_b64_tr_b16 v[206:207], v20 offset:34688
s_waitcnt vmcnt(7)
s_waitcnt lgkmcnt(10)
v_mfma_f32_32x32x16_bf16 v[64:79], v[184:187], v[228:231], v[64:79]
ds_read_b64_tr_b16 v[160:161], v20 offset:36864
ds_read_b64_tr_b16 v[162:163], v20 offset:37632
s_waitcnt lgkmcnt(10)
v_mfma_f32_32x32x16_bf16 v[80:95], v[188:191], v[228:231], v[80:95]
ds_read_b64_tr_b16 v[164:165], v20 offset:36928
ds_read_b64_tr_b16 v[166:167], v20 offset:37696
buffer_load_dwordx4 v[52:55], v24, s[12:15], s52 offen sc1
s_add_u32 s52, s52, 4608
s_waitcnt lgkmcnt(10)
v_mfma_f32_32x32x16_bf16 v[96:111], v[192:195], v[228:231], v[96:111]
ds_read_b64_tr_b16 v[168:169], v20 offset:36992
ds_read_b64_tr_b16 v[170:171], v20 offset:37760
s_waitcnt lgkmcnt(10)
v_mfma_f32_32x32x16_bf16 v[112:127], v[196:199], v[228:231], v[112:127]
ds_read_b64_tr_b16 v[172:173], v20 offset:43008
ds_read_b64_tr_b16 v[174:175], v20 offset:43776
s_waitcnt lgkmcnt(10)
v_mfma_f32_32x32x16_bf16 v[128:143], v[200:203], v[228:231], v[128:143]
ds_read_b64_tr_b16 v[176:177], v20 offset:43072
ds_read_b64_tr_b16 v[178:179], v20 offset:43840
s_waitcnt lgkmcnt(10)
v_mfma_f32_32x32x16_bf16 v[144:159], v[204:207], v[228:231], v[144:159]
ds_read_b64_tr_b16 v[180:181], v20 offset:43136
ds_read_b64_tr_b16 v[182:183], v20 offset:43904
s_waitcnt vmcnt(7)
s_waitcnt lgkmcnt(10)
v_mfma_f32_32x32x16_bf16 v[64:79], v[160:163], v[232:235], v[64:79]
ds_read_b64_tr_b16 v[184:185], v20 offset:39936
ds_read_b64_tr_b16 v[186:187], v20 offset:40704
s_waitcnt lgkmcnt(10)
v_mfma_f32_32x32x16_bf16 v[80:95], v[164:167], v[232:235], v[80:95]
ds_read_b64_tr_b16 v[188:189], v20 offset:40000
ds_read_b64_tr_b16 v[190:191], v20 offset:40768
buffer_load_dwordx4 v[56:59], v24, s[12:15], s52 offen sc1
s_add_u32 s52, s52, 4608
s_waitcnt lgkmcnt(10)
v_mfma_f32_32x32x16_bf16 v[96:111], v[168:171], v[232:235], v[96:111]
ds_read_b64_tr_b16 v[192:193], v20 offset:40064
ds_read_b64_tr_b16 v[194:195], v20 offset:40832
s_waitcnt lgkmcnt(10)
v_mfma_f32_32x32x16_bf16 v[112:127], v[172:175], v[232:235], v[112:127]
ds_read_b64_tr_b16 v[196:197], v20 offset:46080
ds_read_b64_tr_b16 v[198:199], v20 offset:46848
s_waitcnt lgkmcnt(10)
v_mfma_f32_32x32x16_bf16 v[128:143], v[176:179], v[232:235], v[128:143]
ds_read_b64_tr_b16 v[200:201], v20 offset:46144
ds_read_b64_tr_b16 v[202:203], v20 offset:46912
s_waitcnt lgkmcnt(10)
v_mfma_f32_32x32x16_bf16 v[144:159], v[180:183], v[232:235], v[144:159]
ds_read_b64_tr_b16 v[204:205], v20 offset:46208
ds_read_b64_tr_b16 v[206:207], v20 offset:46976
s_waitcnt lgkmcnt(0)
s_barrier
s_waitcnt vmcnt(7)
v_mfma_f32_32x32x16_bf16 v[64:79], v[184:187], v[236:239], v[64:79]
ds_read_b64_tr_b16 v[160:161], v21 offset:0
ds_read_b64_tr_b16 v[162:163], v21 offset:768
v_mfma_f32_32x32x16_bf16 v[80:95], v[188:191], v[236:239], v[80:95]
ds_read_b64_tr_b16 v[164:165], v21 offset:64
ds_read_b64_tr_b16 v[166:167], v21 offset:832
buffer_load_dwordx4 v[60:63], v24, s[12:15], s52 offen sc1
s_add_u32 s52, s52, 4608
v_mfma_f32_32x32x16_bf16 v[96:111], v[192:195], v[236:239], v[96:111]
ds_read_b64_tr_b16 v[168:169], v21 offset:128
ds_read_b64_tr_b16 v[170:171], v21 offset:896
v_mfma_f32_32x32x16_bf16 v[112:127], v[196:199], v[236:239], v[112:127]
ds_read_b64_tr_b16 v[172:173], v21 offset:6144
ds_read_b64_tr_b16 v[174:175], v21 offset:6912
v_mfma_f32_32x32x16_bf16 v[128:143], v[200:203], v[236:239], v[128:143]
ds_read_b64_tr_b16 v[176:177], v21 offset:6208
ds_read_b64_tr_b16 v[178:179], v21 offset:6976
v_mfma_f32_32x32x16_bf16 v[144:159], v[204:207], v[236:239], v[144:159]
ds_read_b64_tr_b16 v[180:181], v21 offset:6272
ds_read_b64_tr_b16 v[182:183], v21 offset:7040
s_waitcnt vmcnt(7)
s_waitcnt lgkmcnt(10)
v_mfma_f32_32x32x16_bf16 v[64:79], v[160:163], v[32:35], v[64:79]
ds_read_b64_tr_b16 v[184:185], v21 offset:3072
ds_read_b64_tr_b16 v[186:187], v21 offset:3840
s_waitcnt lgkmcnt(10)
v_mfma_f32_32x32x16_bf16 v[80:95], v[164:167], v[32:35], v[80:95]
ds_read_b64_tr_b16 v[188:189], v21 offset:3136
ds_read_b64_tr_b16 v[190:191], v21 offset:3904
buffer_load_dwordx4 v[208:211], v24, s[12:15], s52 offen sc1
s_add_u32 s52, s52, 4608
s_waitcnt lgkmcnt(10)
v_mfma_f32_32x32x16_bf16 v[96:111], v[168:171], v[32:35], v[96:111]
ds_read_b64_tr_b16 v[192:193], v21 offset:3200
ds_read_b64_tr_b16 v[194:195], v21 offset:3968
s_waitcnt lgkmcnt(10)
v_mfma_f32_32x32x16_bf16 v[112:127], v[172:175], v[32:35], v[112:127]
ds_read_b64_tr_b16 v[196:197], v21 offset:9216
ds_read_b64_tr_b16 v[198:199], v21 offset:9984
s_waitcnt lgkmcnt(10)
v_mfma_f32_32x32x16_bf16 v[128:143], v[176:179], v[32:35], v[128:143]
ds_read_b64_tr_b16 v[200:201], v21 offset:9280
ds_read_b64_tr_b16 v[202:203], v21 offset:10048
s_waitcnt lgkmcnt(10)
v_mfma_f32_32x32x16_bf16 v[144:159], v[180:183], v[32:35], v[144:159]
ds_read_b64_tr_b16 v[204:205], v21 offset:9344
ds_read_b64_tr_b16 v[206:207], v21 offset:10112
s_waitcnt vmcnt(7)
s_waitcnt lgkmcnt(10)
v_mfma_f32_32x32x16_bf16 v[64:79], v[184:187], v[36:39], v[64:79]
ds_read_b64_tr_b16 v[160:161], v21 offset:12288
ds_read_b64_tr_b16 v[162:163], v21 offset:13056
s_waitcnt lgkmcnt(10)
v_mfma_f32_32x32x16_bf16 v[80:95], v[188:191], v[36:39], v[80:95]
ds_read_b64_tr_b16 v[164:165], v21 offset:12352
ds_read_b64_tr_b16 v[166:167], v21 offset:13120
buffer_load_dwordx4 v[212:215], v24, s[12:15], s52 offen sc1
s_add_u32 s52, s52, 4608
s_waitcnt lgkmcnt(10)
v_mfma_f32_32x32x16_bf16 v[96:111], v[192:195], v[36:39], v[96:111]
ds_read_b64_tr_b16 v[168:169], v21 offset:12416
ds_read_b64_tr_b16 v[170:171], v21 offset:13184
s_waitcnt lgkmcnt(10)
v_mfma_f32_32x32x16_bf16 v[112:127], v[196:199], v[36:39], v[112:127]
ds_read_b64_tr_b16 v[172:173], v21 offset:18432
ds_read_b64_tr_b16 v[174:175], v21 offset:19200
s_waitcnt lgkmcnt(10)
v_mfma_f32_32x32x16_bf16 v[128:143], v[200:203], v[36:39], v[128:143]
ds_read_b64_tr_b16 v[176:177], v21 offset:18496
ds_read_b64_tr_b16 v[178:179], v21 offset:19264
s_waitcnt lgkmcnt(10)
v_mfma_f32_32x32x16_bf16 v[144:159], v[204:207], v[36:39], v[144:159]
ds_read_b64_tr_b16 v[180:181], v21 offset:18560
ds_read_b64_tr_b16 v[182:183], v21 offset:19328
s_waitcnt vmcnt(7)
s_waitcnt lgkmcnt(10)
v_mfma_f32_32x32x16_bf16 v[64:79], v[160:163], v[40:43], v[64:79]
ds_read_b64_tr_b16 v[184:185], v21 offset:15360
ds_read_b64_tr_b16 v[186:187], v21 offset:16128
s_waitcnt lgkmcnt(10)
v_mfma_f32_32x32x16_bf16 v[80:95], v[164:167], v[40:43], v[80:95]
ds_read_b64_tr_b16 v[188:189], v21 offset:15424
ds_read_b64_tr_b16 v[190:191], v21 offset:16192
buffer_load_dwordx4 v[216:219], v24, s[12:15], s52 offen sc1
s_add_u32 s52, s52, 4608
s_waitcnt lgkmcnt(10)
v_mfma_f32_32x32x16_bf16 v[96:111], v[168:171], v[40:43], v[96:111]
ds_read_b64_tr_b16 v[192:193], v21 offset:15488
ds_read_b64_tr_b16 v[194:195], v21 offset:16256
s_waitcnt lgkmcnt(10)
v_mfma_f32_32x32x16_bf16 v[112:127], v[172:175], v[40:43], v[112:127]
ds_read_b64_tr_b16 v[196:197], v21 offset:21504
ds_read_b64_tr_b16 v[198:199], v21 offset:22272
s_waitcnt lgkmcnt(10)
v_mfma_f32_32x32x16_bf16 v[128:143], v[176:179], v[40:43], v[128:143]
ds_read_b64_tr_b16 v[200:201], v21 offset:21568
ds_read_b64_tr_b16 v[202:203], v21 offset:22336
s_waitcnt lgkmcnt(10)
v_mfma_f32_32x32x16_bf16 v[144:159], v[180:183], v[40:43], v[144:159]
ds_read_b64_tr_b16 v[204:205], v21 offset:21632
ds_read_b64_tr_b16 v[206:207], v21 offset:22400
s_waitcnt lgkmcnt(0)
s_barrier
s_waitcnt vmcnt(7)
v_mfma_f32_32x32x16_bf16 v[64:79], v[184:187], v[44:47], v[64:79]
ds_read_b64_tr_b16 v[160:161], v21 offset:24576
ds_read_b64_tr_b16 v[162:163], v21 offset:25344
v_mfma_f32_32x32x16_bf16 v[80:95], v[188:191], v[44:47], v[80:95]
ds_read_b64_tr_b16 v[164:165], v21 offset:24640
ds_read_b64_tr_b16 v[166:167], v21 offset:25408
buffer_load_dwordx4 v[220:223], v24, s[12:15], s52 offen sc1
s_add_u32 s52, s52, s60
v_mfma_f32_32x32x16_bf16 v[96:111], v[192:195], v[44:47], v[96:111]
ds_read_b64_tr_b16 v[168:169], v21 offset:24704
ds_read_b64_tr_b16 v[170:171], v21 offset:25472
v_mfma_f32_32x32x16_bf16 v[112:127], v[196:199], v[44:47], v[112:127]
ds_read_b64_tr_b16 v[172:173], v21 offset:30720
ds_read_b64_tr_b16 v[174:175], v21 offset:31488
v_mfma_f32_32x32x16_bf16 v[128:143], v[200:203], v[44:47], v[128:143]
ds_read_b64_tr_b16 v[176:177], v21 offset:30784
ds_read_b64_tr_b16 v[178:179], v21 offset:31552
v_mfma_f32_32x32x16_bf16 v[144:159], v[204:207], v[44:47], v[144:159]
ds_read_b64_tr_b16 v[180:181], v21 offset:30848
ds_read_b64_tr_b16 v[182:183], v21 offset:31616
s_waitcnt vmcnt(7)
s_waitcnt lgkmcnt(10)
v_mfma_f32_32x32x16_bf16 v[64:79], v[160:163], v[48:51], v[64:79]
ds_read_b64_tr_b16 v[184:185], v21 offset:27648
ds_read_b64_tr_b16 v[186:187], v21 offset:28416
s_waitcnt lgkmcnt(10)
v_mfma_f32_32x32x16_bf16 v[80:95], v[164:167], v[48:51], v[80:95]
ds_read_b64_tr_b16 v[188:189], v21 offset:27712
ds_read_b64_tr_b16 v[190:191], v21 offset:28480
buffer_load_dwordx4 v[224:227], v24, s[12:15], s52 offen sc1
s_add_u32 s52, s52, 4608
s_waitcnt lgkmcnt(10)
v_mfma_f32_32x32x16_bf16 v[96:111], v[168:171], v[48:51], v[96:111]
ds_read_b64_tr_b16 v[192:193], v21 offset:27776
ds_read_b64_tr_b16 v[194:195], v21 offset:28544
s_waitcnt lgkmcnt(10)
v_mfma_f32_32x32x16_bf16 v[112:127], v[172:175], v[48:51], v[112:127]
ds_read_b64_tr_b16 v[196:197], v21 offset:33792
ds_read_b64_tr_b16 v[198:199], v21 offset:34560
s_waitcnt lgkmcnt(10)
v_mfma_f32_32x32x16_bf16 v[128:143], v[176:179], v[48:51], v[128:143]
ds_read_b64_tr_b16 v[200:201], v21 offset:33856
ds_read_b64_tr_b16 v[202:203], v21 offset:34624
s_waitcnt lgkmcnt(10)
v_mfma_f32_32x32x16_bf16 v[144:159], v[180:183], v[48:51], v[144:159]
ds_read_b64_tr_b16 v[204:205], v21 offset:33920
ds_read_b64_tr_b16 v[206:207], v21 offset:34688
s_waitcnt vmcnt(7)
s_waitcnt lgkmcnt(10)
v_mfma_f32_32x32x16_bf16 v[64:79], v[184:187], v[52:55], v[64:79]
ds_read_b64_tr_b16 v[160:161], v21 offset:36864
ds_read_b64_tr_b16 v[162:163], v21 offset:37632
s_waitcnt lgkmcnt(10)
v_mfma_f32_32x32x16_bf16 v[80:95], v[188:191], v[52:55], v[80:95]
ds_read_b64_tr_b16 v[164:165], v21 offset:36928
ds_read_b64_tr_b16 v[166:167], v21 offset:37696
buffer_load_dwordx4 v[228:231], v24, s[12:15], s52 offen sc1
s_add_u32 s52, s52, 4608
s_waitcnt lgkmcnt(10)
v_mfma_f32_32x32x16_bf16 v[96:111], v[192:195], v[52:55], v[96:111]
ds_read_b64_tr_b16 v[168:169], v21 offset:36992
ds_read_b64_tr_b16 v[170:171], v21 offset:37760
s_waitcnt lgkmcnt(10)
v_mfma_f32_32x32x16_bf16 v[112:127], v[196:199], v[52:55], v[112:127]
ds_read_b64_tr_b16 v[172:173], v21 offset:43008
ds_read_b64_tr_b16 v[174:175], v21 offset:43776
s_waitcnt lgkmcnt(10)
v_mfma_f32_32x32x16_bf16 v[128:143], v[200:203], v[52:55], v[128:143]
ds_read_b64_tr_b16 v[176:177], v21 offset:43072
ds_read_b64_tr_b16 v[178:179], v21 offset:43840
s_waitcnt lgkmcnt(10)
v_mfma_f32_32x32x16_bf16 v[144:159], v[204:207], v[52:55], v[144:159]
ds_read_b64_tr_b16 v[180:181], v21 offset:43136
ds_read_b64_tr_b16 v[182:183], v21 offset:43904
s_waitcnt vmcnt(7)
s_waitcnt lgkmcnt(10)
v_mfma_f32_32x32x16_bf16 v[64:79], v[160:163], v[56:59], v[64:79]
ds_read_b64_tr_b16 v[184:185], v21 offset:39936
ds_read_b64_tr_b16 v[186:187], v21 offset:40704
s_waitcnt lgkmcnt(10)
v_mfma_f32_32x32x16_bf16 v[80:95], v[164:167], v[56:59], v[80:95]
ds_read_b64_tr_b16 v[188:189], v21 offset:40000
ds_read_b64_tr_b16 v[190:191], v21 offset:40768
buffer_load_dwordx4 v[232:235], v24, s[12:15], s52 offen sc1
s_add_u32 s52, s52, 4608
s_waitcnt lgkmcnt(10)
v_mfma_f32_32x32x16_bf16 v[96:111], v[168:171], v[56:59], v[96:111]
ds_read_b64_tr_b16 v[192:193], v21 offset:40064
ds_read_b64_tr_b16 v[194:195], v21 offset:40832
s_waitcnt lgkmcnt(10)
v_mfma_f32_32x32x16_bf16 v[112:127], v[172:175], v[56:59], v[112:127]
ds_read_b64_tr_b16 v[196:197], v21 offset:46080
ds_read_b64_tr_b16 v[198:199], v21 offset:46848
s_waitcnt lgkmcnt(10)
v_mfma_f32_32x32x16_bf16 v[128:143], v[176:179], v[56:59], v[128:143]
ds_read_b64_tr_b16 v[200:201], v21 offset:46144
ds_read_b64_tr_b16 v[202:203], v21 offset:46912
s_waitcnt lgkmcnt(10)
v_mfma_f32_32x32x16_bf16 v[144:159], v[180:183], v[56:59], v[144:159]
ds_read_b64_tr_b16 v[204:205], v21 offset:46208
ds_read_b64_tr_b16 v[206:207], v21 offset:46976
s_waitcnt lgkmcnt(0)
s_barrier
s_waitcnt vmcnt(7)
v_mfma_f32_32x32x16_bf16 v[64:79], v[184:187], v[60:63], v[64:79]
ds_read_b64_tr_b16 v[160:161], v22 offset:0
ds_read_b64_tr_b16 v[162:163], v22 offset:768
v_mfma_f32_32x32x16_bf16 v[80:95], v[188:191], v[60:63], v[80:95]
ds_read_b64_tr_b16 v[164:165], v22 offset:64
ds_read_b64_tr_b16 v[166:167], v22 offset:832
buffer_load_dwordx4 v[236:239], v24, s[12:15], s52 offen sc1
s_add_u32 s52, s52, 4608
v_mfma_f32_32x32x16_bf16 v[96:111], v[192:195], v[60:63], v[96:111]
ds_read_b64_tr_b16 v[168:169], v22 offset:128
ds_read_b64_tr_b16 v[170:171], v22 offset:896
v_mfma_f32_32x32x16_bf16 v[112:127], v[196:199], v[60:63], v[112:127]
ds_read_b64_tr_b16 v[172:173], v22 offset:6144
ds_read_b64_tr_b16 v[174:175], v22 offset:6912
v_mfma_f32_32x32x16_bf16 v[128:143], v[200:203], v[60:63], v[128:143]
ds_read_b64_tr_b16 v[176:177], v22 offset:6208
ds_read_b64_tr_b16 v[178:179], v22 offset:6976
v_mfma_f32_32x32x16_bf16 v[144:159], v[204:207], v[60:63], v[144:159]
ds_read_b64_tr_b16 v[180:181], v22 offset:6272
ds_read_b64_tr_b16 v[182:183], v22 offset:7040
s_waitcnt vmcnt(7)
s_waitcnt lgkmcnt(10)
v_mfma_f32_32x32x16_bf16 v[64:79], v[160:163], v[208:211], v[64:79]
ds_read_b64_tr_b16 v[184:185], v22 offset:3072
ds_read_b64_tr_b16 v[186:187], v22 offset:3840
s_waitcnt lgkmcnt(10)
v_mfma_f32_32x32x16_bf16 v[80:95], v[164:167], v[208:211], v[80:95]
ds_read_b64_tr_b16 v[188:189], v22 offset:3136
ds_read_b64_tr_b16 v[190:191], v22 offset:3904
buffer_load_dwordx4 v[32:35], v24, s[12:15], s52 offen sc1
s_add_u32 s52, s52, 4608
s_waitcnt lgkmcnt(10)
v_mfma_f32_32x32x16_bf16 v[96:111], v[168:171], v[208:211], v[96:111]
ds_read_b64_tr_b16 v[192:193], v22 offset:3200
ds_read_b64_tr_b16 v[194:195], v22 offset:3968
s_waitcnt lgkmcnt(10)
v_mfma_f32_32x32x16_bf16 v[112:127], v[172:175], v[208:211], v[112:127]
ds_read_b64_tr_b16 v[196:197], v22 offset:9216
ds_read_b64_tr_b16 v[198:199], v22 offset:9984
s_waitcnt lgkmcnt(10)
v_mfma_f32_32x32x16_bf16 v[128:143], v[176:179], v[208:211], v[128:143]
ds_read_b64_tr_b16 v[200:201], v22 offset:9280
ds_read_b64_tr_b16 v[202:203], v22 offset:10048
s_waitcnt lgkmcnt(10)
v_mfma_f32_32x32x16_bf16 v[144:159], v[180:183], v[208:211], v[144:159]
ds_read_b64_tr_b16 v[204:205], v22 offset:9344
ds_read_b64_tr_b16 v[206:207], v22 offset:10112
s_waitcnt vmcnt(7)
s_waitcnt lgkmcnt(10)
v_mfma_f32_32x32x16_bf16 v[64:79], v[184:187], v[212:215], v[64:79]
ds_read_b64_tr_b16 v[160:161], v22 offset:12288
ds_read_b64_tr_b16 v[162:163], v22 offset:13056
s_waitcnt lgkmcnt(10)
v_mfma_f32_32x32x16_bf16 v[80:95], v[188:191], v[212:215], v[80:95]
ds_read_b64_tr_b16 v[164:165], v22 offset:12352
ds_read_b64_tr_b16 v[166:167], v22 offset:13120
buffer_load_dwordx4 v[36:39], v24, s[12:15], s52 offen sc1
s_add_u32 s52, s52, 4608
s_waitcnt lgkmcnt(10)
v_mfma_f32_32x32x16_bf16 v[96:111], v[192:195], v[212:215], v[96:111]
ds_read_b64_tr_b16 v[168:169], v22 offset:12416
ds_read_b64_tr_b16 v[170:171], v22 offset:13184
s_waitcnt lgkmcnt(10)
v_mfma_f32_32x32x16_bf16 v[112:127], v[196:199], v[212:215], v[112:127]
ds_read_b64_tr_b16 v[172:173], v22 offset:18432
ds_read_b64_tr_b16 v[174:175], v22 offset:19200
s_waitcnt lgkmcnt(10)
v_mfma_f32_32x32x16_bf16 v[128:143], v[200:203], v[212:215], v[128:143]
ds_read_b64_tr_b16 v[176:177], v22 offset:18496
ds_read_b64_tr_b16 v[178:179], v22 offset:19264
s_waitcnt lgkmcnt(10)
v_mfma_f32_32x32x16_bf16 v[144:159], v[204:207], v[212:215], v[144:159]
ds_read_b64_tr_b16 v[180:181], v22 offset:18560
ds_read_b64_tr_b16 v[182:183], v22 offset:19328
s_waitcnt vmcnt(7)
s_waitcnt lgkmcnt(10)
v_mfma_f32_32x32x16_bf16 v[64:79], v[160:163], v[216:219], v[64:79]
ds_read_b64_tr_b16 v[184:185], v22 offset:15360
ds_read_b64_tr_b16 v[186:187], v22 offset:16128
s_waitcnt lgkmcnt(10)
v_mfma_f32_32x32x16_bf16 v[80:95], v[164:167], v[216:219], v[80:95]
ds_read_b64_tr_b16 v[188:189], v22 offset:15424
ds_read_b64_tr_b16 v[190:191], v22 offset:16192
buffer_load_dwordx4 v[40:43], v24, s[12:15], s52 offen sc1
s_add_u32 s52, s52, 4608
s_waitcnt lgkmcnt(10)
v_mfma_f32_32x32x16_bf16 v[96:111], v[168:171], v[216:219], v[96:111]
ds_read_b64_tr_b16 v[192:193], v22 offset:15488
ds_read_b64_tr_b16 v[194:195], v22 offset:16256
s_waitcnt lgkmcnt(10)
v_mfma_f32_32x32x16_bf16 v[112:127], v[172:175], v[216:219], v[112:127]
ds_read_b64_tr_b16 v[196:197], v22 offset:21504
ds_read_b64_tr_b16 v[198:199], v22 offset:22272
s_waitcnt lgkmcnt(10)
v_mfma_f32_32x32x16_bf16 v[128:143], v[176:179], v[216:219], v[128:143]
ds_read_b64_tr_b16 v[200:201], v22 offset:21568
ds_read_b64_tr_b16 v[202:203], v22 offset:22336
s_waitcnt lgkmcnt(10)
v_mfma_f32_32x32x16_bf16 v[144:159], v[180:183], v[216:219], v[144:159]
ds_read_b64_tr_b16 v[204:205], v22 offset:21632
ds_read_b64_tr_b16 v[206:207], v22 offset:22400
s_waitcnt lgkmcnt(0)
s_barrier
s_waitcnt vmcnt(7)
v_mfma_f32_32x32x16_bf16 v[64:79], v[184:187], v[220:223], v[64:79]
ds_read_b64_tr_b16 v[160:161], v22 offset:24576
ds_read_b64_tr_b16 v[162:163], v22 offset:25344
v_mfma_f32_32x32x16_bf16 v[80:95], v[188:191], v[220:223], v[80:95]
ds_read_b64_tr_b16 v[164:165], v22 offset:24640
ds_read_b64_tr_b16 v[166:167], v22 offset:25408
buffer_load_dwordx4 v[44:47], v24, s[12:15], s52 offen sc1
s_add_u32 s52, s52, 4608
v_mfma_f32_32x32x16_bf16 v[96:111], v[192:195], v[220:223], v[96:111]
ds_read_b64_tr_b16 v[168:169], v22 offset:24704
ds_read_b64_tr_b16 v[170:171], v22 offset:25472
v_mfma_f32_32x32x16_bf16 v[112:127], v[196:199], v[220:223], v[112:127]
ds_read_b64_tr_b16 v[172:173], v22 offset:30720
ds_read_b64_tr_b16 v[174:175], v22 offset:31488
v_mfma_f32_32x32x16_bf16 v[128:143], v[200:203], v[220:223], v[128:143]
ds_read_b64_tr_b16 v[176:177], v22 offset:30784
ds_read_b64_tr_b16 v[178:179], v22 offset:31552
v_mfma_f32_32x32x16_bf16 v[144:159], v[204:207], v[220:223], v[144:159]
ds_read_b64_tr_b16 v[180:181], v22 offset:30848
ds_read_b64_tr_b16 v[182:183], v22 offset:31616
s_waitcnt vmcnt(7)
s_waitcnt lgkmcnt(10)
v_mfma_f32_32x32x16_bf16 v[64:79], v[160:163], v[224:227], v[64:79]
ds_read_b64_tr_b16 v[184:185], v22 offset:27648
ds_read_b64_tr_b16 v[186:187], v22 offset:28416
s_waitcnt lgkmcnt(10)
v_mfma_f32_32x32x16_bf16 v[80:95], v[164:167], v[224:227], v[80:95]
ds_read_b64_tr_b16 v[188:189], v22 offset:27712
ds_read_b64_tr_b16 v[190:191], v22 offset:28480
buffer_load_dwordx4 v[48:51], v24, s[12:15], s52 offen sc1
s_add_u32 s52, s52, 4608
s_waitcnt lgkmcnt(10)
v_mfma_f32_32x32x16_bf16 v[96:111], v[168:171], v[224:227], v[96:111]
ds_read_b64_tr_b16 v[192:193], v22 offset:27776
ds_read_b64_tr_b16 v[194:195], v22 offset:28544
s_waitcnt lgkmcnt(10)
v_mfma_f32_32x32x16_bf16 v[112:127], v[172:175], v[224:227], v[112:127]
ds_read_b64_tr_b16 v[196:197], v22 offset:33792
ds_read_b64_tr_b16 v[198:199], v22 offset:34560
s_waitcnt lgkmcnt(10)
v_mfma_f32_32x32x16_bf16 v[128:143], v[176:179], v[224:227], v[128:143]
ds_read_b64_tr_b16 v[200:201], v22 offset:33856
ds_read_b64_tr_b16 v[202:203], v22 offset:34624
s_waitcnt lgkmcnt(10)
v_mfma_f32_32x32x16_bf16 v[144:159], v[180:183], v[224:227], v[144:159]
ds_read_b64_tr_b16 v[204:205], v22 offset:33920
ds_read_b64_tr_b16 v[206:207], v22 offset:34688
s_waitcnt vmcnt(7)
s_waitcnt lgkmcnt(10)
v_mfma_f32_32x32x16_bf16 v[64:79], v[184:187], v[228:231], v[64:79]
ds_read_b64_tr_b16 v[160:161], v22 offset:36864
ds_read_b64_tr_b16 v[162:163], v22 offset:37632
s_waitcnt lgkmcnt(10)
v_mfma_f32_32x32x16_bf16 v[80:95], v[188:191], v[228:231], v[80:95]
ds_read_b64_tr_b16 v[164:165], v22 offset:36928
ds_read_b64_tr_b16 v[166:167], v22 offset:37696
buffer_load_dwordx4 v[52:55], v24, s[12:15], s52 offen sc1
s_add_u32 s52, s52, 4608
s_waitcnt lgkmcnt(10)
v_mfma_f32_32x32x16_bf16 v[96:111], v[192:195], v[228:231], v[96:111]
ds_read_b64_tr_b16 v[168:169], v22 offset:36992
ds_read_b64_tr_b16 v[170:171], v22 offset:37760
s_waitcnt lgkmcnt(10)
v_mfma_f32_32x32x16_bf16 v[112:127], v[196:199], v[228:231], v[112:127]
ds_read_b64_tr_b16 v[172:173], v22 offset:43008
ds_read_b64_tr_b16 v[174:175], v22 offset:43776
s_waitcnt lgkmcnt(10)
v_mfma_f32_32x32x16_bf16 v[128:143], v[200:203], v[228:231], v[128:143]
ds_read_b64_tr_b16 v[176:177], v22 offset:43072
ds_read_b64_tr_b16 v[178:179], v22 offset:43840
s_waitcnt lgkmcnt(10)
v_mfma_f32_32x32x16_bf16 v[144:159], v[204:207], v[228:231], v[144:159]
ds_read_b64_tr_b16 v[180:181], v22 offset:43136
ds_read_b64_tr_b16 v[182:183], v22 offset:43904
s_waitcnt vmcnt(7)
s_waitcnt lgkmcnt(10)
v_mfma_f32_32x32x16_bf16 v[64:79], v[160:163], v[232:235], v[64:79]
ds_read_b64_tr_b16 v[184:185], v22 offset:39936
ds_read_b64_tr_b16 v[186:187], v22 offset:40704
s_waitcnt lgkmcnt(10)
v_mfma_f32_32x32x16_bf16 v[80:95], v[164:167], v[232:235], v[80:95]
ds_read_b64_tr_b16 v[188:189], v22 offset:40000
ds_read_b64_tr_b16 v[190:191], v22 offset:40768
buffer_load_dwordx4 v[56:59], v24, s[12:15], s52 offen sc1
s_add_u32 s52, s52, 4608
s_waitcnt lgkmcnt(10)
v_mfma_f32_32x32x16_bf16 v[96:111], v[168:171], v[232:235], v[96:111]
ds_read_b64_tr_b16 v[192:193], v22 offset:40064
ds_read_b64_tr_b16 v[194:195], v22 offset:40832
s_waitcnt lgkmcnt(10)
v_mfma_f32_32x32x16_bf16 v[112:127], v[172:175], v[232:235], v[112:127]
ds_read_b64_tr_b16 v[196:197], v22 offset:46080
ds_read_b64_tr_b16 v[198:199], v22 offset:46848
s_waitcnt lgkmcnt(10)
v_mfma_f32_32x32x16_bf16 v[128:143], v[176:179], v[232:235], v[128:143]
ds_read_b64_tr_b16 v[200:201], v22 offset:46144
ds_read_b64_tr_b16 v[202:203], v22 offset:46912
s_waitcnt lgkmcnt(10)
v_mfma_f32_32x32x16_bf16 v[144:159], v[180:183], v[232:235], v[144:159]
ds_read_b64_tr_b16 v[204:205], v22 offset:46208
ds_read_b64_tr_b16 v[206:207], v22 offset:46976
s_waitcnt lgkmcnt(0)
s_barrier
s_waitcnt vmcnt(7)
v_mfma_f32_32x32x16_bf16 v[64:79], v[184:187], v[236:239], v[64:79]
ds_read_b64_tr_b16 v[160:161], v20 offset:0
ds_read_b64_tr_b16 v[162:163], v20 offset:768
v_mfma_f32_32x32x16_bf16 v[80:95], v[188:191], v[236:239], v[80:95]
ds_read_b64_tr_b16 v[164:165], v20 offset:64
ds_read_b64_tr_b16 v[166:167], v20 offset:832
buffer_load_dwordx4 v[60:63], v24, s[12:15], s52 offen sc1
s_add_u32 s52, s52, 4608
v_mfma_f32_32x32x16_bf16 v[96:111], v[192:195], v[236:239], v[96:111]
ds_read_b64_tr_b16 v[168:169], v20 offset:128
ds_read_b64_tr_b16 v[170:171], v20 offset:896
v_mfma_f32_32x32x16_bf16 v[112:127], v[196:199], v[236:239], v[112:127]
ds_read_b64_tr_b16 v[172:173], v20 offset:6144
ds_read_b64_tr_b16 v[174:175], v20 offset:6912
v_mfma_f32_32x32x16_bf16 v[128:143], v[200:203], v[236:239], v[128:143]
ds_read_b64_tr_b16 v[176:177], v20 offset:6208
ds_read_b64_tr_b16 v[178:179], v20 offset:6976
v_mfma_f32_32x32x16_bf16 v[144:159], v[204:207], v[236:239], v[144:159]
ds_read_b64_tr_b16 v[180:181], v20 offset:6272
ds_read_b64_tr_b16 v[182:183], v20 offset:7040
s_waitcnt vmcnt(7)
s_waitcnt lgkmcnt(10)
v_mfma_f32_32x32x16_bf16 v[64:79], v[160:163], v[32:35], v[64:79]
ds_read_b64_tr_b16 v[184:185], v20 offset:3072
ds_read_b64_tr_b16 v[186:187], v20 offset:3840
s_waitcnt lgkmcnt(10)
v_mfma_f32_32x32x16_bf16 v[80:95], v[164:167], v[32:35], v[80:95]
ds_read_b64_tr_b16 v[188:189], v20 offset:3136
ds_read_b64_tr_b16 v[190:191], v20 offset:3904
buffer_load_dwordx4 v[208:211], v24, s[12:15], s52 offen sc1
s_add_u32 s52, s52, 4608
s_waitcnt lgkmcnt(10)
v_mfma_f32_32x32x16_bf16 v[96:111], v[168:171], v[32:35], v[96:111]
ds_read_b64_tr_b16 v[192:193], v20 offset:3200
ds_read_b64_tr_b16 v[194:195], v20 offset:3968
s_waitcnt lgkmcnt(10)
v_mfma_f32_32x32x16_bf16 v[112:127], v[172:175], v[32:35], v[112:127]
ds_read_b64_tr_b16 v[196:197], v20 offset:9216
ds_read_b64_tr_b16 v[198:199], v20 offset:9984
s_waitcnt lgkmcnt(10)
v_mfma_f32_32x32x16_bf16 v[128:143], v[176:179], v[32:35], v[128:143]
ds_read_b64_tr_b16 v[200:201], v20 offset:9280
ds_read_b64_tr_b16 v[202:203], v20 offset:10048
s_waitcnt lgkmcnt(10)
v_mfma_f32_32x32x16_bf16 v[144:159], v[180:183], v[32:35], v[144:159]
ds_read_b64_tr_b16 v[204:205], v20 offset:9344
ds_read_b64_tr_b16 v[206:207], v20 offset:10112
s_waitcnt vmcnt(7)
s_waitcnt lgkmcnt(10)
v_mfma_f32_32x32x16_bf16 v[64:79], v[184:187], v[36:39], v[64:79]
ds_read_b64_tr_b16 v[160:161], v20 offset:12288
ds_read_b64_tr_b16 v[162:163], v20 offset:13056
s_waitcnt lgkmcnt(10)
v_mfma_f32_32x32x16_bf16 v[80:95], v[188:191], v[36:39], v[80:95]
ds_read_b64_tr_b16 v[164:165], v20 offset:12352
ds_read_b64_tr_b16 v[166:167], v20 offset:13120
buffer_load_dwordx4 v[212:215], v24, s[12:15], s52 offen sc1
s_add_u32 s52, s52, 4608
s_waitcnt lgkmcnt(10)
v_mfma_f32_32x32x16_bf16 v[96:111], v[192:195], v[36:39], v[96:111]
ds_read_b64_tr_b16 v[168:169], v20 offset:12416
ds_read_b64_tr_b16 v[170:171], v20 offset:13184
s_waitcnt lgkmcnt(10)
v_mfma_f32_32x32x16_bf16 v[112:127], v[196:199], v[36:39], v[112:127]
ds_read_b64_tr_b16 v[172:173], v20 offset:18432
ds_read_b64_tr_b16 v[174:175], v20 offset:19200
s_waitcnt lgkmcnt(10)
v_mfma_f32_32x32x16_bf16 v[128:143], v[200:203], v[36:39], v[128:143]
ds_read_b64_tr_b16 v[176:177], v20 offset:18496
ds_read_b64_tr_b16 v[178:179], v20 offset:19264
s_waitcnt lgkmcnt(10)
v_mfma_f32_32x32x16_bf16 v[144:159], v[204:207], v[36:39], v[144:159]
ds_read_b64_tr_b16 v[180:181], v20 offset:18560
ds_read_b64_tr_b16 v[182:183], v20 offset:19328
s_waitcnt vmcnt(7)
s_waitcnt lgkmcnt(10)
v_mfma_f32_32x32x16_bf16 v[64:79], v[160:163], v[40:43], v[64:79]
ds_read_b64_tr_b16 v[184:185], v20 offset:15360
ds_read_b64_tr_b16 v[186:187], v20 offset:16128
s_waitcnt lgkmcnt(10)
v_mfma_f32_32x32x16_bf16 v[80:95], v[164:167], v[40:43], v[80:95]
ds_read_b64_tr_b16 v[188:189], v20 offset:15424
ds_read_b64_tr_b16 v[190:191], v20 offset:16192
buffer_load_dwordx4 v[216:219], v24, s[12:15], s52 offen sc1
s_add_u32 s52, s52, 4608
s_waitcnt lgkmcnt(10)
v_mfma_f32_32x32x16_bf16 v[96:111], v[168:171], v[40:43], v[96:111]
ds_read_b64_tr_b16 v[192:193], v20 offset:15488
ds_read_b64_tr_b16 v[194:195], v20 offset:16256
s_waitcnt lgkmcnt(10)
v_mfma_f32_32x32x16_bf16 v[112:127], v[172:175], v[40:43], v[112:127]
ds_read_b64_tr_b16 v[196:197], v20 offset:21504
ds_read_b64_tr_b16 v[198:199], v20 offset:22272
s_waitcnt lgkmcnt(10)
v_mfma_f32_32x32x16_bf16 v[128:143], v[176:179], v[40:43], v[128:143]
ds_read_b64_tr_b16 v[200:201], v20 offset:21568
ds_read_b64_tr_b16 v[202:203], v20 offset:22336
s_waitcnt lgkmcnt(10)
v_mfma_f32_32x32x16_bf16 v[144:159], v[180:183], v[40:43], v[144:159]
ds_read_b64_tr_b16 v[204:205], v20 offset:21632
ds_read_b64_tr_b16 v[206:207], v20 offset:22400
s_waitcnt lgkmcnt(0)
s_barrier
s_waitcnt vmcnt(7)
v_mfma_f32_32x32x16_bf16 v[64:79], v[184:187], v[44:47], v[64:79]
ds_read_b64_tr_b16 v[160:161], v20 offset:24576
ds_read_b64_tr_b16 v[162:163], v20 offset:25344
v_mfma_f32_32x32x16_bf16 v[80:95], v[188:191], v[44:47], v[80:95]
ds_read_b64_tr_b16 v[164:165], v20 offset:24640
ds_read_b64_tr_b16 v[166:167], v20 offset:25408
buffer_load_dwordx4 v[220:223], v24, s[12:15], s52 offen sc1
s_add_u32 s52, s52, 4608
v_mfma_f32_32x32x16_bf16 v[96:111], v[192:195], v[44:47], v[96:111]
ds_read_b64_tr_b16 v[168:169], v20 offset:24704
ds_read_b64_tr_b16 v[170:171], v20 offset:25472
v_mfma_f32_32x32x16_bf16 v[112:127], v[196:199], v[44:47], v[112:127]
ds_read_b64_tr_b16 v[172:173], v20 offset:30720
ds_read_b64_tr_b16 v[174:175], v20 offset:31488
v_mfma_f32_32x32x16_bf16 v[128:143], v[200:203], v[44:47], v[128:143]
ds_read_b64_tr_b16 v[176:177], v20 offset:30784
ds_read_b64_tr_b16 v[178:179], v20 offset:31552
v_mfma_f32_32x32x16_bf16 v[144:159], v[204:207], v[44:47], v[144:159]
ds_read_b64_tr_b16 v[180:181], v20 offset:30848
ds_read_b64_tr_b16 v[182:183], v20 offset:31616
s_waitcnt vmcnt(7)
s_waitcnt lgkmcnt(10)
v_mfma_f32_32x32x16_bf16 v[64:79], v[160:163], v[48:51], v[64:79]
ds_read_b64_tr_b16 v[184:185], v20 offset:27648
ds_read_b64_tr_b16 v[186:187], v20 offset:28416
s_waitcnt lgkmcnt(10)
v_mfma_f32_32x32x16_bf16 v[80:95], v[164:167], v[48:51], v[80:95]
ds_read_b64_tr_b16 v[188:189], v20 offset:27712
ds_read_b64_tr_b16 v[190:191], v20 offset:28480
buffer_load_dwordx4 v[224:227], v24, s[12:15], s52 offen sc1
s_add_u32 s52, s52, 4608
s_waitcnt lgkmcnt(10)
v_mfma_f32_32x32x16_bf16 v[96:111], v[168:171], v[48:51], v[96:111]
ds_read_b64_tr_b16 v[192:193], v20 offset:27776
ds_read_b64_tr_b16 v[194:195], v20 offset:28544
s_waitcnt lgkmcnt(10)
v_mfma_f32_32x32x16_bf16 v[112:127], v[172:175], v[48:51], v[112:127]
ds_read_b64_tr_b16 v[196:197], v20 offset:33792
ds_read_b64_tr_b16 v[198:199], v20 offset:34560
s_waitcnt lgkmcnt(10)
v_mfma_f32_32x32x16_bf16 v[128:143], v[176:179], v[48:51], v[128:143]
ds_read_b64_tr_b16 v[200:201], v20 offset:33856
ds_read_b64_tr_b16 v[202:203], v20 offset:34624
s_waitcnt lgkmcnt(10)
v_mfma_f32_32x32x16_bf16 v[144:159], v[180:183], v[48:51], v[144:159]
ds_read_b64_tr_b16 v[204:205], v20 offset:33920
ds_read_b64_tr_b16 v[206:207], v20 offset:34688
s_waitcnt vmcnt(7)
s_waitcnt lgkmcnt(10)
v_mfma_f32_32x32x16_bf16 v[64:79], v[184:187], v[52:55], v[64:79]
ds_read_b64_tr_b16 v[160:161], v20 offset:36864
ds_read_b64_tr_b16 v[162:163], v20 offset:37632
s_waitcnt lgkmcnt(10)
v_mfma_f32_32x32x16_bf16 v[80:95], v[188:191], v[52:55], v[80:95]
ds_read_b64_tr_b16 v[164:165], v20 offset:36928
ds_read_b64_tr_b16 v[166:167], v20 offset:37696
buffer_load_dwordx4 v[228:231], v24, s[12:15], s52 offen sc1
s_add_u32 s52, s52, 4608
s_waitcnt lgkmcnt(10)
v_mfma_f32_32x32x16_bf16 v[96:111], v[192:195], v[52:55], v[96:111]
ds_read_b64_tr_b16 v[168:169], v20 offset:36992
ds_read_b64_tr_b16 v[170:171], v20 offset:37760
s_waitcnt lgkmcnt(10)
v_mfma_f32_32x32x16_bf16 v[112:127], v[196:199], v[52:55], v[112:127]
ds_read_b64_tr_b16 v[172:173], v20 offset:43008
ds_read_b64_tr_b16 v[174:175], v20 offset:43776
s_waitcnt lgkmcnt(10)
v_mfma_f32_32x32x16_bf16 v[128:143], v[200:203], v[52:55], v[128:143]
ds_read_b64_tr_b16 v[176:177], v20 offset:43072
ds_read_b64_tr_b16 v[178:179], v20 offset:43840
s_waitcnt lgkmcnt(10)
v_mfma_f32_32x32x16_bf16 v[144:159], v[204:207], v[52:55], v[144:159]
ds_read_b64_tr_b16 v[180:181], v20 offset:43136
ds_read_b64_tr_b16 v[182:183], v20 offset:43904
s_waitcnt vmcnt(7)
s_waitcnt lgkmcnt(10)
v_mfma_f32_32x32x16_bf16 v[64:79], v[160:163], v[56:59], v[64:79]
ds_read_b64_tr_b16 v[184:185], v20 offset:39936
ds_read_b64_tr_b16 v[186:187], v20 offset:40704
s_waitcnt lgkmcnt(10)
v_mfma_f32_32x32x16_bf16 v[80:95], v[164:167], v[56:59], v[80:95]
ds_read_b64_tr_b16 v[188:189], v20 offset:40000
ds_read_b64_tr_b16 v[190:191], v20 offset:40768
buffer_load_dwordx4 v[232:235], v24, s[12:15], s52 offen sc1
s_add_u32 s52, s52, 4608
s_waitcnt lgkmcnt(10)
v_mfma_f32_32x32x16_bf16 v[96:111], v[168:171], v[56:59], v[96:111]
ds_read_b64_tr_b16 v[192:193], v20 offset:40064
ds_read_b64_tr_b16 v[194:195], v20 offset:40832
s_waitcnt lgkmcnt(10)
v_mfma_f32_32x32x16_bf16 v[112:127], v[172:175], v[56:59], v[112:127]
ds_read_b64_tr_b16 v[196:197], v20 offset:46080
ds_read_b64_tr_b16 v[198:199], v20 offset:46848
s_waitcnt lgkmcnt(10)
v_mfma_f32_32x32x16_bf16 v[128:143], v[176:179], v[56:59], v[128:143]
ds_read_b64_tr_b16 v[200:201], v20 offset:46144
ds_read_b64_tr_b16 v[202:203], v20 offset:46912
s_waitcnt lgkmcnt(10)
v_mfma_f32_32x32x16_bf16 v[144:159], v[180:183], v[56:59], v[144:159]
ds_read_b64_tr_b16 v[204:205], v20 offset:46208
ds_read_b64_tr_b16 v[206:207], v20 offset:46976
s_waitcnt lgkmcnt(0)
s_barrier
s_waitcnt vmcnt(7)
v_mfma_f32_32x32x16_bf16 v[64:79], v[184:187], v[60:63], v[64:79]
ds_read_b64_tr_b16 v[160:161], v21 offset:0
ds_read_b64_tr_b16 v[162:163], v21 offset:768
v_mfma_f32_32x32x16_bf16 v[80:95], v[188:191], v[60:63], v[80:95]
ds_read_b64_tr_b16 v[164:165], v21 offset:64
ds_read_b64_tr_b16 v[166:167], v21 offset:832
buffer_load_dwordx4 v[236:239], v24, s[12:15], s52 offen sc1
v_mfma_f32_32x32x16_bf16 v[96:111], v[192:195], v[60:63], v[96:111]
ds_read_b64_tr_b16 v[168:169], v21 offset:128
ds_read_b64_tr_b16 v[170:171], v21 offset:896
v_mfma_f32_32x32x16_bf16 v[112:127], v[196:199], v[60:63], v[112:127]
ds_read_b64_tr_b16 v[172:173], v21 offset:6144
ds_read_b64_tr_b16 v[174:175], v21 offset:6912
v_mfma_f32_32x32x16_bf16 v[128:143], v[200:203], v[60:63], v[128:143]
ds_read_b64_tr_b16 v[176:177], v21 offset:6208
ds_read_b64_tr_b16 v[178:179], v21 offset:6976
v_mfma_f32_32x32x16_bf16 v[144:159], v[204:207], v[60:63], v[144:159]
ds_read_b64_tr_b16 v[180:181], v21 offset:6272
ds_read_b64_tr_b16 v[182:183], v21 offset:7040
s_waitcnt vmcnt(7)
s_waitcnt lgkmcnt(10)
v_mfma_f32_32x32x16_bf16 v[64:79], v[160:163], v[208:211], v[64:79]
v_add_f32 v28, v28, v29
ds_read_b64_tr_b16 v[184:185], v21 offset:3072
ds_read_b64_tr_b16 v[186:187], v21 offset:3840
v_add_f32 v30, v30, v31
s_waitcnt lgkmcnt(10)
v_mfma_f32_32x32x16_bf16 v[80:95], v[164:167], v[208:211], v[80:95]
v_add_f32 v28, v28, v30
ds_read_b64_tr_b16 v[188:189], v21 offset:3136
ds_read_b64_tr_b16 v[190:191], v21 offset:3904
v_mov_b32 v29, v28
s_waitcnt lgkmcnt(10)
v_mfma_f32_32x32x16_bf16 v[96:111], v[168:171], v[208:211], v[96:111]
v_mov_b32 v4, 1.0
ds_read_b64_tr_b16 v[192:193], v21 offset:3200
ds_read_b64_tr_b16 v[194:195], v21 offset:3968
v_mov_b32 v5, 1.0
s_waitcnt lgkmcnt(10)
v_mfma_f32_32x32x16_bf16 v[112:127], v[172:175], v[208:211], v[112:127]
ds_read_b64_tr_b16 v[196:197], v21 offset:9216
ds_read_b64_tr_b16 v[198:199], v21 offset:9984
s_waitcnt lgkmcnt(10)
v_mfma_f32_32x32x16_bf16 v[128:143], v[176:179], v[208:211], v[128:143]
ds_read_b64_tr_b16 v[200:201], v21 offset:9280
ds_read_b64_tr_b16 v[202:203], v21 offset:10048
s_waitcnt lgkmcnt(10)
v_mfma_f32_32x32x16_bf16 v[144:159], v[180:183], v[208:211], v[144:159]
ds_read_b64_tr_b16 v[204:205], v21 offset:9344
ds_read_b64_tr_b16 v[206:207], v21 offset:10112
s_waitcnt vmcnt(6)
s_waitcnt lgkmcnt(10)
v_mfma_f32_32x32x16_bf16 v[64:79], v[184:187], v[212:215], v[64:79]
v_permlane32_swap_b32 v28, v29
ds_read_b64_tr_b16 v[160:161], v21 offset:12288
ds_read_b64_tr_b16 v[162:163], v21 offset:13056
s_mul_i32 s66, s36, 630784
s_waitcnt lgkmcnt(10)
v_mfma_f32_32x32x16_bf16 v[80:95], v[188:191], v[212:215], v[80:95]
s_mul_i32 s53, s37, 27648
ds_read_b64_tr_b16 v[164:165], v21 offset:12352
ds_read_b64_tr_b16 v[166:167], v21 offset:13120
v_add_f32 v28, v28, v29
s_waitcnt lgkmcnt(10)
v_mfma_f32_32x32x16_bf16 v[96:111], v[192:195], v[212:215], v[96:111]
v_mul_f32 v28, 0x3acccccd, v28
ds_read_b64_tr_b16 v[168:169], v21 offset:12416
ds_read_b64_tr_b16 v[170:171], v21 offset:13184
v_add_f32 v28, 0x3727c5ac, v28
s_waitcnt lgkmcnt(10)
v_mfma_f32_32x32x16_bf16 v[112:127], v[196:199], v[212:215], v[112:127]
ds_read_b64_tr_b16 v[172:173], v21 offset:18432
ds_read_b64_tr_b16 v[174:175], v21 offset:19200
s_waitcnt lgkmcnt(10)
v_mfma_f32_32x32x16_bf16 v[128:143], v[200:203], v[212:215], v[128:143]
ds_read_b64_tr_b16 v[176:177], v21 offset:18496
ds_read_b64_tr_b16 v[178:179], v21 offset:19264
s_waitcnt lgkmcnt(10)
v_mfma_f32_32x32x16_bf16 v[144:159], v[204:207], v[212:215], v[144:159]
ds_read_b64_tr_b16 v[180:181], v21 offset:18560
ds_read_b64_tr_b16 v[182:183], v21 offset:19328
s_waitcnt vmcnt(5)
s_waitcnt lgkmcnt(10)
v_mfma_f32_32x32x16_bf16 v[64:79], v[160:163], v[216:219], v[64:79]
v_rsq_f32 v28, v28
ds_read_b64_tr_b16 v[184:185], v21 offset:15360
ds_read_b64_tr_b16 v[186:187], v21 offset:16128
s_add_u32 s66, s66, s53
s_waitcnt lgkmcnt(10)
v_mfma_f32_32x32x16_bf16 v[80:95], v[164:167], v[216:219], v[80:95]
s_add_u32 s66, s66, 1048832
ds_read_b64_tr_b16 v[188:189], v21 offset:15424
ds_read_b64_tr_b16 v[190:191], v21 offset:16192
v_mul_f32 v27, 0xbfb8aa3b, v28
s_waitcnt lgkmcnt(10)
v_mfma_f32_32x32x16_bf16 v[96:111], v[168:171], v[216:219], v[96:111]
s_mul_i32 s45, s37, 12
ds_read_b64_tr_b16 v[192:193], v21 offset:15488
ds_read_b64_tr_b16 v[194:195], v21 offset:16256
s_add_u32 s44, s45, 0
s_waitcnt lgkmcnt(10)
v_mfma_f32_32x32x16_bf16 v[112:127], v[172:175], v[216:219], v[112:127]
ds_read_b64_tr_b16 v[196:197], v21 offset:21504
ds_read_b64_tr_b16 v[198:199], v21 offset:22272
s_waitcnt lgkmcnt(10)
v_mfma_f32_32x32x16_bf16 v[128:143], v[176:179], v[216:219], v[128:143]
ds_read_b64_tr_b16 v[200:201], v21 offset:21568
ds_read_b64_tr_b16 v[202:203], v21 offset:22336
s_waitcnt lgkmcnt(10)
v_mfma_f32_32x32x16_bf16 v[144:159], v[180:183], v[216:219], v[144:159]
ds_read_b64_tr_b16 v[204:205], v21 offset:21632
ds_read_b64_tr_b16 v[206:207], v21 offset:22400
s_waitcnt lgkmcnt(0)
s_barrier
s_waitcnt vmcnt(4)
v_mfma_f32_32x32x16_bf16 v[64:79], v[184:187], v[220:223], v[64:79]
s_cmp_ge_u32 s44, 80
s_cselect_b32 s44, 184320, 0
ds_read_b64_tr_b16 v[160:161], v21 offset:24576
ds_read_b64_tr_b16 v[162:163], v21 offset:25344
s_add_u32 s54, s66, 0
v_mfma_f32_32x32x16_bf16 v[80:95], v[188:191], v[220:223], v[80:95]
s_add_u32 s54, s54, s44
ds_read_b64_tr_b16 v[164:165], v21 offset:24640
ds_read_b64_tr_b16 v[166:167], v21 offset:25408
s_add_u32 s44, s45, 2
v_mfma_f32_32x32x16_bf16 v[96:111], v[192:195], v[220:223], v[96:111]
s_cmp_ge_u32 s44, 80
s_cselect_b32 s44, 184320, 0
ds_read_b64_tr_b16 v[168:169], v21 offset:24704
ds_read_b64_tr_b16 v[170:171], v21 offset:25472
s_add_u32 s55, s66, 4608
v_mfma_f32_32x32x16_bf16 v[112:127], v[196:199], v[220:223], v[112:127]
ds_read_b64_tr_b16 v[172:173], v21 offset:30720
ds_read_b64_tr_b16 v[174:175], v21 offset:31488
v_mfma_f32_32x32x16_bf16 v[128:143], v[200:203], v[220:223], v[128:143]
ds_read_b64_tr_b16 v[176:177], v21 offset:30784
ds_read_b64_tr_b16 v[178:179], v21 offset:31552
v_mfma_f32_32x32x16_bf16 v[144:159], v[204:207], v[220:223], v[144:159]
ds_read_b64_tr_b16 v[180:181], v21 offset:30848
ds_read_b64_tr_b16 v[182:183], v21 offset:31616
s_waitcnt vmcnt(3)
s_waitcnt lgkmcnt(10)
v_mfma_f32_32x32x16_bf16 v[64:79], v[160:163], v[224:227], v[64:79]
s_add_u32 s55, s55, s44
ds_read_b64_tr_b16 v[184:185], v21 offset:27648
ds_read_b64_tr_b16 v[186:187], v21 offset:28416
s_add_u32 s44, s45, 4
s_waitcnt lgkmcnt(10)
v_mfma_f32_32x32x16_bf16 v[80:95], v[164:167], v[224:227], v[80:95]
s_cmp_ge_u32 s44, 80
s_cselect_b32 s44, 184320, 0
ds_read_b64_tr_b16 v[188:189], v21 offset:27712
ds_read_b64_tr_b16 v[190:191], v21 offset:28480
s_add_u32 s56, s66, 9216
s_waitcnt lgkmcnt(10)
v_mfma_f32_32x32x16_bf16 v[96:111], v[168:171], v[224:227], v[96:111]
s_add_u32 s56, s56, s44
ds_read_b64_tr_b16 v[192:193], v21 offset:27776
ds_read_b64_tr_b16 v[194:195], v21 offset:28544
s_add_u32 s44, s45, 6
s_waitcnt lgkmcnt(10)
v_mfma_f32_32x32x16_bf16 v[112:127], v[172:175], v[224:227], v[112:127]
ds_read_b64_tr_b16 v[196:197], v21 offset:33792
ds_read_b64_tr_b16 v[198:199], v21 offset:34560
s_waitcnt lgkmcnt(10)
v_mfma_f32_32x32x16_bf16 v[128:143], v[176:179], v[224:227], v[128:143]
ds_read_b64_tr_b16 v[200:201], v21 offset:33856
ds_read_b64_tr_b16 v[202:203], v21 offset:34624
s_waitcnt lgkmcnt(10)
v_mfma_f32_32x32x16_bf16 v[144:159], v[180:183], v[224:227], v[144:159]
ds_read_b64_tr_b16 v[204:205], v21 offset:33920
ds_read_b64_tr_b16 v[206:207], v21 offset:34688
s_waitcnt vmcnt(2)
s_waitcnt lgkmcnt(10)
v_mfma_f32_32x32x16_bf16 v[64:79], v[184:187], v[228:231], v[64:79]
s_cmp_ge_u32 s44, 80
s_cselect_b32 s44, 184320, 0
ds_read_b64_tr_b16 v[160:161], v21 offset:36864
ds_read_b64_tr_b16 v[162:163], v21 offset:37632
s_add_u32 s57, s66, 13824
s_waitcnt lgkmcnt(10)
v_mfma_f32_32x32x16_bf16 v[80:95], v[188:191], v[228:231], v[80:95]
s_add_u32 s57, s57, s44
ds_read_b64_tr_b16 v[164:165], v21 offset:36928
ds_read_b64_tr_b16 v[166:167], v21 offset:37696
s_add_u32 s44, s45, 8
s_waitcnt lgkmcnt(10)
v_mfma_f32_32x32x16_bf16 v[96:111], v[192:195], v[228:231], v[96:111]
s_cmp_ge_u32 s44, 80
s_cselect_b32 s44, 184320, 0
ds_read_b64_tr_b16 v[168:169], v21 offset:36992
ds_read_b64_tr_b16 v[170:171], v21 offset:37760
s_add_u32 s58, s66, 18432
s_waitcnt lgkmcnt(10)
v_mfma_f32_32x32x16_bf16 v[112:127], v[196:199], v[228:231], v[112:127]
ds_read_b64_tr_b16 v[172:173], v21 offset:43008
ds_read_b64_tr_b16 v[174:175], v21 offset:43776
s_waitcnt lgkmcnt(10)
v_mfma_f32_32x32x16_bf16 v[128:143], v[200:203], v[228:231], v[128:143]
ds_read_b64_tr_b16 v[176:177], v21 offset:43072
ds_read_b64_tr_b16 v[178:179], v21 offset:43840
s_waitcnt lgkmcnt(10)
v_mfma_f32_32x32x16_bf16 v[144:159], v[204:207], v[228:231], v[144:159]
ds_read_b64_tr_b16 v[180:181], v21 offset:43136
ds_read_b64_tr_b16 v[182:183], v21 offset:43904
s_waitcnt vmcnt(1)
s_waitcnt lgkmcnt(10)
v_mfma_f32_32x32x16_bf16 v[64:79], v[160:163], v[232:235], v[64:79]
s_add_u32 s58, s58, s44
ds_read_b64_tr_b16 v[184:185], v21 offset:39936
ds_read_b64_tr_b16 v[186:187], v21 offset:40704
s_add_u32 s44, s45, 10
s_waitcnt lgkmcnt(10)
v_mfma_f32_32x32x16_bf16 v[80:95], v[164:167], v[232:235], v[80:95]
s_cmp_ge_u32 s44, 80
s_cselect_b32 s44, 184320, 0
ds_read_b64_tr_b16 v[188:189], v21 offset:40000
ds_read_b64_tr_b16 v[190:191], v21 offset:40768
s_add_u32 s59, s66, 23040
s_waitcnt lgkmcnt(10)
v_mfma_f32_32x32x16_bf16 v[96:111], v[168:171], v[232:235], v[96:111]
s_add_u32 s59, s59, s44
ds_read_b64_tr_b16 v[192:193], v21 offset:40064
ds_read_b64_tr_b16 v[194:195], v21 offset:40832
s_waitcnt lgkmcnt(10)
v_mfma_f32_32x32x16_bf16 v[112:127], v[172:175], v[232:235], v[112:127]
ds_read_b64_tr_b16 v[196:197], v21 offset:46080
ds_read_b64_tr_b16 v[198:199], v21 offset:46848
s_waitcnt lgkmcnt(10)
v_mfma_f32_32x32x16_bf16 v[128:143], v[176:179], v[232:235], v[128:143]
ds_read_b64_tr_b16 v[200:201], v21 offset:46144
ds_read_b64_tr_b16 v[202:203], v21 offset:46912
s_waitcnt lgkmcnt(10)
v_mfma_f32_32x32x16_bf16 v[144:159], v[180:183], v[232:235], v[144:159]
ds_read_b64_tr_b16 v[204:205], v21 offset:46208
ds_read_b64_tr_b16 v[206:207], v21 offset:46976
s_waitcnt vmcnt(0)
s_waitcnt lgkmcnt(10)
v_mfma_f32_32x32x16_bf16 v[64:79], v[184:187], v[236:239], v[64:79]
s_waitcnt lgkmcnt(8)
v_mfma_f32_32x32x16_bf16 v[80:95], v[188:191], v[236:239], v[80:95]
s_waitcnt lgkmcnt(6)
v_mfma_f32_32x32x16_bf16 v[96:111], v[192:195], v[236:239], v[96:111]
s_waitcnt lgkmcnt(4)
v_mfma_f32_32x32x16_bf16 v[112:127], v[196:199], v[236:239], v[112:127]
s_waitcnt lgkmcnt(2)
v_mfma_f32_32x32x16_bf16 v[128:143], v[200:203], v[236:239], v[128:143]
s_waitcnt lgkmcnt(0)
v_mfma_f32_32x32x16_bf16 v[144:159], v[204:207], v[236:239], v[144:159]
s_waitcnt lgkmcnt(0)
s_barrier
s_nop 7
v_pk_mul_f32 v[64:65], v[64:65], v[26:27] op_sel:[0,1] op_sel_hi:[1,1]
v_pk_mul_f32 v[66:67], v[66:67], v[26:27] op_sel:[0,1] op_sel_hi:[1,1]
v_pk_mul_f32 v[68:69], v[68:69], v[26:27] op_sel:[0,1] op_sel_hi:[1,1]
v_pk_mul_f32 v[70:71], v[70:71], v[26:27] op_sel:[0,1] op_sel_hi:[1,1]
v_pk_mul_f32 v[72:73], v[72:73], v[26:27] op_sel:[0,1] op_sel_hi:[1,1]
v_pk_mul_f32 v[74:75], v[74:75], v[26:27] op_sel:[0,1] op_sel_hi:[1,1]
v_pk_mul_f32 v[76:77], v[76:77], v[26:27] op_sel:[0,1] op_sel_hi:[1,1]
v_pk_mul_f32 v[78:79], v[78:79], v[26:27] op_sel:[0,1] op_sel_hi:[1,1]
v_exp_f32 v64, v64
v_exp_f32 v65, v65
v_exp_f32 v66, v66
v_exp_f32 v67, v67
v_exp_f32 v68, v68
v_exp_f32 v69, v69
v_exp_f32 v70, v70
v_exp_f32 v71, v71
v_exp_f32 v72, v72
v_exp_f32 v73, v73
v_exp_f32 v74, v74
v_exp_f32 v75, v75
v_exp_f32 v76, v76
v_exp_f32 v77, v77
v_exp_f32 v78, v78
v_exp_f32 v79, v79
s_nop 0
v_pk_add_f32 v[64:65], v[64:65], v[4:5]
v_pk_add_f32 v[66:67], v[66:67], v[4:5]
v_pk_add_f32 v[68:69], v[68:69], v[4:5]
v_pk_add_f32 v[70:71], v[70:71], v[4:5]
v_pk_add_f32 v[72:73], v[72:73], v[4:5]
v_pk_add_f32 v[74:75], v[74:75], v[4:5]
v_pk_add_f32 v[76:77], v[76:77], v[4:5]
v_pk_add_f32 v[78:79], v[78:79], v[4:5]
v_rcp_f32 v64, v64
v_rcp_f32 v65, v65
v_rcp_f32 v66, v66
v_rcp_f32 v67, v67
v_rcp_f32 v68, v68
v_rcp_f32 v69, v69
v_rcp_f32 v70, v70
v_rcp_f32 v71, v71
v_rcp_f32 v72, v72
v_rcp_f32 v73, v73
v_rcp_f32 v74, v74
v_rcp_f32 v75, v75
v_rcp_f32 v76, v76
v_rcp_f32 v77, v77
v_rcp_f32 v78, v78
v_rcp_f32 v79, v79
s_nop 0
v_pk_mul_f32 v[64:65], v[64:65], v[112:113]
v_pk_mul_f32 v[66:67], v[66:67], v[114:115]
v_pk_mul_f32 v[68:69], v[68:69], v[116:117]
v_pk_mul_f32 v[70:71], v[70:71], v[118:119]
v_pk_mul_f32 v[72:73], v[72:73], v[120:121]
v_pk_mul_f32 v[74:75], v[74:75], v[122:123]
v_pk_mul_f32 v[76:77], v[76:77], v[124:125]
v_pk_mul_f32 v[78:79], v[78:79], v[126:127]
v_cvt_pk_bf16_f32 v160, v64, v65
v_cvt_pk_bf16_f32 v161, v66, v67
v_cvt_pk_bf16_f32 v162, v68, v69
v_cvt_pk_bf16_f32 v163, v70, v71
v_cvt_pk_bf16_f32 v164, v72, v73
v_cvt_pk_bf16_f32 v165, v74, v75
v_cvt_pk_bf16_f32 v166, v76, v77
v_cvt_pk_bf16_f32 v167, v78, v79
s_cmp_eq_u32 s40, 0
s_cbranch_scc1 L_stsafe_8
buffer_store_dwordx4 v[160:163], v24, s[12:15], s54 offen
buffer_store_dwordx4 v[164:167], v24, s[12:15], s55 offen
s_branch L_stdone_9
L_stsafe_8:
buffer_store_dwordx4 v[160:163], v24, s[12:15], s54 offen sc1
buffer_store_dwordx4 v[164:167], v24, s[12:15], s55 offen sc1
L_stdone_9:
v_pk_mul_f32 v[80:81], v[80:81], v[26:27] op_sel:[0,1] op_sel_hi:[1,1]
v_pk_mul_f32 v[82:83], v[82:83], v[26:27] op_sel:[0,1] op_sel_hi:[1,1]
v_pk_mul_f32 v[84:85], v[84:85], v[26:27] op_sel:[0,1] op_sel_hi:[1,1]
v_pk_mul_f32 v[86:87], v[86:87], v[26:27] op_sel:[0,1] op_sel_hi:[1,1]
v_pk_mul_f32 v[88:89], v[88:89], v[26:27] op_sel:[0,1] op_sel_hi:[1,1]
v_pk_mul_f32 v[90:91], v[90:91], v[26:27] op_sel:[0,1] op_sel_hi:[1,1]
v_pk_mul_f32 v[92:93], v[92:93], v[26:27] op_sel:[0,1] op_sel_hi:[1,1]
v_pk_mul_f32 v[94:95], v[94:95], v[26:27] op_sel:[0,1] op_sel_hi:[1,1]
v_exp_f32 v80, v80
v_exp_f32 v81, v81
v_exp_f32 v82, v82
v_exp_f32 v83, v83
v_exp_f32 v84, v84
v_exp_f32 v85, v85
v_exp_f32 v86, v86
v_exp_f32 v87, v87
v_exp_f32 v88, v88
v_exp_f32 v89, v89
v_exp_f32 v90, v90
v_exp_f32 v91, v91
v_exp_f32 v92, v92
v_exp_f32 v93, v93
v_exp_f32 v94, v94
v_exp_f32 v95, v95
s_nop 0
v_pk_add_f32 v[80:81], v[80:81], v[4:5]
v_pk_add_f32 v[82:83], v[82:83], v[4:5]
v_pk_add_f32 v[84:85], v[84:85], v[4:5]
v_pk_add_f32 v[86:87], v[86:87], v[4:5]
v_pk_add_f32 v[88:89], v[88:89], v[4:5]
v_pk_add_f32 v[90:91], v[90:91], v[4:5]
v_pk_add_f32 v[92:93], v[92:93], v[4:5]
v_pk_add_f32 v[94:95], v[94:95], v[4:5]
v_rcp_f32 v80, v80
v_rcp_f32 v81, v81
v_rcp_f32 v82, v82
v_rcp_f32 v83, v83
v_rcp_f32 v84, v84
v_rcp_f32 v85, v85
v_rcp_f32 v86, v86
v_rcp_f32 v87, v87
v_rcp_f32 v88, v88
v_rcp_f32 v89, v89
v_rcp_f32 v90, v90
v_rcp_f32 v91, v91
v_rcp_f32 v92, v92
v_rcp_f32 v93, v93
v_rcp_f32 v94, v94
v_rcp_f32 v95, v95
s_nop 0
v_pk_mul_f32 v[80:81], v[80:81], v[128:129]
v_pk_mul_f32 v[82:83], v[82:83], v[130:131]
v_pk_mul_f32 v[84:85], v[84:85], v[132:133]
v_pk_mul_f32 v[86:87], v[86:87], v[134:135]
v_pk_mul_f32 v[88:89], v[88:89], v[136:137]
v_pk_mul_f32 v[90:91], v[90:91], v[138:139]
v_pk_mul_f32 v[92:93], v[92:93], v[140:141]
v_pk_mul_f32 v[94:95], v[94:95], v[142:143]
v_cvt_pk_bf16_f32 v168, v80, v81
v_cvt_pk_bf16_f32 v169, v82, v83
v_cvt_pk_bf16_f32 v170, v84, v85
v_cvt_pk_bf16_f32 v171, v86, v87
v_cvt_pk_bf16_f32 v172, v88, v89
v_cvt_pk_bf16_f32 v173, v90, v91
v_cvt_pk_bf16_f32 v174, v92, v93
v_cvt_pk_bf16_f32 v175, v94, v95
s_cmp_eq_u32 s40, 0
s_cbranch_scc1 L_stsafe_10
buffer_store_dwordx4 v[168:171], v24, s[12:15], s56 offen
buffer_store_dwordx4 v[172:175], v24, s[12:15], s57 offen
s_branch L_stdone_11
L_stsafe_10:
buffer_store_dwordx4 v[168:171], v24, s[12:15], s56 offen sc1
buffer_store_dwordx4 v[172:175], v24, s[12:15], s57 offen sc1
L_stdone_11:
v_pk_mul_f32 v[96:97], v[96:97], v[26:27] op_sel:[0,1] op_sel_hi:[1,1]
v_pk_mul_f32 v[98:99], v[98:99], v[26:27] op_sel:[0,1] op_sel_hi:[1,1]
v_pk_mul_f32 v[100:101], v[100:101], v[26:27] op_sel:[0,1] op_sel_hi:[1,1]
v_pk_mul_f32 v[102:103], v[102:103], v[26:27] op_sel:[0,1] op_sel_hi:[1,1]
v_pk_mul_f32 v[104:105], v[104:105], v[26:27] op_sel:[0,1] op_sel_hi:[1,1]
v_pk_mul_f32 v[106:107], v[106:107], v[26:27] op_sel:[0,1] op_sel_hi:[1,1]
v_pk_mul_f32 v[108:109], v[108:109], v[26:27] op_sel:[0,1] op_sel_hi:[1,1]
v_pk_mul_f32 v[110:111], v[110:111], v[26:27] op_sel:[0,1] op_sel_hi:[1,1]
v_exp_f32 v96, v96
v_exp_f32 v97, v97
v_exp_f32 v98, v98
v_exp_f32 v99, v99
v_exp_f32 v100, v100
v_exp_f32 v101, v101
v_exp_f32 v102, v102
v_exp_f32 v103, v103
v_exp_f32 v104, v104
v_exp_f32 v105, v105
v_exp_f32 v106, v106
v_exp_f32 v107, v107
v_exp_f32 v108, v108
v_exp_f32 v109, v109
v_exp_f32 v110, v110
v_exp_f32 v111, v111
s_nop 0
v_pk_add_f32 v[96:97], v[96:97], v[4:5]
v_pk_add_f32 v[98:99], v[98:99], v[4:5]
v_pk_add_f32 v[100:101], v[100:101], v[4:5]
v_pk_add_f32 v[102:103], v[102:103], v[4:5]
v_pk_add_f32 v[104:105], v[104:105], v[4:5]
v_pk_add_f32 v[106:107], v[106:107], v[4:5]
v_pk_add_f32 v[108:109], v[108:109], v[4:5]
v_pk_add_f32 v[110:111], v[110:111], v[4:5]
v_rcp_f32 v96, v96
v_rcp_f32 v97, v97
v_rcp_f32 v98, v98
v_rcp_f32 v99, v99
v_rcp_f32 v100, v100
v_rcp_f32 v101, v101
v_rcp_f32 v102, v102
v_rcp_f32 v103, v103
v_rcp_f32 v104, v104
v_rcp_f32 v105, v105
v_rcp_f32 v106, v106
v_rcp_f32 v107, v107
v_rcp_f32 v108, v108
v_rcp_f32 v109, v109
v_rcp_f32 v110, v110
v_rcp_f32 v111, v111
s_nop 0
v_pk_mul_f32 v[96:97], v[96:97], v[144:145]
v_pk_mul_f32 v[98:99], v[98:99], v[146:147]
v_pk_mul_f32 v[100:101], v[100:101], v[148:149]
v_pk_mul_f32 v[102:103], v[102:103], v[150:151]
v_pk_mul_f32 v[104:105], v[104:105], v[152:153]
v_pk_mul_f32 v[106:107], v[106:107], v[154:155]
v_pk_mul_f32 v[108:109], v[108:109], v[156:157]
v_pk_mul_f32 v[110:111], v[110:111], v[158:159]
v_cvt_pk_bf16_f32 v176, v96, v97
v_cvt_pk_bf16_f32 v177, v98, v99
v_cvt_pk_bf16_f32 v178, v100, v101
v_cvt_pk_bf16_f32 v179, v102, v103
v_cvt_pk_bf16_f32 v180, v104, v105
v_cvt_pk_bf16_f32 v181, v106, v107
v_cvt_pk_bf16_f32 v182, v108, v109
v_cvt_pk_bf16_f32 v183, v110, v111
s_cmp_eq_u32 s40, 0
s_cbranch_scc1 L_stsafe_12
buffer_store_dwordx4 v[176:179], v24, s[12:15], s58 offen
buffer_store_dwordx4 v[180:183], v24, s[12:15], s59 offen
s_branch L_stdone_13
L_stsafe_12:
buffer_store_dwordx4 v[176:179], v24, s[12:15], s58 offen sc1
buffer_store_dwordx4 v[180:183], v24, s[12:15], s59 offen sc1
L_stdone_13:
s_waitcnt vmcnt(0)
s_waitcnt lgkmcnt(0)
s_barrier
s_barrier
s_barrier
s_and_b32 s46, s37, 7
s_lshr_b32 s47, s37, 3
s_lshr_b32 s48, s38, 1
s_and_b32 s49, s38, 1
s_lshl_b32 s52, s47, 6
s_lshl_b32 s53, s49, 5
s_add_u32 s52, s52, s53
v_mul_u32_u24 v24, 2304, v3
v_add_u32 v4, s52, v2
v_lshl_add_u32 v24, v4, 4, v24
s_mul_i32 s54, s36, 630784
s_mul_i32 s55, s48, 405504
s_add_u32 s54, s54, s55
s_add_u32 s54, s54, 1048832
s_mov_b32 s42, 0
s_mul_i32 s43, s42, 110592
s_add_u32 s54, s54, s43
s_xor_b32 s44, s48, 1
s_and_b32 s45, s44, s42
s_mul_i32 s45, s45, 184320
s_add_u32 s61, s45, 9216
s_mul_i32 s43, s42, 221184
s_add_u32 s43, s43, s45
s_sub_u32 s62, 9216, s43
s_xor_b32 s45, s42, 1
s_and_b32 s45, s45, s44
s_mul_i32 s45, s45, 184320
s_add_u32 s60, s45, 9216
buffer_load_dwordx4 v[152:155], v24, s[12:15], s54 offen offset:0 sc1
buffer_load_dwordx4 v[156:159], v24, s[12:15], s54 offen offset:256 sc1
s_add_u32 s54, s54, 9216
buffer_load_dwordx4 v[160:163], v24, s[12:15], s54 offen offset:0 sc1
buffer_load_dwordx4 v[164:167], v24, s[12:15], s54 offen offset:256 sc1
s_add_u32 s54, s54, 9216
buffer_load_dwordx4 v[168:171], v24, s[12:15], s54 offen offset:0 sc1
buffer_load_dwordx4 v[172:175], v24, s[12:15], s54 offen offset:256 sc1
s_add_u32 s54, s54, 9216
s_lshl_b32 s55, s48, 4
s_add_u32 s57, s52, s55
v_add_u32 v25, s57, v2
v_lshlrev_b32 v4, 2, v25
v_mul_u32_u24 v5, 1024, v3
v_add_u32 v4, v4, v5
s_lshl_b32 s59, s36, 12
s_add_u32 s59, s59, 131072
buffer_load_dword v30, v4, s[12:15], s59 offen offset:0 sc1
buffer_load_dword v31, v4, s[12:15], s59 offen offset:512 sc1
v_lshrrev_b32 v4, 2, v2
v_and_b32 v5, 1, v3
v_lshl_add_u32 v4, v5, 2, v4
v_lshrrev_b32 v5, 1, v3
v_lshl_add_u32 v4, v5, 4, v4
v_mul_u32_u24 v4, 160, v4
v_and_b32 v5, 3, v2
v_lshl_add_u32 v4, v5, 3, v4
s_mul_i32 s55, s48, 10240
v_add_u32 v21, s55, v4
v_add_u32 v22, 61440, v21
v_add_u32 v23, 122880, v21
ds_read_b64_tr_b16 v[112:113], v22 offset:40960
ds_read_b64_tr_b16 v[114:115], v22 offset:42240
ds_read_b64_tr_b16 v[116:117], v22 offset:40992
ds_read_b64_tr_b16 v[118:119], v22 offset:42272
ds_read_b64_tr_b16 v[120:121], v22 offset:41024
ds_read_b64_tr_b16 v[122:123], v22 offset:42304
ds_read_b64_tr_b16 v[124:125], v22 offset:41056
ds_read_b64_tr_b16 v[126:127], v22 offset:42336
ds_read_b64_tr_b16 v[128:129], v22 offset:41088
ds_read_b64_tr_b16 v[130:131], v22 offset:42368
s_waitcnt vmcnt(6)
s_waitcnt lgkmcnt(8)
v_mfma_f32_16x16x32_bf16 v[64:67], v[112:115], v[152:155], 0
ds_read_b64_tr_b16 v[132:133], v22 offset:46080
v_mfma_f32_16x16x32_bf16 v[68:71], v[112:115], v[156:159], 0
ds_read_b64_tr_b16 v[134:135], v22 offset:47360
s_waitcnt lgkmcnt(8)
v_mfma_f32_16x16x32_bf16 v[72:75], v[116:119], v[152:155], 0
ds_read_b64_tr_b16 v[136:137], v22 offset:46112
buffer_load_dwordx4 v[176:179], v24, s[12:15], s54 offen offset:0 sc1
buffer_load_dwordx4 v[180:183], v24, s[12:15], s54 offen offset:256 sc1
s_add_u32 s54, s54, 9216
v_mfma_f32_16x16x32_bf16 v[76:79], v[116:119], v[156:159], 0
ds_read_b64_tr_b16 v[138:139], v22 offset:47392
s_waitcnt lgkmcnt(8)
v_mfma_f32_16x16x32_bf16 v[80:83], v[120:123], v[152:155], 0
ds_read_b64_tr_b16 v[140:141], v22 offset:46144
v_mfma_f32_16x16x32_bf16 v[84:87], v[120:123], v[156:159], 0
buffer_load_dwordx4 v[184:187], v24, s[12:15], s54 offen offset:0 sc1
buffer_load_dwordx4 v[188:191], v24, s[12:15], s54 offen offset:256 sc1
s_add_u32 s54, s54, 9216
ds_read_b64_tr_b16 v[142:143], v22 offset:47424
s_waitcnt lgkmcnt(8)
v_mfma_f32_16x16x32_bf16 v[88:91], v[124:127], v[152:155], 0
ds_read_b64_tr_b16 v[144:145], v22 offset:46176
v_mfma_f32_16x16x32_bf16 v[92:95], v[124:127], v[156:159], 0
ds_read_b64_tr_b16 v[146:147], v22 offset:47456
s_waitcnt lgkmcnt(8)
v_mfma_f32_16x16x32_bf16 v[96:99], v[128:131], v[152:155], 0
ds_read_b64_tr_b16 v[148:149], v22 offset:46208
v_mfma_f32_16x16x32_bf16 v[100:103], v[128:131], v[156:159], 0
ds_read_b64_tr_b16 v[150:151], v22 offset:47488
s_waitcnt vmcnt(8)
s_waitcnt lgkmcnt(8)
v_mfma_f32_16x16x32_bf16 v[64:67], v[132:135], v[160:163], v[64:67]
ds_read_b64_tr_b16 v[112:113], v23 offset:0
v_mfma_f32_16x16x32_bf16 v[68:71], v[132:135], v[164:167], v[68:71]
ds_read_b64_tr_b16 v[114:115], v23 offset:1280
s_waitcnt lgkmcnt(8)
v_mfma_f32_16x16x32_bf16 v[72:75], v[136:139], v[160:163], v[72:75]
ds_read_b64_tr_b16 v[116:117], v23 offset:32
buffer_load_dwordx4 v[192:195], v24, s[12:15], s54 offen offset:0 sc1
buffer_load_dwordx4 v[196:199], v24, s[12:15], s54 offen offset:256 sc1
s_add_u32 s54, s54, 9216
v_mfma_f32_16x16x32_bf16 v[76:79], v[136:139], v[164:167], v[76:79]
ds_read_b64_tr_b16 v[118:119], v23 offset:1312
s_waitcnt lgkmcnt(8)
v_mfma_f32_16x16x32_bf16 v[80:83], v[140:143], v[160:163], v[80:83]
ds_read_b64_tr_b16 v[120:121], v23 offset:64
v_mfma_f32_16x16x32_bf16 v[84:87], v[140:143], v[164:167], v[84:87]
buffer_load_dwordx4 v[200:203], v24, s[12:15], s54 offen offset:0 sc1
buffer_load_dwordx4 v[204:207], v24, s[12:15], s54 offen offset:256 sc1
s_add_u32 s54, s54, 9216
ds_read_b64_tr_b16 v[122:123], v23 offset:1344
s_waitcnt lgkmcnt(8)
v_mfma_f32_16x16x32_bf16 v[88:91], v[144:147], v[160:163], v[88:91]
ds_read_b64_tr_b16 v[124:125], v23 offset:96
v_mfma_f32_16x16x32_bf16 v[92:95], v[144:147], v[164:167], v[92:95]
ds_read_b64_tr_b16 v[126:127], v23 offset:1376
s_waitcnt lgkmcnt(8)
v_mfma_f32_16x16x32_bf16 v[96:99], v[148:151], v[160:163], v[96:99]
ds_read_b64_tr_b16 v[128:129], v23 offset:128
v_mfma_f32_16x16x32_bf16 v[100:103], v[148:151], v[164:167], v[100:103]
ds_read_b64_tr_b16 v[130:131], v23 offset:1408
s_waitcnt vmcnt(10)
s_waitcnt lgkmcnt(8)
v_mfma_f32_16x16x32_bf16 v[64:67], v[112:115], v[168:171], v[64:67]
ds_read_b64_tr_b16 v[132:133], v23 offset:5120
v_mfma_f32_16x16x32_bf16 v[68:71], v[112:115], v[172:175], v[68:71]
ds_read_b64_tr_b16 v[134:135], v23 offset:6400
s_waitcnt lgkmcnt(8)
v_mfma_f32_16x16x32_bf16 v[72:75], v[116:119], v[168:171], v[72:75]
ds_read_b64_tr_b16 v[136:137], v23 offset:5152
buffer_load_dwordx4 v[208:211], v24, s[12:15], s54 offen offset:0 sc1
buffer_load_dwordx4 v[212:215], v24, s[12:15], s54 offen offset:256 sc1
s_add_u32 s54, s54, s61
v_mfma_f32_16x16x32_bf16 v[76:79], v[116:119], v[172:175], v[76:79]
ds_read_b64_tr_b16 v[138:139], v23 offset:6432
s_waitcnt lgkmcnt(8)
v_mfma_f32_16x16x32_bf16 v[80:83], v[120:123], v[168:171], v[80:83]
ds_read_b64_tr_b16 v[140:141], v23 offset:5184
v_mfma_f32_16x16x32_bf16 v[84:87], v[120:123], v[172:175], v[84:87]
buffer_load_dwordx4 v[216:219], v24, s[12:15], s54 offen offset:0 sc1
buffer_load_dwordx4 v[220:223], v24, s[12:15], s54 offen offset:256 sc1
s_add_u32 s54, s54, 9216
ds_read_b64_tr_b16 v[142:143], v23 offset:6464
s_waitcnt lgkmcnt(8)
v_mfma_f32_16x16x32_bf16 v[88:91], v[124:127], v[168:171], v[88:91]
ds_read_b64_tr_b16 v[144:145], v23 offset:5216
v_mfma_f32_16x16x32_bf16 v[92:95], v[124:127], v[172:175], v[92:95]
ds_read_b64_tr_b16 v[146:147], v23 offset:6496
s_waitcnt lgkmcnt(8)
v_mfma_f32_16x16x32_bf16 v[96:99], v[128:131], v[168:171], v[96:99]
ds_read_b64_tr_b16 v[148:149], v23 offset:5248
v_mfma_f32_16x16x32_bf16 v[100:103], v[128:131], v[172:175], v[100:103]
ds_read_b64_tr_b16 v[150:151], v23 offset:6528
s_waitcnt lgkmcnt(0)
s_barrier
s_waitcnt vmcnt(10)
v_mfma_f32_16x16x32_bf16 v[64:67], v[132:135], v[176:179], v[64:67]
ds_read_b64_tr_b16 v[112:113], v23 offset:20480
v_mfma_f32_16x16x32_bf16 v[68:71], v[132:135], v[180:183], v[68:71]
ds_read_b64_tr_b16 v[114:115], v23 offset:21760
v_mfma_f32_16x16x32_bf16 v[72:75], v[136:139], v[176:179], v[72:75]
ds_read_b64_tr_b16 v[116:117], v23 offset:20512
buffer_load_dwordx4 v[224:227], v24, s[12:15], s54 offen offset:0 sc1
buffer_load_dwordx4 v[228:231], v24, s[12:15], s54 offen offset:256 sc1
s_add_u32 s54, s54, 9216
v_mfma_f32_16x16x32_bf16 v[76:79], v[136:139], v[180:183], v[76:79]
ds_read_b64_tr_b16 v[118:119], v23 offset:21792
v_mfma_f32_16x16x32_bf16 v[80:83], v[140:143], v[176:179], v[80:83]
ds_read_b64_tr_b16 v[120:121], v23 offset:20544
v_mfma_f32_16x16x32_bf16 v[84:87], v[140:143], v[180:183], v[84:87]
buffer_load_dwordx4 v[232:235], v24, s[12:15], s54 offen offset:0 sc1
buffer_load_dwordx4 v[236:239], v24, s[12:15], s54 offen offset:256 sc1
s_add_u32 s54, s54, 9216
ds_read_b64_tr_b16 v[122:123], v23 offset:21824
v_mfma_f32_16x16x32_bf16 v[88:91], v[144:147], v[176:179], v[88:91]
ds_read_b64_tr_b16 v[124:125], v23 offset:20576
v_mfma_f32_16x16x32_bf16 v[92:95], v[144:147], v[180:183], v[92:95]
ds_read_b64_tr_b16 v[126:127], v23 offset:21856
v_mfma_f32_16x16x32_bf16 v[96:99], v[148:151], v[176:179], v[96:99]
ds_read_b64_tr_b16 v[128:129], v23 offset:20608
v_mfma_f32_16x16x32_bf16 v[100:103], v[148:151], v[180:183], v[100:103]
ds_read_b64_tr_b16 v[130:131], v23 offset:21888
s_waitcnt vmcnt(12)
s_waitcnt lgkmcnt(8)
v_mfma_f32_16x16x32_bf16 v[64:67], v[112:115], v[184:187], v[64:67]
ds_read_b64_tr_b16 v[132:133], v23 offset:25600
v_mfma_f32_16x16x32_bf16 v[68:71], v[112:115], v[188:191], v[68:71]
ds_read_b64_tr_b16 v[134:135], v23 offset:26880
s_waitcnt lgkmcnt(8)
v_mfma_f32_16x16x32_bf16 v[72:75], v[116:119], v[184:187], v[72:75]
ds_read_b64_tr_b16 v[136:137], v23 offset:25632
buffer_load_dwordx4 v[32:35], v24, s[12:15], s54 offen offset:0 sc1
buffer_load_dwordx4 v[36:39], v24, s[12:15], s54 offen offset:256 sc1
s_add_u32 s54, s54, s62
v_mfma_f32_16x16x32_bf16 v[76:79], v[116:119], v[188:191], v[76:79]
ds_read_b64_tr_b16 v[138:139], v23 offset:26912
s_waitcnt lgkmcnt(8)
v_mfma_f32_16x16x32_bf16 v[80:83], v[120:123], v[184:187], v[80:83]
ds_read_b64_tr_b16 v[140:141], v23 offset:25664
v_mfma_f32_16x16x32_bf16 v[84:87], v[120:123], v[188:191], v[84:87]
buffer_load_dwordx4 v[40:43], v24, s[12:15], s54 offen offset:0 sc1
buffer_load_dwordx4 v[44:47], v24, s[12:15], s54 offen offset:256 sc1
s_add_u32 s54, s54, 9216
ds_read_b64_tr_b16 v[142:143], v23 offset:26944
s_waitcnt lgkmcnt(8)
v_mfma_f32_16x16x32_bf16 v[88:91], v[124:127], v[184:187], v[88:91]
ds_read_b64_tr_b16 v[144:145], v23 offset:25696
v_mfma_f32_16x16x32_bf16 v[92:95], v[124:127], v[188:191], v[92:95]
ds_read_b64_tr_b16 v[146:147], v23 offset:26976
s_waitcnt lgkmcnt(8)
v_mfma_f32_16x16x32_bf16 v[96:99], v[128:131], v[184:187], v[96:99]
ds_read_b64_tr_b16 v[148:149], v23 offset:25728
v_mfma_f32_16x16x32_bf16 v[100:103], v[128:131], v[188:191], v[100:103]
ds_read_b64_tr_b16 v[150:151], v23 offset:27008
s_waitcnt vmcnt(14)
s_waitcnt lgkmcnt(8)
v_mfma_f32_16x16x32_bf16 v[64:67], v[132:135], v[192:195], v[64:67]
ds_read_b64_tr_b16 v[112:113], v21 offset:0
v_mfma_f32_16x16x32_bf16 v[68:71], v[132:135], v[196:199], v[68:71]
ds_read_b64_tr_b16 v[114:115], v21 offset:1280
s_waitcnt lgkmcnt(8)
v_mfma_f32_16x16x32_bf16 v[72:75], v[136:139], v[192:195], v[72:75]
ds_read_b64_tr_b16 v[116:117], v21 offset:32
buffer_load_dwordx4 v[48:51], v24, s[12:15], s54 offen offset:0 sc1
buffer_load_dwordx4 v[52:55], v24, s[12:15], s54 offen offset:256 sc1
s_add_u32 s54, s54, 9216
v_mfma_f32_16x16x32_bf16 v[76:79], v[136:139], v[196:199], v[76:79]
ds_read_b64_tr_b16 v[118:119], v21 offset:1312
s_waitcnt lgkmcnt(8)
v_mfma_f32_16x16x32_bf16 v[80:83], v[140:143], v[192:195], v[80:83]
ds_read_b64_tr_b16 v[120:121], v21 offset:64
v_mfma_f32_16x16x32_bf16 v[84:87], v[140:143], v[196:199], v[84:87]
buffer_load_dwordx4 v[56:59], v24, s[12:15], s54 offen offset:0 sc1
buffer_load_dwordx4 v[60:63], v24, s[12:15], s54 offen offset:256 sc1
s_add_u32 s54, s54, 9216
ds_read_b64_tr_b16 v[122:123], v21 offset:1344
s_waitcnt lgkmcnt(8)
v_mfma_f32_16x16x32_bf16 v[88:91], v[144:147], v[192:195], v[88:91]
ds_read_b64_tr_b16 v[124:125], v21 offset:96
v_mfma_f32_16x16x32_bf16 v[92:95], v[144:147], v[196:199], v[92:95]
ds_read_b64_tr_b16 v[126:127], v21 offset:1376
s_waitcnt lgkmcnt(8)
v_mfma_f32_16x16x32_bf16 v[96:99], v[148:151], v[192:195], v[96:99]
ds_read_b64_tr_b16 v[128:129], v21 offset:128
v_mfma_f32_16x16x32_bf16 v[100:103], v[148:151], v[196:199], v[100:103]
ds_read_b64_tr_b16 v[130:131], v21 offset:1408
s_waitcnt vmcnt(16)
s_waitcnt lgkmcnt(8)
v_mfma_f32_16x16x32_bf16 v[64:67], v[112:115], v[200:203], v[64:67]
ds_read_b64_tr_b16 v[132:133], v21 offset:5120
v_mfma_f32_16x16x32_bf16 v[68:71], v[112:115], v[204:207], v[68:71]
ds_read_b64_tr_b16 v[134:135], v21 offset:6400
s_waitcnt lgkmcnt(8)
v_mfma_f32_16x16x32_bf16 v[72:75], v[116:119], v[200:203], v[72:75]
ds_read_b64_tr_b16 v[136:137], v21 offset:5152
buffer_load_dwordx4 v[152:155], v24, s[12:15], s54 offen offset:0 sc1
buffer_load_dwordx4 v[156:159], v24, s[12:15], s54 offen offset:256 sc1
s_add_u32 s54, s54, 9216
v_mfma_f32_16x16x32_bf16 v[76:79], v[116:119], v[204:207], v[76:79]
ds_read_b64_tr_b16 v[138:139], v21 offset:6432
s_waitcnt lgkmcnt(8)
v_mfma_f32_16x16x32_bf16 v[80:83], v[120:123], v[200:203], v[80:83]
ds_read_b64_tr_b16 v[140:141], v21 offset:5184
v_mfma_f32_16x16x32_bf16 v[84:87], v[120:123], v[204:207], v[84:87]
buffer_load_dwordx4 v[160:163], v24, s[12:15], s54 offen offset:0 sc1
buffer_load_dwordx4 v[164:167], v24, s[12:15], s54 offen offset:256 sc1
s_add_u32 s54, s54, 9216
ds_read_b64_tr_b16 v[142:143], v21 offset:6464
s_waitcnt lgkmcnt(8)
v_mfma_f32_16x16x32_bf16 v[88:91], v[124:127], v[200:203], v[88:91]
ds_read_b64_tr_b16 v[144:145], v21 offset:5216
v_mfma_f32_16x16x32_bf16 v[92:95], v[124:127], v[204:207], v[92:95]
ds_read_b64_tr_b16 v[146:147], v21 offset:6496
s_waitcnt lgkmcnt(8)
v_mfma_f32_16x16x32_bf16 v[96:99], v[128:131], v[200:203], v[96:99]
ds_read_b64_tr_b16 v[148:149], v21 offset:5248
v_mfma_f32_16x16x32_bf16 v[100:103], v[128:131], v[204:207], v[100:103]
ds_read_b64_tr_b16 v[150:151], v21 offset:6528
s_waitcnt lgkmcnt(0)
s_barrier
s_waitcnt vmcnt(18)
v_mfma_f32_16x16x32_bf16 v[64:67], v[132:135], v[208:211], v[64:67]
ds_read_b64_tr_b16 v[112:113], v21 offset:20480
v_mfma_f32_16x16x32_bf16 v[68:71], v[132:135], v[212:215], v[68:71]
ds_read_b64_tr_b16 v[114:115], v21 offset:21760
v_mfma_f32_16x16x32_bf16 v[72:75], v[136:139], v[208:211], v[72:75]
ds_read_b64_tr_b16 v[116:117], v21 offset:20512
buffer_load_dwordx4 v[168:171], v24, s[12:15], s54 offen offset:0 sc1
buffer_load_dwordx4 v[172:175], v24, s[12:15], s54 offen offset:256 sc1
s_add_u32 s54, s54, 9216
v_mfma_f32_16x16x32_bf16 v[76:79], v[136:139], v[212:215], v[76:79]
ds_read_b64_tr_b16 v[118:119], v21 offset:21792
v_mfma_f32_16x16x32_bf16 v[80:83], v[140:143], v[208:211], v[80:83]
ds_read_b64_tr_b16 v[120:121], v21 offset:20544
v_mfma_f32_16x16x32_bf16 v[84:87], v[140:143], v[212:215], v[84:87]
ds_read_b64_tr_b16 v[122:123], v21 offset:21824
v_mfma_f32_16x16x32_bf16 v[88:91], v[144:147], v[208:211], v[88:91]
ds_read_b64_tr_b16 v[124:125], v21 offset:20576
v_mfma_f32_16x16x32_bf16 v[92:95], v[144:147], v[212:215], v[92:95]
ds_read_b64_tr_b16 v[126:127], v21 offset:21856
v_mfma_f32_16x16x32_bf16 v[96:99], v[148:151], v[208:211], v[96:99]
ds_read_b64_tr_b16 v[128:129], v21 offset:20608
v_mfma_f32_16x16x32_bf16 v[100:103], v[148:151], v[212:215], v[100:103]
ds_read_b64_tr_b16 v[130:131], v21 offset:21888
s_waitcnt vmcnt(18)
s_waitcnt lgkmcnt(8)
v_mfma_f32_16x16x32_bf16 v[64:67], v[112:115], v[216:219], v[64:67]
ds_read_b64_tr_b16 v[132:133], v21 offset:25600
v_mfma_f32_16x16x32_bf16 v[68:71], v[112:115], v[220:223], v[68:71]
ds_read_b64_tr_b16 v[134:135], v21 offset:26880
s_waitcnt lgkmcnt(8)
v_mfma_f32_16x16x32_bf16 v[72:75], v[116:119], v[216:219], v[72:75]
ds_read_b64_tr_b16 v[136:137], v21 offset:25632
buffer_load_dwordx4 v[176:179], v24, s[12:15], s54 offen offset:0 sc1
buffer_load_dwordx4 v[180:183], v24, s[12:15], s54 offen offset:256 sc1
s_add_u32 s54, s54, 9216
v_mfma_f32_16x16x32_bf16 v[76:79], v[116:119], v[220:223], v[76:79]
ds_read_b64_tr_b16 v[138:139], v21 offset:26912
s_waitcnt lgkmcnt(8)
v_mfma_f32_16x16x32_bf16 v[80:83], v[120:123], v[216:219], v[80:83]
ds_read_b64_tr_b16 v[140:141], v21 offset:25664
v_mfma_f32_16x16x32_bf16 v[84:87], v[120:123], v[220:223], v[84:87]
ds_read_b64_tr_b16 v[142:143], v21 offset:26944
s_waitcnt lgkmcnt(8)
v_mfma_f32_16x16x32_bf16 v[88:91], v[124:127], v[216:219], v[88:91]
ds_read_b64_tr_b16 v[144:145], v21 offset:25696
v_mfma_f32_16x16x32_bf16 v[92:95], v[124:127], v[220:223], v[92:95]
ds_read_b64_tr_b16 v[146:147], v21 offset:26976
s_waitcnt lgkmcnt(8)
v_mfma_f32_16x16x32_bf16 v[96:99], v[128:131], v[216:219], v[96:99]
ds_read_b64_tr_b16 v[148:149], v21 offset:25728
v_mfma_f32_16x16x32_bf16 v[100:103], v[128:131], v[220:223], v[100:103]
ds_read_b64_tr_b16 v[150:151], v21 offset:27008
s_waitcnt vmcnt(18)
s_waitcnt lgkmcnt(8)
v_mfma_f32_16x16x32_bf16 v[64:67], v[132:135], v[224:227], v[64:67]
ds_read_b64_tr_b16 v[112:113], v21 offset:40960
v_mfma_f32_16x16x32_bf16 v[68:71], v[132:135], v[228:231], v[68:71]
ds_read_b64_tr_b16 v[114:115], v21 offset:42240
s_waitcnt lgkmcnt(8)
v_mfma_f32_16x16x32_bf16 v[72:75], v[136:139], v[224:227], v[72:75]
ds_read_b64_tr_b16 v[116:117], v21 offset:40992
buffer_load_dwordx4 v[184:187], v24, s[12:15], s54 offen offset:0 sc1
buffer_load_dwordx4 v[188:191], v24, s[12:15], s54 offen offset:256 sc1
s_add_u32 s54, s54, s60
v_mfma_f32_16x16x32_bf16 v[76:79], v[136:139], v[228:231], v[76:79]
ds_read_b64_tr_b16 v[118:119], v21 offset:42272
s_waitcnt lgkmcnt(8)
v_mfma_f32_16x16x32_bf16 v[80:83], v[140:143], v[224:227], v[80:83]
ds_read_b64_tr_b16 v[120:121], v21 offset:41024
v_mfma_f32_16x16x32_bf16 v[84:87], v[140:143], v[228:231], v[84:87]
ds_read_b64_tr_b16 v[122:123], v21 offset:42304
s_waitcnt lgkmcnt(8)
v_mfma_f32_16x16x32_bf16 v[88:91], v[144:147], v[224:227], v[88:91]
ds_read_b64_tr_b16 v[124:125], v21 offset:41056
v_mfma_f32_16x16x32_bf16 v[92:95], v[144:147], v[228:231], v[92:95]
ds_read_b64_tr_b16 v[126:127], v21 offset:42336
s_waitcnt lgkmcnt(8)
v_mfma_f32_16x16x32_bf16 v[96:99], v[148:151], v[224:227], v[96:99]
ds_read_b64_tr_b16 v[128:129], v21 offset:41088
v_mfma_f32_16x16x32_bf16 v[100:103], v[148:151], v[228:231], v[100:103]
ds_read_b64_tr_b16 v[130:131], v21 offset:42368
s_waitcnt vmcnt(18)
s_waitcnt lgkmcnt(8)
v_mfma_f32_16x16x32_bf16 v[64:67], v[112:115], v[232:235], v[64:67]
ds_read_b64_tr_b16 v[132:133], v21 offset:46080
v_mfma_f32_16x16x32_bf16 v[68:71], v[112:115], v[236:239], v[68:71]
ds_read_b64_tr_b16 v[134:135], v21 offset:47360
s_waitcnt lgkmcnt(8)
v_mfma_f32_16x16x32_bf16 v[72:75], v[116:119], v[232:235], v[72:75]
ds_read_b64_tr_b16 v[136:137], v21 offset:46112
buffer_load_dwordx4 v[192:195], v24, s[12:15], s54 offen offset:0 sc1
buffer_load_dwordx4 v[196:199], v24, s[12:15], s54 offen offset:256 sc1
s_add_u32 s54, s54, 9216
v_mfma_f32_16x16x32_bf16 v[76:79], v[116:119], v[236:239], v[76:79]
ds_read_b64_tr_b16 v[138:139], v21 offset:47392
s_waitcnt lgkmcnt(8)
v_mfma_f32_16x16x32_bf16 v[80:83], v[120:123], v[232:235], v[80:83]
ds_read_b64_tr_b16 v[140:141], v21 offset:46144
v_mfma_f32_16x16x32_bf16 v[84:87], v[120:123], v[236:239], v[84:87]
ds_read_b64_tr_b16 v[142:143], v21 offset:47424
s_waitcnt lgkmcnt(8)
v_mfma_f32_16x16x32_bf16 v[88:91], v[124:127], v[232:235], v[88:91]
ds_read_b64_tr_b16 v[144:145], v21 offset:46176
v_mfma_f32_16x16x32_bf16 v[92:95], v[124:127], v[236:239], v[92:95]
ds_read_b64_tr_b16 v[146:147], v21 offset:47456
s_waitcnt lgkmcnt(8)
v_mfma_f32_16x16x32_bf16 v[96:99], v[128:131], v[232:235], v[96:99]
ds_read_b64_tr_b16 v[148:149], v21 offset:46208
v_mfma_f32_16x16x32_bf16 v[100:103], v[128:131], v[236:239], v[100:103]
ds_read_b64_tr_b16 v[150:151], v21 offset:47488
s_waitcnt vmcnt(18)
s_waitcnt lgkmcnt(8)
v_mfma_f32_16x16x32_bf16 v[64:67], v[132:135], v[32:35], v[64:67]
ds_read_b64_tr_b16 v[112:113], v22 offset:0
v_mfma_f32_16x16x32_bf16 v[68:71], v[132:135], v[36:39], v[68:71]
ds_read_b64_tr_b16 v[114:115], v22 offset:1280
s_waitcnt lgkmcnt(8)
v_mfma_f32_16x16x32_bf16 v[72:75], v[136:139], v[32:35], v[72:75]
ds_read_b64_tr_b16 v[116:117], v22 offset:32
buffer_load_dwordx4 v[200:203], v24, s[12:15], s54 offen offset:0 sc1
buffer_load_dwordx4 v[204:207], v24, s[12:15], s54 offen offset:256 sc1
s_add_u32 s54, s54, 9216
v_mfma_f32_16x16x32_bf16 v[76:79], v[136:139], v[36:39], v[76:79]
ds_read_b64_tr_b16 v[118:119], v22 offset:1312
s_waitcnt lgkmcnt(8)
v_mfma_f32_16x16x32_bf16 v[80:83], v[140:143], v[32:35], v[80:83]
ds_read_b64_tr_b16 v[120:121], v22 offset:64
v_mfma_f32_16x16x32_bf16 v[84:87], v[140:143], v[36:39], v[84:87]
ds_read_b64_tr_b16 v[122:123], v22 offset:1344
s_waitcnt lgkmcnt(8)
v_mfma_f32_16x16x32_bf16 v[88:91], v[144:147], v[32:35], v[88:91]
ds_read_b64_tr_b16 v[124:125], v22 offset:96
v_mfma_f32_16x16x32_bf16 v[92:95], v[144:147], v[36:39], v[92:95]
ds_read_b64_tr_b16 v[126:127], v22 offset:1376
s_waitcnt lgkmcnt(8)
v_mfma_f32_16x16x32_bf16 v[96:99], v[148:151], v[32:35], v[96:99]
ds_read_b64_tr_b16 v[128:129], v22 offset:128
v_mfma_f32_16x16x32_bf16 v[100:103], v[148:151], v[36:39], v[100:103]
ds_read_b64_tr_b16 v[130:131], v22 offset:1408
s_waitcnt vmcnt(18)
s_waitcnt lgkmcnt(8)
v_mfma_f32_16x16x32_bf16 v[64:67], v[112:115], v[40:43], v[64:67]
ds_read_b64_tr_b16 v[132:133], v22 offset:5120
v_mfma_f32_16x16x32_bf16 v[68:71], v[112:115], v[44:47], v[68:71]
ds_read_b64_tr_b16 v[134:135], v22 offset:6400
s_waitcnt lgkmcnt(8)
v_mfma_f32_16x16x32_bf16 v[72:75], v[116:119], v[40:43], v[72:75]
ds_read_b64_tr_b16 v[136:137], v22 offset:5152
buffer_load_dwordx4 v[208:211], v24, s[12:15], s54 offen offset:0 sc1
buffer_load_dwordx4 v[212:215], v24, s[12:15], s54 offen offset:256 sc1
s_add_u32 s54, s54, 9216
v_mfma_f32_16x16x32_bf16 v[76:79], v[116:119], v[44:47], v[76:79]
ds_read_b64_tr_b16 v[138:139], v22 offset:6432
s_waitcnt lgkmcnt(8)
v_mfma_f32_16x16x32_bf16 v[80:83], v[120:123], v[40:43], v[80:83]
ds_read_b64_tr_b16 v[140:141], v22 offset:5184
v_mfma_f32_16x16x32_bf16 v[84:87], v[120:123], v[44:47], v[84:87]
ds_read_b64_tr_b16 v[142:143], v22 offset:6464
s_waitcnt lgkmcnt(8)
v_mfma_f32_16x16x32_bf16 v[88:91], v[124:127], v[40:43], v[88:91]
ds_read_b64_tr_b16 v[144:145], v22 offset:5216
v_mfma_f32_16x16x32_bf16 v[92:95], v[124:127], v[44:47], v[92:95]
ds_read_b64_tr_b16 v[146:147], v22 offset:6496
s_waitcnt lgkmcnt(8)
v_mfma_f32_16x16x32_bf16 v[96:99], v[128:131], v[40:43], v[96:99]
ds_read_b64_tr_b16 v[148:149], v22 offset:5248
v_mfma_f32_16x16x32_bf16 v[100:103], v[128:131], v[44:47], v[100:103]
ds_read_b64_tr_b16 v[150:151], v22 offset:6528
s_waitcnt vmcnt(18)
s_waitcnt lgkmcnt(8)
v_mfma_f32_16x16x32_bf16 v[64:67], v[132:135], v[48:51], v[64:67]
ds_read_b64_tr_b16 v[112:113], v22 offset:20480
v_mfma_f32_16x16x32_bf16 v[68:71], v[132:135], v[52:55], v[68:71]
ds_read_b64_tr_b16 v[114:115], v22 offset:21760
s_waitcnt lgkmcnt(8)
v_mfma_f32_16x16x32_bf16 v[72:75], v[136:139], v[48:51], v[72:75]
ds_read_b64_tr_b16 v[116:117], v22 offset:20512
buffer_load_dwordx4 v[216:219], v24, s[12:15], s54 offen offset:0 sc1
buffer_load_dwordx4 v[220:223], v24, s[12:15], s54 offen offset:256 sc1
v_mfma_f32_16x16x32_bf16 v[76:79], v[136:139], v[52:55], v[76:79]
ds_read_b64_tr_b16 v[118:119], v22 offset:21792
s_waitcnt lgkmcnt(8)
v_mfma_f32_16x16x32_bf16 v[80:83], v[140:143], v[48:51], v[80:83]
ds_read_b64_tr_b16 v[120:121], v22 offset:20544
v_mfma_f32_16x16x32_bf16 v[84:87], v[140:143], v[52:55], v[84:87]
ds_read_b64_tr_b16 v[122:123], v22 offset:21824
s_waitcnt lgkmcnt(8)
v_mfma_f32_16x16x32_bf16 v[88:91], v[144:147], v[48:51], v[88:91]
ds_read_b64_tr_b16 v[124:125], v22 offset:20576
v_mfma_f32_16x16x32_bf16 v[92:95], v[144:147], v[52:55], v[92:95]
ds_read_b64_tr_b16 v[126:127], v22 offset:21856
s_waitcnt lgkmcnt(8)
v_mfma_f32_16x16x32_bf16 v[96:99], v[148:151], v[48:51], v[96:99]
ds_read_b64_tr_b16 v[128:129], v22 offset:20608
v_mfma_f32_16x16x32_bf16 v[100:103], v[148:151], v[52:55], v[100:103]
ds_read_b64_tr_b16 v[130:131], v22 offset:21888
s_waitcnt vmcnt(18)
s_waitcnt lgkmcnt(8)
v_mfma_f32_16x16x32_bf16 v[64:67], v[112:115], v[56:59], v[64:67]
ds_read_b64_tr_b16 v[132:133], v22 offset:25600
v_mfma_f32_16x16x32_bf16 v[68:71], v[112:115], v[60:63], v[68:71]
ds_read_b64_tr_b16 v[134:135], v22 offset:26880
s_waitcnt lgkmcnt(8)
v_mfma_f32_16x16x32_bf16 v[72:75], v[116:119], v[56:59], v[72:75]
ds_read_b64_tr_b16 v[136:137], v22 offset:25632
v_mfma_f32_16x16x32_bf16 v[76:79], v[116:119], v[60:63], v[76:79]
ds_read_b64_tr_b16 v[138:139], v22 offset:26912
s_waitcnt lgkmcnt(8)
v_mfma_f32_16x16x32_bf16 v[80:83], v[120:123], v[56:59], v[80:83]
ds_read_b64_tr_b16 v[140:141], v22 offset:25664
v_mfma_f32_16x16x32_bf16 v[84:87], v[120:123], v[60:63], v[84:87]
ds_read_b64_tr_b16 v[142:143], v22 offset:26944
s_waitcnt lgkmcnt(8)
v_mfma_f32_16x16x32_bf16 v[88:91], v[124:127], v[56:59], v[88:91]
ds_read_b64_tr_b16 v[144:145], v22 offset:25696
v_mfma_f32_16x16x32_bf16 v[92:95], v[124:127], v[60:63], v[92:95]
ds_read_b64_tr_b16 v[146:147], v22 offset:26976
s_waitcnt lgkmcnt(8)
v_mfma_f32_16x16x32_bf16 v[96:99], v[128:131], v[56:59], v[96:99]
ds_read_b64_tr_b16 v[148:149], v22 offset:25728
v_mfma_f32_16x16x32_bf16 v[100:103], v[128:131], v[60:63], v[100:103]
ds_read_b64_tr_b16 v[150:151], v22 offset:27008
s_waitcnt lgkmcnt(0)
s_barrier
s_waitcnt vmcnt(16)
v_mfma_f32_16x16x32_bf16 v[64:67], v[132:135], v[152:155], v[64:67]
ds_read_b64_tr_b16 v[112:113], v22 offset:40960
v_mfma_f32_16x16x32_bf16 v[68:71], v[132:135], v[156:159], v[68:71]
ds_read_b64_tr_b16 v[114:115], v22 offset:42240
v_mfma_f32_16x16x32_bf16 v[72:75], v[136:139], v[152:155], v[72:75]
ds_read_b64_tr_b16 v[116:117], v22 offset:40992
v_mfma_f32_16x16x32_bf16 v[76:79], v[136:139], v[156:159], v[76:79]
ds_read_b64_tr_b16 v[118:119], v22 offset:42272
v_mfma_f32_16x16x32_bf16 v[80:83], v[140:143], v[152:155], v[80:83]
ds_read_b64_tr_b16 v[120:121], v22 offset:41024
v_mfma_f32_16x16x32_bf16 v[84:87], v[140:143], v[156:159], v[84:87]
ds_read_b64_tr_b16 v[122:123], v22 offset:42304
v_mfma_f32_16x16x32_bf16 v[88:91], v[144:147], v[152:155], v[88:91]
ds_read_b64_tr_b16 v[124:125], v22 offset:41056
v_mfma_f32_16x16x32_bf16 v[92:95], v[144:147], v[156:159], v[92:95]
ds_read_b64_tr_b16 v[126:127], v22 offset:42336
v_mfma_f32_16x16x32_bf16 v[96:99], v[148:151], v[152:155], v[96:99]
ds_read_b64_tr_b16 v[128:129], v22 offset:41088
v_mfma_f32_16x16x32_bf16 v[100:103], v[148:151], v[156:159], v[100:103]
ds_read_b64_tr_b16 v[130:131], v22 offset:42368
s_waitcnt vmcnt(14)
s_waitcnt lgkmcnt(8)
v_mfma_f32_16x16x32_bf16 v[64:67], v[112:115], v[160:163], v[64:67]
ds_read_b64_tr_b16 v[132:133], v22 offset:46080
v_mfma_f32_16x16x32_bf16 v[68:71], v[112:115], v[164:167], v[68:71]
ds_read_b64_tr_b16 v[134:135], v22 offset:47360
s_waitcnt lgkmcnt(8)
v_mfma_f32_16x16x32_bf16 v[72:75], v[116:119], v[160:163], v[72:75]
ds_read_b64_tr_b16 v[136:137], v22 offset:46112
v_mfma_f32_16x16x32_bf16 v[76:79], v[116:119], v[164:167], v[76:79]
ds_read_b64_tr_b16 v[138:139], v22 offset:47392
s_waitcnt lgkmcnt(8)
v_mfma_f32_16x16x32_bf16 v[80:83], v[120:123], v[160:163], v[80:83]
ds_read_b64_tr_b16 v[140:141], v22 offset:46144
v_mfma_f32_16x16x32_bf16 v[84:87], v[120:123], v[164:167], v[84:87]
ds_read_b64_tr_b16 v[142:143], v22 offset:47424
s_waitcnt lgkmcnt(8)
v_mfma_f32_16x16x32_bf16 v[88:91], v[124:127], v[160:163], v[88:91]
ds_read_b64_tr_b16 v[144:145], v22 offset:46176
v_mfma_f32_16x16x32_bf16 v[92:95], v[124:127], v[164:167], v[92:95]
ds_read_b64_tr_b16 v[146:147], v22 offset:47456
s_waitcnt lgkmcnt(8)
v_mfma_f32_16x16x32_bf16 v[96:99], v[128:131], v[160:163], v[96:99]
ds_read_b64_tr_b16 v[148:149], v22 offset:46208
v_mfma_f32_16x16x32_bf16 v[100:103], v[128:131], v[164:167], v[100:103]
ds_read_b64_tr_b16 v[150:151], v22 offset:47488
s_waitcnt vmcnt(12)
s_waitcnt lgkmcnt(8)
v_mfma_f32_16x16x32_bf16 v[64:67], v[132:135], v[168:171], v[64:67]
ds_read_b64_tr_b16 v[112:113], v23 offset:0
v_mfma_f32_16x16x32_bf16 v[68:71], v[132:135], v[172:175], v[68:71]
ds_read_b64_tr_b16 v[114:115], v23 offset:1280
s_waitcnt lgkmcnt(8)
v_mfma_f32_16x16x32_bf16 v[72:75], v[136:139], v[168:171], v[72:75]
ds_read_b64_tr_b16 v[116:117], v23 offset:32
v_mfma_f32_16x16x32_bf16 v[76:79], v[136:139], v[172:175], v[76:79]
ds_read_b64_tr_b16 v[118:119], v23 offset:1312
s_waitcnt lgkmcnt(8)
v_mfma_f32_16x16x32_bf16 v[80:83], v[140:143], v[168:171], v[80:83]
ds_read_b64_tr_b16 v[120:121], v23 offset:64
v_mfma_f32_16x16x32_bf16 v[84:87], v[140:143], v[172:175], v[84:87]
ds_read_b64_tr_b16 v[122:123], v23 offset:1344
s_waitcnt lgkmcnt(8)
v_mfma_f32_16x16x32_bf16 v[88:91], v[144:147], v[168:171], v[88:91]
ds_read_b64_tr_b16 v[124:125], v23 offset:96
v_mfma_f32_16x16x32_bf16 v[92:95], v[144:147], v[172:175], v[92:95]
ds_read_b64_tr_b16 v[126:127], v23 offset:1376
s_waitcnt lgkmcnt(8)
v_mfma_f32_16x16x32_bf16 v[96:99], v[148:151], v[168:171], v[96:99]
ds_read_b64_tr_b16 v[128:129], v23 offset:128
v_mfma_f32_16x16x32_bf16 v[100:103], v[148:151], v[172:175], v[100:103]
ds_read_b64_tr_b16 v[130:131], v23 offset:1408
s_waitcnt vmcnt(10)
s_waitcnt lgkmcnt(8)
v_mfma_f32_16x16x32_bf16 v[64:67], v[112:115], v[176:179], v[64:67]
ds_read_b64_tr_b16 v[132:133], v23 offset:5120
v_mfma_f32_16x16x32_bf16 v[68:71], v[112:115], v[180:183], v[68:71]
v_add_f32 v30, v30, v31
ds_read_b64_tr_b16 v[134:135], v23 offset:6400
s_waitcnt lgkmcnt(8)
v_mfma_f32_16x16x32_bf16 v[72:75], v[116:119], v[176:179], v[72:75]
s_lshl_b32 s53, s36, 7
ds_read_b64_tr_b16 v[136:137], v23 offset:5152
v_mfma_f32_16x16x32_bf16 v[76:79], v[116:119], v[180:183], v[76:79]
v_mov_b32 v31, v30
ds_read_b64_tr_b16 v[138:139], v23 offset:6432
s_waitcnt lgkmcnt(8)
v_mfma_f32_16x16x32_bf16 v[80:83], v[120:123], v[176:179], v[80:83]
v_add_u32 v6, s53, v25
ds_read_b64_tr_b16 v[140:141], v23 offset:5184
v_mfma_f32_16x16x32_bf16 v[84:87], v[120:123], v[180:183], v[84:87]
v_mul_u32_u24 v6, 1280, v6
ds_read_b64_tr_b16 v[142:143], v23 offset:6464
s_waitcnt lgkmcnt(8)
v_mfma_f32_16x16x32_bf16 v[88:91], v[124:127], v[176:179], v[88:91]
ds_read_b64_tr_b16 v[144:145], v23 offset:5216
v_mfma_f32_16x16x32_bf16 v[92:95], v[124:127], v[180:183], v[92:95]
ds_read_b64_tr_b16 v[146:147], v23 offset:6496
s_waitcnt lgkmcnt(8)
v_mfma_f32_16x16x32_bf16 v[96:99], v[128:131], v[176:179], v[96:99]
ds_read_b64_tr_b16 v[148:149], v23 offset:5248
v_mfma_f32_16x16x32_bf16 v[100:103], v[128:131], v[180:183], v[100:103]
ds_read_b64_tr_b16 v[150:151], v23 offset:6528
s_waitcnt lgkmcnt(0)
s_barrier
s_waitcnt vmcnt(8)
v_mfma_f32_16x16x32_bf16 v[64:67], v[132:135], v[184:187], v[64:67]
ds_read_b64_tr_b16 v[112:113], v23 offset:20480
v_mfma_f32_16x16x32_bf16 v[68:71], v[132:135], v[188:191], v[68:71]
v_permlane32_swap_b32 v30, v31
ds_read_b64_tr_b16 v[114:115], v23 offset:21760
v_mfma_f32_16x16x32_bf16 v[72:75], v[136:139], v[184:187], v[72:75]
v_and_b32 v4, 1, v3
ds_read_b64_tr_b16 v[116:117], v23 offset:20512
v_mfma_f32_16x16x32_bf16 v[76:79], v[136:139], v[188:191], v[76:79]
v_lshrrev_b32 v5, 1, v3
ds_read_b64_tr_b16 v[118:119], v23 offset:21792
v_mfma_f32_16x16x32_bf16 v[80:83], v[140:143], v[184:187], v[80:83]
v_add_f32 v30, v30, v31
ds_read_b64_tr_b16 v[120:121], v23 offset:20544
v_mfma_f32_16x16x32_bf16 v[84:87], v[140:143], v[188:191], v[84:87]
v_lshl_add_u32 v4, v4, 1, v5
ds_read_b64_tr_b16 v[122:123], v23 offset:21824
v_mfma_f32_16x16x32_bf16 v[88:91], v[144:147], v[184:187], v[88:91]
ds_read_b64_tr_b16 v[124:125], v23 offset:20576
v_mfma_f32_16x16x32_bf16 v[92:95], v[144:147], v[188:191], v[92:95]
ds_read_b64_tr_b16 v[126:127], v23 offset:21856
v_mfma_f32_16x16x32_bf16 v[96:99], v[148:151], v[184:187], v[96:99]
ds_read_b64_tr_b16 v[128:129], v23 offset:20608
v_mfma_f32_16x16x32_bf16 v[100:103], v[148:151], v[188:191], v[100:103]
ds_read_b64_tr_b16 v[130:131], v23 offset:21888
s_waitcnt vmcnt(6)
s_waitcnt lgkmcnt(8)
v_mfma_f32_16x16x32_bf16 v[64:67], v[112:115], v[192:195], v[64:67]
ds_read_b64_tr_b16 v[132:133], v23 offset:25600
v_mfma_f32_16x16x32_bf16 v[68:71], v[112:115], v[196:199], v[68:71]
v_mov_b32 v31, v30
ds_read_b64_tr_b16 v[134:135], v23 offset:26880
s_waitcnt lgkmcnt(8)
v_mfma_f32_16x16x32_bf16 v[72:75], v[116:119], v[192:195], v[72:75]
v_lshl_add_u32 v8, v4, 4, v6
ds_read_b64_tr_b16 v[136:137], v23 offset:25632
v_mfma_f32_16x16x32_bf16 v[76:79], v[116:119], v[196:199], v[76:79]
v_lshl_add_u32 v9, v5, 4, v6
ds_read_b64_tr_b16 v[138:139], v23 offset:26912
s_waitcnt lgkmcnt(8)
v_mfma_f32_16x16x32_bf16 v[80:83], v[120:123], v[192:195], v[80:83]
v_permlane16_swap_b32 v30, v31
ds_read_b64_tr_b16 v[140:141], v23 offset:25664
v_mfma_f32_16x16x32_bf16 v[84:87], v[120:123], v[196:199], v[84:87]
s_mul_i32 s66, s46, 160
ds_read_b64_tr_b16 v[142:143], v23 offset:26944
s_waitcnt lgkmcnt(8)
v_mfma_f32_16x16x32_bf16 v[88:91], v[124:127], v[192:195], v[88:91]
ds_read_b64_tr_b16 v[144:145], v23 offset:25696
v_mfma_f32_16x16x32_bf16 v[92:95], v[124:127], v[196:199], v[92:95]
ds_read_b64_tr_b16 v[146:147], v23 offset:26976
s_waitcnt lgkmcnt(8)
v_mfma_f32_16x16x32_bf16 v[96:99], v[128:131], v[192:195], v[96:99]
ds_read_b64_tr_b16 v[148:149], v23 offset:25728
v_mfma_f32_16x16x32_bf16 v[100:103], v[128:131], v[196:199], v[100:103]
ds_read_b64_tr_b16 v[150:151], v23 offset:27008
s_waitcnt vmcnt(4)
s_waitcnt lgkmcnt(8)
v_mfma_f32_16x16x32_bf16 v[64:67], v[132:135], v[200:203], v[64:67]
ds_read_b64_tr_b16 v[112:113], v21 offset:0
v_mfma_f32_16x16x32_bf16 v[68:71], v[132:135], v[204:207], v[68:71]
s_nop 0
ds_read_b64_tr_b16 v[114:115], v21 offset:1280
s_waitcnt lgkmcnt(8)
v_mfma_f32_16x16x32_bf16 v[72:75], v[136:139], v[200:203], v[72:75]
v_add_f32 v30, v30, v31
ds_read_b64_tr_b16 v[116:117], v21 offset:32
v_mfma_f32_16x16x32_bf16 v[76:79], v[136:139], v[204:207], v[76:79]
v_mul_f32 v30, 0x3acccccd, v30
ds_read_b64_tr_b16 v[118:119], v21 offset:1312
s_waitcnt lgkmcnt(8)
v_mfma_f32_16x16x32_bf16 v[80:83], v[140:143], v[200:203], v[80:83]
v_add_f32 v30, 0x3727c5ac, v30
ds_read_b64_tr_b16 v[120:121], v21 offset:64
v_mfma_f32_16x16x32_bf16 v[84:87], v[140:143], v[204:207], v[84:87]
v_rsq_f32 v30, v30
ds_read_b64_tr_b16 v[122:123], v21 offset:1344
s_waitcnt lgkmcnt(8)
v_mfma_f32_16x16x32_bf16 v[88:91], v[144:147], v[200:203], v[88:91]
ds_read_b64_tr_b16 v[124:125], v21 offset:96
v_mfma_f32_16x16x32_bf16 v[92:95], v[144:147], v[204:207], v[92:95]
ds_read_b64_tr_b16 v[126:127], v21 offset:1376
s_waitcnt lgkmcnt(8)
v_mfma_f32_16x16x32_bf16 v[96:99], v[148:151], v[200:203], v[96:99]
ds_read_b64_tr_b16 v[128:129], v21 offset:128
v_mfma_f32_16x16x32_bf16 v[100:103], v[148:151], v[204:207], v[100:103]
ds_read_b64_tr_b16 v[130:131], v21 offset:1408
s_waitcnt vmcnt(2)
s_waitcnt lgkmcnt(8)
v_mfma_f32_16x16x32_bf16 v[64:67], v[112:115], v[208:211], v[64:67]
ds_read_b64_tr_b16 v[132:133], v21 offset:5120
v_mfma_f32_16x16x32_bf16 v[68:71], v[112:115], v[212:215], v[68:71]
s_mul_i32 s65, s38, 5120
ds_read_b64_tr_b16 v[134:135], v21 offset:6400
s_waitcnt lgkmcnt(8)
v_mfma_f32_16x16x32_bf16 v[72:75], v[116:119], v[208:211], v[72:75]
v_lshlrev_b32 v26, 4, v1
ds_read_b64_tr_b16 v[136:137], v21 offset:5152
v_mfma_f32_16x16x32_bf16 v[76:79], v[116:119], v[212:215], v[76:79]
v_add_u32 v26, s65, v26
ds_read_b64_tr_b16 v[138:139], v21 offset:6432
s_waitcnt lgkmcnt(8)
v_mfma_f32_16x16x32_bf16 v[80:83], v[120:123], v[208:211], v[80:83]
s_xor_b32 s65, s38, 2
ds_read_b64_tr_b16 v[140:141], v21 offset:5184
v_mfma_f32_16x16x32_bf16 v[84:87], v[120:123], v[212:215], v[84:87]
s_mul_i32 s65, s65, 5120
ds_read_b64_tr_b16 v[142:143], v21 offset:6464
s_waitcnt lgkmcnt(8)
v_mfma_f32_16x16x32_bf16 v[88:91], v[124:127], v[208:211], v[88:91]
ds_read_b64_tr_b16 v[144:145], v21 offset:5216
v_mfma_f32_16x16x32_bf16 v[92:95], v[124:127], v[212:215], v[92:95]
ds_read_b64_tr_b16 v[146:147], v21 offset:6496
s_waitcnt lgkmcnt(8)
v_mfma_f32_16x16x32_bf16 v[96:99], v[128:131], v[208:211], v[96:99]
ds_read_b64_tr_b16 v[148:149], v21 offset:5248
v_mfma_f32_16x16x32_bf16 v[100:103], v[128:131], v[212:215], v[100:103]
ds_read_b64_tr_b16 v[150:151], v21 offset:6528
s_waitcnt vmcnt(0)
s_waitcnt lgkmcnt(8)
v_mfma_f32_16x16x32_bf16 v[64:67], v[132:135], v[216:219], v[64:67]
v_mfma_f32_16x16x32_bf16 v[68:71], v[132:135], v[220:223], v[68:71]
s_waitcnt lgkmcnt(6)
v_mfma_f32_16x16x32_bf16 v[72:75], v[136:139], v[216:219], v[72:75]
v_lshlrev_b32 v28, 4, v1
v_mfma_f32_16x16x32_bf16 v[76:79], v[136:139], v[220:223], v[76:79]
s_waitcnt lgkmcnt(4)
v_mfma_f32_16x16x32_bf16 v[80:83], v[140:143], v[216:219], v[80:83]
v_add_u32 v28, s65, v28
v_mfma_f32_16x16x32_bf16 v[84:87], v[140:143], v[220:223], v[84:87]
s_waitcnt lgkmcnt(2)
v_mfma_f32_16x16x32_bf16 v[88:91], v[144:147], v[216:219], v[88:91]
v_mfma_f32_16x16x32_bf16 v[92:95], v[144:147], v[220:223], v[92:95]
s_waitcnt lgkmcnt(0)
v_mfma_f32_16x16x32_bf16 v[96:99], v[148:151], v[216:219], v[96:99]
v_mfma_f32_16x16x32_bf16 v[100:103], v[148:151], v[220:223], v[100:103]
s_waitcnt lgkmcnt(0)
s_barrier
s_nop 3
s_cmp_lg_u32 s48, 0
s_cbranch_scc1 L_keep1_14
ds_write_b128 v26, v[68:71] offset:0
ds_write_b128 v26, v[76:79] offset:1024
ds_write_b128 v26, v[84:87] offset:2048
ds_write_b128 v26, v[92:95] offset:3072
ds_write_b128 v26, v[100:103] offset:4096
s_branch L_kdone_15
L_keep1_14:
ds_write_b128 v26, v[64:67] offset:0
ds_write_b128 v26, v[72:75] offset:1024
ds_write_b128 v26, v[80:83] offset:2048
ds_write_b128 v26, v[88:91] offset:3072
ds_write_b128 v26, v[96:99] offset:4096
s_waitcnt lgkmcnt(0)
v_mov_b32 v64, v68
v_mov_b32 v65, v69
v_mov_b32 v66, v70
v_mov_b32 v67, v71
v_mov_b32 v72, v76
v_mov_b32 v73, v77
v_mov_b32 v74, v78
v_mov_b32 v75, v79
v_mov_b32 v80, v84
v_mov_b32 v81, v85
v_mov_b32 v82, v86
v_mov_b32 v83, v87
v_mov_b32 v88, v92
v_mov_b32 v89, v93
v_mov_b32 v90, v94
v_mov_b32 v91, v95
v_mov_b32 v96, v100
v_mov_b32 v97, v101
v_mov_b32 v98, v102
v_mov_b32 v99, v103
L_kdone_15:
s_waitcnt lgkmcnt(0)
s_barrier
ds_read_b128 v[68:71], v28 offset:0
ds_read_b128 v[76:79], v28 offset:1024
ds_read_b128 v[84:87], v28 offset:2048
ds_read_b128 v[92:95], v28 offset:3072
ds_read_b128 v[100:103], v28 offset:4096
s_waitcnt lgkmcnt(0)
v_pk_add_f32 v[64:65], v[64:65], v[68:69]
v_pk_add_f32 v[66:67], v[66:67], v[70:71]
v_pk_add_f32 v[72:73], v[72:73], v[76:77]
v_pk_add_f32 v[74:75], v[74:75], v[78:79]
v_pk_add_f32 v[80:81], v[80:81], v[84:85]
v_pk_add_f32 v[82:83], v[82:83], v[86:87]
v_pk_add_f32 v[88:89], v[88:89], v[92:93]
v_pk_add_f32 v[90:91], v[90:91], v[94:95]
v_pk_add_f32 v[96:97], v[96:97], v[100:101]
v_pk_add_f32 v[98:99], v[98:99], v[102:103]
v_lshlrev_b32 v4, 16, v240
v_and_b32 v5, 0xffff0000, v240
v_pk_fma_f32 v[64:65], v[64:65], v[30:31], v[4:5] op_sel_hi:[1,0,1]
v_lshlrev_b32 v4, 16, v241
v_and_b32 v5, 0xffff0000, v241
v_pk_fma_f32 v[66:67], v[66:67], v[30:31], v[4:5] op_sel_hi:[1,0,1]
v_cvt_pk_bf16_f32 v112, v64, v65
v_cvt_pk_bf16_f32 v113, v66, v67
v_lshlrev_b32 v4, 16, v242
v_and_b32 v5, 0xffff0000, v242
v_pk_fma_f32 v[72:73], v[72:73], v[30:31], v[4:5] op_sel_hi:[1,0,1]
v_lshlrev_b32 v4, 16, v243
v_and_b32 v5, 0xffff0000, v243
v_pk_fma_f32 v[74:75], v[74:75], v[30:31], v[4:5] op_sel_hi:[1,0,1]
v_cvt_pk_bf16_f32 v114, v72, v73
v_cvt_pk_bf16_f32 v115, v74, v75
v_lshlrev_b32 v4, 16, v244
v_and_b32 v5, 0xffff0000, v244
v_pk_fma_f32 v[80:81], v[80:81], v[30:31], v[4:5] op_sel_hi:[1,0,1]
v_lshlrev_b32 v4, 16, v245
v_and_b32 v5, 0xffff0000, v245
v_pk_fma_f32 v[82:83], v[82:83], v[30:31], v[4:5] op_sel_hi:[1,0,1]
v_cvt_pk_bf16_f32 v116, v80, v81
v_cvt_pk_bf16_f32 v117, v82, v83
v_lshlrev_b32 v4, 16, v246
v_and_b32 v5, 0xffff0000, v246
v_pk_fma_f32 v[88:89], v[88:89], v[30:31], v[4:5] op_sel_hi:[1,0,1]
v_lshlrev_b32 v4, 16, v247
v_and_b32 v5, 0xffff0000, v247
v_pk_fma_f32 v[90:91], v[90:91], v[30:31], v[4:5] op_sel_hi:[1,0,1]
v_cvt_pk_bf16_f32 v118, v88, v89
v_cvt_pk_bf16_f32 v119, v90, v91
v_lshlrev_b32 v4, 16, v248
v_and_b32 v5, 0xffff0000, v248
v_pk_fma_f32 v[96:97], v[96:97], v[30:31], v[4:5] op_sel_hi:[1,0,1]
v_lshlrev_b32 v4, 16, v249
v_and_b32 v5, 0xffff0000, v249
v_pk_fma_f32 v[98:99], v[98:99], v[30:31], v[4:5] op_sel_hi:[1,0,1]
v_cvt_pk_bf16_f32 v120, v96, v97
v_cvt_pk_bf16_f32 v121, v98, v99
v_mov_b32 v122, v120
v_mov_b32 v123, v121
s_nop 1
v_permlane16_swap_b32 v112, v114
v_permlane16_swap_b32 v113, v115
v_permlane16_swap_b32 v116, v118
v_permlane16_swap_b32 v117, v119
v_permlane16_swap_b32 v120, v122
v_permlane16_swap_b32 v121, v123
buffer_store_dwordx4 v[112:115], v8, s[16:19], s66 offen
buffer_store_dwordx4 v[116:119], v8, s[16:19], s66 offen offset:64
buffer_store_dwordx4 v[120:123], v9, s[16:19], s66 offen offset:128
s_waitcnt vmcnt(0)
s_endpgm
L_dma:
s_sub_u32 s50, s38, 4
v_lshlrev_b32 v35, 4, v1
s_mul_i32 s51, s50, 3
s_lshl_b32 s42, s51, 3
v_lshrrev_b32 v4, 3, v1
v_and_b32 v5, 7, v1
v_add_u32 v6, s42, v4
v_bfe_u32 v7, v6, 1, 3
v_xor_b32 v7, v7, v5
v_lshlrev_b32 v7, 4, v7
v_xor_b32 v8, 64, v7
s_lshl_b32 s43, s36, 7
s_sub_u32 s43, s43, 16
v_add_u32 v6, s43, v6
s_movk_i32 s44, 1280
v_add_u32 v9, 0, v6
v_max_i32 v9, 0, v9
v_mad_u32_u24 v36, v9, s44, v7
v_add_u32 v9, 8, v6
v_max_i32 v9, 0, v9
v_mad_u32_u24 v37, v9, s44, v8
v_add_u32 v9, 16, v6
v_max_i32 v9, 0, v9
v_mad_u32_u24 v38, v9, s44, v7
s_lshl_b32 s92, s51, 10
s_cmp_eq_u32 s50, 0
s_cselect_b32 s59, 0xffffff00, -1
v_lshlrev_b32 v6, 1, v3
v_xor_b32 v6, v6, v2
v_xor_b32 v7, 8, v6
s_movk_i32 s45, 3840
v_min_u32 v6, 14, v6
v_mul_u32_u24 v8, 52, v6
v_lshrrev_b32 v8, 8, v8
v_mul_u32_u24 v8, 1200, v8
v_lshl_add_u32 v6, v6, 4, v8
v_mad_u32_u24 v25, v3, s45, v6
v_min_u32 v7, 14, v7
v_mul_u32_u24 v8, 52, v7
v_lshrrev_b32 v8, 8, v8
v_mul_u32_u24 v8, 1200, v8
v_lshl_add_u32 v7, v7, 4, v8
v_mad_u32_u24 v26, v3, s45, v7
s_lshl_b32 s93, s50, 13
s_add_u32 s93, s93, 36864
s_mul_i32 s94, s37, 80
s_mul_i32 s42, s50, 122880
s_add_u32 s94, s94, s42
s_lshr_b32 s42, s36, 3
s_mul_i32 s42, s42, 5
s_add_u32 s42, s42, s37
s_and_b32 s43, s36, 7
s_add_u32 s42, s42, s43
s_mul_i32 s43, s42, 26
s_lshr_b32 s43, s43, 8
s_mul_i32 s43, s43, 10
s_sub_u32 s95, s42, s43
s_waitcnt lgkmcnt(0)
s_mov_b32 s4, s68
s_mov_b32 s5, s69
s_mov_b32 s6, 0x280000
s_mov_b32 s7, 0x20000
s_mov_b32 s8, s70
s_mov_b32 s9, s71
s_mov_b32 s10, 0x258000
s_mov_b32 s11, 0x20000
s_mov_b32 s12, s86
s_mov_b32 s13, s87
s_mov_b32 s14, 0x3000000
s_mov_b32 s15, 0x20000
s_mov_b32 s20, s84
s_mov_b32 s21, s85
s_mov_b32 s22, 0x100
s_mov_b32 s23, 0x20000
s_mov_b32 s16, s82
s_mov_b32 s17, s83
s_mov_b32 s18, 0x280000
s_mov_b32 s19, 0x20000
s_lshl_b32 s48, s95, 7
s_mul_i32 s49, s95, 245760
s_add_u32 s49, s49, s94
s_add_u32 s95, s95, 1
s_cmp_eq_u32 s95, 10
s_cselect_b32 s95, 0, s95
s_add_u32 m0, s92, 0
s_mov_b32 exec_lo, s59
buffer_load_dwordx4 v36, s[4:7], s48 offen lds
s_mov_b32 exec_lo, -1
s_add_u32 m0, s92, 1024
s_nop 0
buffer_load_dwordx4 v37, s[4:7], s48 offen lds
s_add_u32 m0, s92, 2048
s_nop 0
buffer_load_dwordx4 v38, s[4:7], s48 offen lds
s_add_u32 m0, s93, 0
s_nop 0
buffer_load_dwordx4 v25, s[8:11], s49 offen lds
s_add_u32 m0, s93, 1024
s_add_u32 s61, s49, 15360
buffer_load_dwordx4 v25, s[8:11], s61 offen lds
s_add_u32 m0, s93, 2048
s_add_u32 s61, s49, 30720
buffer_load_dwordx4 v26, s[8:11], s61 offen lds
s_add_u32 m0, s93, 3072
s_add_u32 s61, s49, 46080
buffer_load_dwordx4 v26, s[8:11], s61 offen lds
s_add_u32 m0, s93, 4096
s_add_u32 s61, s49, 61440
buffer_load_dwordx4 v25, s[8:11], s61 offen lds
s_add_u32 m0, s93, 5120
s_add_u32 s61, s49, 76800
buffer_load_dwordx4 v25, s[8:11], s61 offen lds
s_add_u32 m0, s93, 6144
s_add_u32 s61, s49, 92160
buffer_load_dwordx4 v26, s[8:11], s61 offen lds
s_add_u32 m0, s93, 7168
s_add_u32 s61, s49, 107520
buffer_load_dwordx4 v26, s[8:11], s61 offen lds
s_mov_b32 s88, s72
s_mov_b32 s89, s73
s_mov_b32 s90, 0xc8000
s_mov_b32 s91, 0x20000
v_add_u32 v4, 0, v1
v_mul_u32_u24 v5, 6554, v4
v_lshrrev_b32 v6, 16, v5
v_mul_u32_u24 v5, 10, v6
v_sub_u32 v7, v4, v5
v_and_b32 v8, 0x13, v6
v_bfe_u32 v9, v6, 2, 1
v_lshl_or_b32 v8, v9, 3, v8
v_bfe_u32 v9, v6, 3, 1
v_lshl_or_b32 v8, v9, 2, v8
v_mul_u32_u24 v8, 1280, v8
v_lshl_add_u32 v27, v7, 4, v8
v_add_u32 v4, 64, v1
v_mul_u32_u24 v5, 6554, v4
v_lshrrev_b32 v6, 16, v5
v_mul_u32_u24 v5, 10, v6
v_sub_u32 v7, v4, v5
v_and_b32 v8, 0x13, v6
v_bfe_u32 v9, v6, 2, 1
v_lshl_or_b32 v8, v9, 3, v8
v_bfe_u32 v9, v6, 3, 1
v_lshl_or_b32 v8, v9, 2, v8
v_mul_u32_u24 v8, 1280, v8
v_lshl_add_u32 v28, v7, 4, v8
v_add_u32 v4, 128, v1
v_mul_u32_u24 v5, 6554, v4
v_lshrrev_b32 v6, 16, v5
v_mul_u32_u24 v5, 10, v6
v_sub_u32 v7, v4, v5
v_and_b32 v8, 0x13, v6
v_bfe_u32 v9, v6, 2, 1
v_lshl_or_b32 v8, v9, 3, v8
v_bfe_u32 v9, v6, 3, 1
v_lshl_or_b32 v8, v9, 2, v8
v_mul_u32_u24 v8, 1280, v8
v_lshl_add_u32 v29, v7, 4, v8
v_add_u32 v4, 192, v1
v_mul_u32_u24 v5, 6554, v4
v_lshrrev_b32 v6, 16, v5
v_mul_u32_u24 v5, 10, v6
v_sub_u32 v7, v4, v5
v_and_b32 v8, 0x13, v6
v_bfe_u32 v9, v6, 2, 1
v_lshl_or_b32 v8, v9, 3, v8
v_bfe_u32 v9, v6, 3, 1
v_lshl_or_b32 v8, v9, 2, v8
v_mul_u32_u24 v8, 1280, v8
v_lshl_add_u32 v30, v7, 4, v8
v_add_u32 v4, 256, v1
v_mul_u32_u24 v5, 6554, v4
v_lshrrev_b32 v6, 16, v5
v_mul_u32_u24 v5, 10, v6
v_sub_u32 v7, v4, v5
v_and_b32 v8, 0x13, v6
v_bfe_u32 v9, v6, 2, 1
v_lshl_or_b32 v8, v9, 3, v8
v_bfe_u32 v9, v6, 3, 1
v_lshl_or_b32 v8, v9, 2, v8
v_mul_u32_u24 v8, 1280, v8
v_lshl_add_u32 v31, v7, 4, v8
s_and_b32 s57, s37, 7
s_mul_i32 s57, s57, 160
s_mul_i32 s56, s50, 40960
s_add_u32 s57, s57, s56
s_mul_i32 s56, s50, 5120
s_add_u32 s56, s56, 61440
s_waitcnt vmcnt(0)
s_barrier
s_lshl_b32 s48, s95, 7
s_mul_i32 s49, s95, 245760
s_add_u32 s49, s49, s94
s_add_u32 s95, s95, 1
s_cmp_eq_u32 s95, 10
s_cselect_b32 s95, 0, s95
s_add_u32 m0, s92, 18432
s_mov_b32 exec_lo, s59
buffer_load_dwordx4 v36, s[4:7], s48 offen lds
s_mov_b32 exec_lo, -1
s_add_u32 m0, s92, 19456
s_nop 0
buffer_load_dwordx4 v37, s[4:7], s48 offen lds
s_add_u32 m0, s92, 20480
s_nop 0
buffer_load_dwordx4 v38, s[4:7], s48 offen lds
s_add_u32 m0, s93, 16384
s_nop 0
buffer_load_dwordx4 v25, s[8:11], s49 offen lds
s_add_u32 m0, s93, 17408
s_add_u32 s61, s49, 15360
buffer_load_dwordx4 v25, s[8:11], s61 offen lds
s_add_u32 m0, s93, 18432
s_add_u32 s61, s49, 30720
buffer_load_dwordx4 v26, s[8:11], s61 offen lds
s_add_u32 m0, s93, 19456
s_add_u32 s61, s49, 46080
buffer_load_dwordx4 v26, s[8:11], s61 offen lds
s_add_u32 m0, s93, 20480
s_add_u32 s61, s49, 61440
buffer_load_dwordx4 v25, s[8:11], s61 offen lds
s_add_u32 m0, s93, 21504
s_add_u32 s61, s49, 76800
buffer_load_dwordx4 v25, s[8:11], s61 offen lds
s_add_u32 m0, s93, 22528
s_add_u32 s61, s49, 92160
buffer_load_dwordx4 v26, s[8:11], s61 offen lds
s_add_u32 m0, s93, 23552
s_add_u32 s61, s49, 107520
buffer_load_dwordx4 v26, s[8:11], s61 offen lds
s_lshl_b32 s48, s95, 7
s_mul_i32 s49, s95, 245760
s_add_u32 s49, s49, s94
s_add_u32 s95, s95, 1
s_cmp_eq_u32 s95, 10
s_cselect_b32 s95, 0, s95
s_add_u32 m0, s92, 102400
s_mov_b32 exec_lo, s59
buffer_load_dwordx4 v36, s[4:7], s48 offen lds
s_mov_b32 exec_lo, -1
s_add_u32 m0, s92, 103424
s_nop 0
buffer_load_dwordx4 v37, s[4:7], s48 offen lds
s_add_u32 m0, s92, 104448
s_nop 0
buffer_load_dwordx4 v38, s[4:7], s48 offen lds
s_add_u32 m0, s93, 32768
s_nop 0
buffer_load_dwordx4 v25, s[8:11], s49 offen lds
s_add_u32 m0, s93, 33792
s_add_u32 s61, s49, 15360
buffer_load_dwordx4 v25, s[8:11], s61 offen lds
s_add_u32 m0, s93, 34816
s_add_u32 s61, s49, 30720
buffer_load_dwordx4 v26, s[8:11], s61 offen lds
s_add_u32 m0, s93, 35840
s_add_u32 s61, s49, 46080
buffer_load_dwordx4 v26, s[8:11], s61 offen lds
s_add_u32 m0, s93, 36864
s_add_u32 s61, s49, 61440
buffer_load_dwordx4 v25, s[8:11], s61 offen lds
s_add_u32 m0, s93, 37888
s_add_u32 s61, s49, 76800
buffer_load_dwordx4 v25, s[8:11], s61 offen lds
s_add_u32 m0, s93, 38912
s_add_u32 s61, s49, 92160
buffer_load_dwordx4 v26, s[8:11], s61 offen lds
s_add_u32 m0, s93, 39936
s_add_u32 s61, s49, 107520
buffer_load_dwordx4 v26, s[8:11], s61 offen lds
s_waitcnt vmcnt(11)
s_barrier
s_lshl_b32 s48, s95, 7
s_mul_i32 s49, s95, 245760
s_add_u32 s49, s49, s94
s_add_u32 s95, s95, 1
s_cmp_eq_u32 s95, 10
s_cselect_b32 s95, 0, s95
s_add_u32 m0, s92, 120832
s_mov_b32 exec_lo, s59
buffer_load_dwordx4 v36, s[4:7], s48 offen lds
s_mov_b32 exec_lo, -1
s_add_u32 m0, s92, 121856
s_nop 0
buffer_load_dwordx4 v37, s[4:7], s48 offen lds
s_add_u32 m0, s92, 122880
s_nop 0
buffer_load_dwordx4 v38, s[4:7], s48 offen lds
s_add_u32 m0, s93, 49152
s_nop 0
buffer_load_dwordx4 v25, s[8:11], s49 offen lds
s_add_u32 m0, s93, 50176
s_add_u32 s61, s49, 15360
buffer_load_dwordx4 v25, s[8:11], s61 offen lds
s_add_u32 m0, s93, 51200
s_add_u32 s61, s49, 30720
buffer_load_dwordx4 v26, s[8:11], s61 offen lds
s_add_u32 m0, s93, 52224
s_add_u32 s61, s49, 46080
buffer_load_dwordx4 v26, s[8:11], s61 offen lds
s_add_u32 m0, s93, 53248
s_add_u32 s61, s49, 61440
buffer_load_dwordx4 v25, s[8:11], s61 offen lds
s_add_u32 m0, s93, 54272
s_add_u32 s61, s49, 76800
buffer_load_dwordx4 v25, s[8:11], s61 offen lds
s_add_u32 m0, s93, 55296
s_add_u32 s61, s49, 92160
buffer_load_dwordx4 v26, s[8:11], s61 offen lds
s_add_u32 m0, s93, 56320
s_add_u32 s61, s49, 107520
buffer_load_dwordx4 v26, s[8:11], s61 offen lds
s_waitcnt vmcnt(11)
s_barrier
s_lshl_b32 s48, s95, 7
s_mul_i32 s49, s95, 245760
s_add_u32 s49, s49, s94
s_add_u32 s95, s95, 1
s_cmp_eq_u32 s95, 10
s_cselect_b32 s95, 0, s95
s_add_u32 m0, s92, 0
s_mov_b32 exec_lo, s59
buffer_load_dwordx4 v36, s[4:7], s48 offen lds
s_mov_b32 exec_lo, -1
s_add_u32 m0, s92, 1024
s_nop 0
buffer_load_dwordx4 v37, s[4:7], s48 offen lds
s_add_u32 m0, s92, 2048
s_nop 0
buffer_load_dwordx4 v38, s[4:7], s48 offen lds
s_add_u32 m0, s93, 0
s_nop 0
buffer_load_dwordx4 v25, s[8:11], s49 offen lds
s_add_u32 m0, s93, 1024
s_add_u32 s61, s49, 15360
buffer_load_dwordx4 v25, s[8:11], s61 offen lds
s_add_u32 m0, s93, 2048
s_add_u32 s61, s49, 30720
buffer_load_dwordx4 v26, s[8:11], s61 offen lds
s_add_u32 m0, s93, 3072
s_add_u32 s61, s49, 46080
buffer_load_dwordx4 v26, s[8:11], s61 offen lds
s_add_u32 m0, s93, 4096
s_add_u32 s61, s49, 61440
buffer_load_dwordx4 v25, s[8:11], s61 offen lds
s_add_u32 m0, s93, 5120
s_add_u32 s61, s49, 76800
buffer_load_dwordx4 v25, s[8:11], s61 offen lds
s_add_u32 m0, s93, 6144
s_add_u32 s61, s49, 92160
buffer_load_dwordx4 v26, s[8:11], s61 offen lds
s_add_u32 m0, s93, 7168
s_add_u32 s61, s49, 107520
buffer_load_dwordx4 v26, s[8:11], s61 offen lds
s_waitcnt vmcnt(11)
s_barrier
s_lshl_b32 s48, s95, 7
s_mul_i32 s49, s95, 245760
s_add_u32 s49, s49, s94
s_add_u32 s95, s95, 1
s_cmp_eq_u32 s95, 10
s_cselect_b32 s95, 0, s95
s_add_u32 m0, s92, 18432
s_mov_b32 exec_lo, s59
buffer_load_dwordx4 v36, s[4:7], s48 offen lds
s_mov_b32 exec_lo, -1
s_add_u32 m0, s92, 19456
s_nop 0
buffer_load_dwordx4 v37, s[4:7], s48 offen lds
s_add_u32 m0, s92, 20480
s_nop 0
buffer_load_dwordx4 v38, s[4:7], s48 offen lds
s_add_u32 m0, s93, 16384
s_nop 0
buffer_load_dwordx4 v25, s[8:11], s49 offen lds
s_add_u32 m0, s93, 17408
s_add_u32 s61, s49, 15360
buffer_load_dwordx4 v25, s[8:11], s61 offen lds
s_add_u32 m0, s93, 18432
s_add_u32 s61, s49, 30720
buffer_load_dwordx4 v26, s[8:11], s61 offen lds
s_add_u32 m0, s93, 19456
s_add_u32 s61, s49, 46080
buffer_load_dwordx4 v26, s[8:11], s61 offen lds
s_add_u32 m0, s93, 20480
s_add_u32 s61, s49, 61440
buffer_load_dwordx4 v25, s[8:11], s61 offen lds
s_add_u32 m0, s93, 21504
s_add_u32 s61, s49, 76800
buffer_load_dwordx4 v25, s[8:11], s61 offen lds
s_add_u32 m0, s93, 22528
s_add_u32 s61, s49, 92160
buffer_load_dwordx4 v26, s[8:11], s61 offen lds
s_add_u32 m0, s93, 23552
s_add_u32 s61, s49, 107520
buffer_load_dwordx4 v26, s[8:11], s61 offen lds
s_waitcnt vmcnt(11)
s_barrier
s_lshl_b32 s48, s95, 7
s_mul_i32 s49, s95, 245760
s_add_u32 s49, s49, s94
s_add_u32 s95, s95, 1
s_cmp_eq_u32 s95, 10
s_cselect_b32 s95, 0, s95
s_add_u32 m0, s92, 102400
s_mov_b32 exec_lo, s59
buffer_load_dwordx4 v36, s[4:7], s48 offen lds
s_mov_b32 exec_lo, -1
s_add_u32 m0, s92, 103424
s_nop 0
buffer_load_dwordx4 v37, s[4:7], s48 offen lds
s_add_u32 m0, s92, 104448
s_nop 0
buffer_load_dwordx4 v38, s[4:7], s48 offen lds
s_add_u32 m0, s93, 32768
s_nop 0
buffer_load_dwordx4 v25, s[8:11], s49 offen lds
s_add_u32 m0, s93, 33792
s_add_u32 s61, s49, 15360
buffer_load_dwordx4 v25, s[8:11], s61 offen lds
s_add_u32 m0, s93, 34816
s_add_u32 s61, s49, 30720
buffer_load_dwordx4 v26, s[8:11], s61 offen lds
s_add_u32 m0, s93, 35840
s_add_u32 s61, s49, 46080
buffer_load_dwordx4 v26, s[8:11], s61 offen lds
s_add_u32 m0, s93, 36864
s_add_u32 s61, s49, 61440
buffer_load_dwordx4 v25, s[8:11], s61 offen lds
s_add_u32 m0, s93, 37888
s_add_u32 s61, s49, 76800
buffer_load_dwordx4 v25, s[8:11], s61 offen lds
s_add_u32 m0, s93, 38912
s_add_u32 s61, s49, 92160
buffer_load_dwordx4 v26, s[8:11], s61 offen lds
s_add_u32 m0, s93, 39936
s_add_u32 s61, s49, 107520
buffer_load_dwordx4 v26, s[8:11], s61 offen lds
s_waitcnt vmcnt(11)
s_barrier
s_lshl_b32 s48, s95, 7
s_mul_i32 s49, s95, 245760
s_add_u32 s49, s49, s94
s_add_u32 s95, s95, 1
s_cmp_eq_u32 s95, 10
s_cselect_b32 s95, 0, s95
s_add_u32 m0, s92, 120832
s_mov_b32 exec_lo, s59
buffer_load_dwordx4 v36, s[4:7], s48 offen lds
s_mov_b32 exec_lo, -1
s_add_u32 m0, s92, 121856
s_nop 0
buffer_load_dwordx4 v37, s[4:7], s48 offen lds
s_add_u32 m0, s92, 122880
s_nop 0
buffer_load_dwordx4 v38, s[4:7], s48 offen lds
s_add_u32 m0, s93, 49152
s_nop 0
buffer_load_dwordx4 v25, s[8:11], s49 offen lds
s_add_u32 m0, s93, 50176
s_add_u32 s61, s49, 15360
buffer_load_dwordx4 v25, s[8:11], s61 offen lds
s_add_u32 m0, s93, 51200
s_add_u32 s61, s49, 30720
buffer_load_dwordx4 v26, s[8:11], s61 offen lds
s_add_u32 m0, s93, 52224
s_add_u32 s61, s49, 46080
buffer_load_dwordx4 v26, s[8:11], s61 offen lds
s_add_u32 m0, s93, 53248
s_add_u32 s61, s49, 61440
buffer_load_dwordx4 v25, s[8:11], s61 offen lds
s_add_u32 m0, s93, 54272
s_add_u32 s61, s49, 76800
buffer_load_dwordx4 v25, s[8:11], s61 offen lds
s_add_u32 m0, s93, 55296
s_add_u32 s61, s49, 92160
buffer_load_dwordx4 v26, s[8:11], s61 offen lds
s_add_u32 m0, s93, 56320
s_add_u32 s61, s49, 107520
buffer_load_dwordx4 v26, s[8:11], s61 offen lds
s_waitcnt vmcnt(11)
s_barrier
s_lshl_b32 s48, s95, 7
s_mul_i32 s49, s95, 245760
s_add_u32 s49, s49, s94
s_add_u32 s95, s95, 1
s_cmp_eq_u32 s95, 10
s_cselect_b32 s95, 0, s95
s_add_u32 m0, s92, 0
s_mov_b32 exec_lo, s59
buffer_load_dwordx4 v36, s[4:7], s48 offen lds
s_mov_b32 exec_lo, -1
s_add_u32 m0, s92, 1024
s_nop 0
buffer_load_dwordx4 v37, s[4:7], s48 offen lds
s_add_u32 m0, s92, 2048
s_nop 0
buffer_load_dwordx4 v38, s[4:7], s48 offen lds
s_add_u32 m0, s93, 0
s_nop 0
buffer_load_dwordx4 v25, s[8:11], s49 offen lds
s_add_u32 m0, s93, 1024
s_add_u32 s61, s49, 15360
buffer_load_dwordx4 v25, s[8:11], s61 offen lds
s_add_u32 m0, s93, 2048
s_add_u32 s61, s49, 30720
buffer_load_dwordx4 v26, s[8:11], s61 offen lds
s_add_u32 m0, s93, 3072
s_add_u32 s61, s49, 46080
buffer_load_dwordx4 v26, s[8:11], s61 offen lds
s_add_u32 m0, s93, 4096
s_add_u32 s61, s49, 61440
buffer_load_dwordx4 v25, s[8:11], s61 offen lds
s_add_u32 m0, s93, 5120
s_add_u32 s61, s49, 76800
buffer_load_dwordx4 v25, s[8:11], s61 offen lds
s_add_u32 m0, s93, 6144
s_add_u32 s61, s49, 92160
buffer_load_dwordx4 v26, s[8:11], s61 offen lds
s_add_u32 m0, s93, 7168
s_add_u32 s61, s49, 107520
buffer_load_dwordx4 v26, s[8:11], s61 offen lds
s_waitcnt vmcnt(11)
s_barrier
s_lshl_b32 s48, s95, 7
s_mul_i32 s49, s95, 245760
s_add_u32 s49, s49, s94
s_add_u32 s95, s95, 1
s_cmp_eq_u32 s95, 10
s_cselect_b32 s95, 0, s95
s_add_u32 m0, s92, 18432
s_mov_b32 exec_lo, s59
buffer_load_dwordx4 v36, s[4:7], s48 offen lds
s_mov_b32 exec_lo, -1
s_add_u32 m0, s92, 19456
s_nop 0
buffer_load_dwordx4 v37, s[4:7], s48 offen lds
s_add_u32 m0, s92, 20480
s_nop 0
buffer_load_dwordx4 v38, s[4:7], s48 offen lds
s_add_u32 m0, s93, 16384
s_nop 0
buffer_load_dwordx4 v25, s[8:11], s49 offen lds
s_add_u32 m0, s93, 17408
s_add_u32 s61, s49, 15360
buffer_load_dwordx4 v25, s[8:11], s61 offen lds
s_add_u32 m0, s93, 18432
s_add_u32 s61, s49, 30720
buffer_load_dwordx4 v26, s[8:11], s61 offen lds
s_add_u32 m0, s93, 19456
s_add_u32 s61, s49, 46080
buffer_load_dwordx4 v26, s[8:11], s61 offen lds
s_add_u32 m0, s93, 20480
s_add_u32 s61, s49, 61440
buffer_load_dwordx4 v25, s[8:11], s61 offen lds
s_add_u32 m0, s93, 21504
s_add_u32 s61, s49, 76800
buffer_load_dwordx4 v25, s[8:11], s61 offen lds
s_add_u32 m0, s93, 22528
s_add_u32 s61, s49, 92160
buffer_load_dwordx4 v26, s[8:11], s61 offen lds
s_add_u32 m0, s93, 23552
s_add_u32 s61, s49, 107520
buffer_load_dwordx4 v26, s[8:11], s61 offen lds
s_waitcnt vmcnt(11)
s_barrier
s_add_u32 m0, s56, 81920
s_add_u32 s61, s57, 655360
buffer_load_dwordx4 v27, s[88:91], s61 offen lds
s_add_u32 m0, s56, 82944
s_add_u32 s61, s57, 655360
buffer_load_dwordx4 v28, s[88:91], s61 offen lds
s_add_u32 m0, s56, 83968
s_add_u32 s61, s57, 655360
buffer_load_dwordx4 v29, s[88:91], s61 offen lds
s_add_u32 m0, s56, 84992
s_add_u32 s61, s57, 655360
buffer_load_dwordx4 v30, s[88:91], s61 offen lds
s_add_u32 m0, s56, 86016
s_add_u32 s61, s57, 655360
buffer_load_dwordx4 v31, s[88:91], s61 offen lds
s_add_u32 m0, s56, 92160
s_add_u32 s61, s57, 737280
buffer_load_dwordx4 v27, s[88:91], s61 offen lds
s_add_u32 m0, s56, 93184
s_add_u32 s61, s57, 737280
buffer_load_dwordx4 v28, s[88:91], s61 offen lds
s_add_u32 m0, s56, 94208
s_add_u32 s61, s57, 737280
buffer_load_dwordx4 v29, s[88:91], s61 offen lds
s_add_u32 m0, s56, 95232
s_add_u32 s61, s57, 737280
buffer_load_dwordx4 v30, s[88:91], s61 offen lds
s_add_u32 m0, s56, 96256
s_add_u32 s61, s57, 737280
buffer_load_dwordx4 v31, s[88:91], s61 offen lds
s_waitcnt vmcnt(10)
s_barrier
s_add_u32 m0, s56, 10240
s_add_u32 s61, s57, 81920
buffer_load_dwordx4 v27, s[88:91], s61 offen lds
s_add_u32 m0, s56, 11264
s_add_u32 s61, s57, 81920
buffer_load_dwordx4 v28, s[88:91], s61 offen lds
s_add_u32 m0, s56, 12288
s_add_u32 s61, s57, 81920
buffer_load_dwordx4 v29, s[88:91], s61 offen lds
s_add_u32 m0, s56, 13312
s_add_u32 s61, s57, 81920
buffer_load_dwordx4 v30, s[88:91], s61 offen lds
s_add_u32 m0, s56, 14336
s_add_u32 s61, s57, 81920
buffer_load_dwordx4 v31, s[88:91], s61 offen lds
s_add_u32 m0, s56, 20480
s_add_u32 s61, s57, 163840
buffer_load_dwordx4 v27, s[88:91], s61 offen lds
s_add_u32 m0, s56, 21504
s_add_u32 s61, s57, 163840
buffer_load_dwordx4 v28, s[88:91], s61 offen lds
s_add_u32 m0, s56, 22528
s_add_u32 s61, s57, 163840
buffer_load_dwordx4 v29, s[88:91], s61 offen lds
s_add_u32 m0, s56, 23552
s_add_u32 s61, s57, 163840
buffer_load_dwordx4 v30, s[88:91], s61 offen lds
s_add_u32 m0, s56, 24576
s_add_u32 s61, s57, 163840
buffer_load_dwordx4 v31, s[88:91], s61 offen lds
s_add_u32 m0, s56, 30720
s_add_u32 s61, s57, 245760
buffer_load_dwordx4 v27, s[88:91], s61 offen lds
s_add_u32 m0, s56, 31744
s_add_u32 s61, s57, 245760
buffer_load_dwordx4 v28, s[88:91], s61 offen lds
s_add_u32 m0, s56, 32768
s_add_u32 s61, s57, 245760
buffer_load_dwordx4 v29, s[88:91], s61 offen lds
s_add_u32 m0, s56, 33792
s_add_u32 s61, s57, 245760
buffer_load_dwordx4 v30, s[88:91], s61 offen lds
s_add_u32 m0, s56, 34816
s_add_u32 s61, s57, 245760
buffer_load_dwordx4 v31, s[88:91], s61 offen lds
s_barrier
s_add_u32 m0, s56, 0
s_nop 0
buffer_load_dwordx4 v27, s[88:91], s57 offen lds
s_add_u32 m0, s56, 1024
s_nop 0
buffer_load_dwordx4 v28, s[88:91], s57 offen lds
s_add_u32 m0, s56, 2048
s_nop 0
buffer_load_dwordx4 v29, s[88:91], s57 offen lds
s_add_u32 m0, s56, 3072
s_nop 0
buffer_load_dwordx4 v30, s[88:91], s57 offen lds
s_add_u32 m0, s56, 4096
s_nop 0
buffer_load_dwordx4 v31, s[88:91], s57 offen lds
s_add_u32 m0, s56, 40960
s_add_u32 s61, s57, 327680
buffer_load_dwordx4 v27, s[88:91], s61 offen lds
s_add_u32 m0, s56, 41984
s_add_u32 s61, s57, 327680
buffer_load_dwordx4 v28, s[88:91], s61 offen lds
s_add_u32 m0, s56, 43008
s_add_u32 s61, s57, 327680
buffer_load_dwordx4 v29, s[88:91], s61 offen lds
s_add_u32 m0, s56, 44032
s_add_u32 s61, s57, 327680
buffer_load_dwordx4 v30, s[88:91], s61 offen lds
s_add_u32 m0, s56, 45056
s_add_u32 s61, s57, 327680
buffer_load_dwordx4 v31, s[88:91], s61 offen lds
s_barrier
s_add_u32 m0, s56, 51200
s_add_u32 s61, s57, 409600
buffer_load_dwordx4 v27, s[88:91], s61 offen lds
s_add_u32 m0, s56, 52224
s_add_u32 s61, s57, 409600
buffer_load_dwordx4 v28, s[88:91], s61 offen lds
s_add_u32 m0, s56, 53248
s_add_u32 s61, s57, 409600
buffer_load_dwordx4 v29, s[88:91], s61 offen lds
s_add_u32 m0, s56, 54272
s_add_u32 s61, s57, 409600
buffer_load_dwordx4 v30, s[88:91], s61 offen lds
s_add_u32 m0, s56, 55296
s_add_u32 s61, s57, 409600
buffer_load_dwordx4 v31, s[88:91], s61 offen lds
s_add_u32 m0, s56, 61440
s_add_u32 s61, s57, 491520
buffer_load_dwordx4 v27, s[88:91], s61 offen lds
s_add_u32 m0, s56, 62464
s_add_u32 s61, s57, 491520
buffer_load_dwordx4 v28, s[88:91], s61 offen lds
s_add_u32 m0, s56, 63488
s_add_u32 s61, s57, 491520
buffer_load_dwordx4 v29, s[88:91], s61 offen lds
s_add_u32 m0, s56, 64512
s_add_u32 s61, s57, 491520
buffer_load_dwordx4 v30, s[88:91], s61 offen lds
s_add_u32 m0, s56, 65536
s_add_u32 s61, s57, 491520
buffer_load_dwordx4 v31, s[88:91], s61 offen lds
s_add_u32 m0, s56, 71680
s_add_u32 s61, s57, 573440
buffer_load_dwordx4 v27, s[88:91], s61 offen lds
s_add_u32 m0, s56, 72704
s_add_u32 s61, s57, 573440
buffer_load_dwordx4 v28, s[88:91], s61 offen lds
s_add_u32 m0, s56, 73728
s_add_u32 s61, s57, 573440
buffer_load_dwordx4 v29, s[88:91], s61 offen lds
s_add_u32 m0, s56, 74752
s_add_u32 s61, s57, 573440
buffer_load_dwordx4 v30, s[88:91], s61 offen lds
s_add_u32 m0, s56, 75776
s_add_u32 s61, s57, 573440
buffer_load_dwordx4 v31, s[88:91], s61 offen lds
s_cmp_eq_u32 s50, 0
s_cselect_b32 s8, s76, s78
s_cselect_b32 s9, s77, s79
s_mov_b32 s10, 0x1e0000
s_mov_b32 s11, 0x20000
v_add_u32 v4, 0, v1
v_mul_u32_u24 v5, 5462, v4
v_lshrrev_b32 v6, 16, v5
v_mul_u32_u24 v5, 12, v6
v_sub_u32 v7, v4, v5
v_mul_u32_u24 v6, 3072, v6
v_lshl_add_u32 v32, v7, 4, v6
v_add_u32 v4, 64, v1
v_mul_u32_u24 v5, 5462, v4
v_lshrrev_b32 v6, 16, v5
v_mul_u32_u24 v5, 12, v6
v_sub_u32 v7, v4, v5
v_mul_u32_u24 v6, 3072, v6
v_lshl_add_u32 v33, v7, 4, v6
v_add_u32 v4, 128, v1
v_mul_u32_u24 v5, 5462, v4
v_lshrrev_b32 v6, 16, v5
v_mul_u32_u24 v5, 12, v6
v_sub_u32 v7, v4, v5
v_mul_u32_u24 v6, 3072, v6
v_lshl_add_u32 v34, v7, 4, v6
s_mul_i32 s92, s37, 192
s_mov_b32 s42, 0
s_mul_i32 s42, s42, 983040
s_sub_u32 s94, s92, s42
s_add_u32 s92, s92, s42
s_mul_i32 s93, s50, 6144
s_and_b32 s42, s37, 7
s_mul_i32 s96, s42, 48
s_mul_i32 s43, s50, 24
s_add_u32 s96, s96, s43
s_mul_i32 s96, s96, 5120
s_add_u32 s96, s96, 25165824
s_mov_b32 s42, 0
s_mul_i32 s42, s42, 61440
s_sub_u32 s95, s96, s42
s_add_u32 s96, s96, s42
s_mul_i32 s97, s50, 10240
s_waitcnt vmcnt(0)
s_barrier
s_barrier
s_add_u32 m0, s93, 0
s_nop 0
buffer_load_dwordx4 v32, s[8:11], s92 offen lds
s_add_u32 m0, s93, 1024
s_nop 0
buffer_load_dwordx4 v33, s[8:11], s92 offen lds
s_add_u32 m0, s93, 2048
s_nop 0
buffer_load_dwordx4 v34, s[8:11], s92 offen lds
s_add_u32 m0, s93, 3072
s_add_u32 s61, s92, 49152
buffer_load_dwordx4 v32, s[8:11], s61 offen lds
s_add_u32 m0, s93, 4096
s_add_u32 s61, s92, 49152
buffer_load_dwordx4 v33, s[8:11], s61 offen lds
s_add_u32 m0, s93, 5120
s_add_u32 s61, s92, 49152
buffer_load_dwordx4 v34, s[8:11], s61 offen lds
s_add_u32 m0, s93, 12288
s_add_u32 s61, s92, 98304
buffer_load_dwordx4 v32, s[8:11], s61 offen lds
s_add_u32 m0, s93, 13312
s_add_u32 s61, s92, 98304
buffer_load_dwordx4 v33, s[8:11], s61 offen lds
s_add_u32 m0, s93, 14336
s_add_u32 s61, s92, 98304
buffer_load_dwordx4 v34, s[8:11], s61 offen lds
s_add_u32 m0, s93, 15360
s_add_u32 s61, s92, 147456
buffer_load_dwordx4 v32, s[8:11], s61 offen lds
s_add_u32 m0, s93, 16384
s_add_u32 s61, s92, 147456
buffer_load_dwordx4 v33, s[8:11], s61 offen lds
s_add_u32 m0, s93, 17408
s_add_u32 s61, s92, 147456
buffer_load_dwordx4 v34, s[8:11], s61 offen lds
s_barrier
s_barrier
s_add_u32 m0, s93, 24576
s_add_u32 s61, s92, 196608
buffer_load_dwordx4 v32, s[8:11], s61 offen lds
s_add_u32 m0, s93, 25600
s_add_u32 s61, s92, 196608
buffer_load_dwordx4 v33, s[8:11], s61 offen lds
s_add_u32 m0, s93, 26624
s_add_u32 s61, s92, 196608
buffer_load_dwordx4 v34, s[8:11], s61 offen lds
s_add_u32 m0, s93, 27648
s_add_u32 s61, s92, 245760
buffer_load_dwordx4 v32, s[8:11], s61 offen lds
s_add_u32 m0, s93, 28672
s_add_u32 s61, s92, 245760
buffer_load_dwordx4 v33, s[8:11], s61 offen lds
s_add_u32 m0, s93, 29696
s_add_u32 s61, s92, 245760
buffer_load_dwordx4 v34, s[8:11], s61 offen lds
s_add_u32 m0, s93, 36864
s_add_u32 s61, s92, 294912
buffer_load_dwordx4 v32, s[8:11], s61 offen lds
s_add_u32 m0, s93, 37888
s_add_u32 s61, s92, 294912
buffer_load_dwordx4 v33, s[8:11], s61 offen lds
s_add_u32 m0, s93, 38912
s_add_u32 s61, s92, 294912
buffer_load_dwordx4 v34, s[8:11], s61 offen lds
s_add_u32 m0, s93, 39936
s_add_u32 s61, s92, 344064
buffer_load_dwordx4 v32, s[8:11], s61 offen lds
s_add_u32 m0, s93, 40960
s_add_u32 s61, s92, 344064
buffer_load_dwordx4 v33, s[8:11], s61 offen lds
s_add_u32 m0, s93, 41984
s_add_u32 s61, s92, 344064
buffer_load_dwordx4 v34, s[8:11], s61 offen lds
s_barrier
s_barrier
s_add_u32 m0, s93, 49152
s_add_u32 s61, s92, 393216
buffer_load_dwordx4 v32, s[8:11], s61 offen lds
s_add_u32 m0, s93, 50176
s_add_u32 s61, s92, 393216
buffer_load_dwordx4 v33, s[8:11], s61 offen lds
s_add_u32 m0, s93, 51200
s_add_u32 s61, s92, 393216
buffer_load_dwordx4 v34, s[8:11], s61 offen lds
s_add_u32 m0, s93, 52224
s_add_u32 s61, s92, 442368
buffer_load_dwordx4 v32, s[8:11], s61 offen lds
s_add_u32 m0, s93, 53248
s_add_u32 s61, s92, 442368
buffer_load_dwordx4 v33, s[8:11], s61 offen lds
s_add_u32 m0, s93, 54272
s_add_u32 s61, s92, 442368
buffer_load_dwordx4 v34, s[8:11], s61 offen lds
s_add_u32 m0, s93, 61440
s_add_u32 s61, s92, 491520
buffer_load_dwordx4 v32, s[8:11], s61 offen lds
s_add_u32 m0, s93, 62464
s_add_u32 s61, s92, 491520
buffer_load_dwordx4 v33, s[8:11], s61 offen lds
s_add_u32 m0, s93, 63488
s_add_u32 s61, s92, 491520
buffer_load_dwordx4 v34, s[8:11], s61 offen lds
s_add_u32 m0, s93, 64512
s_add_u32 s61, s92, 540672
buffer_load_dwordx4 v32, s[8:11], s61 offen lds
s_add_u32 m0, s93, 65536
s_add_u32 s61, s92, 540672
buffer_load_dwordx4 v33, s[8:11], s61 offen lds
s_add_u32 m0, s93, 66560
s_add_u32 s61, s92, 540672
buffer_load_dwordx4 v34, s[8:11], s61 offen lds
s_barrier
s_barrier
s_add_u32 m0, s93, 73728
s_add_u32 s61, s92, 589824
buffer_load_dwordx4 v32, s[8:11], s61 offen lds
s_add_u32 m0, s93, 74752
s_add_u32 s61, s92, 589824
buffer_load_dwordx4 v33, s[8:11], s61 offen lds
s_add_u32 m0, s93, 75776
s_add_u32 s61, s92, 589824
buffer_load_dwordx4 v34, s[8:11], s61 offen lds
s_add_u32 m0, s93, 76800
s_add_u32 s61, s92, 638976
buffer_load_dwordx4 v32, s[8:11], s61 offen lds
s_add_u32 m0, s93, 77824
s_add_u32 s61, s92, 638976
buffer_load_dwordx4 v33, s[8:11], s61 offen lds
s_add_u32 m0, s93, 78848
s_add_u32 s61, s92, 638976
buffer_load_dwordx4 v34, s[8:11], s61 offen lds
s_add_u32 m0, s93, 86016
s_add_u32 s61, s92, 688128
buffer_load_dwordx4 v32, s[8:11], s61 offen lds
s_add_u32 m0, s93, 87040
s_add_u32 s61, s92, 688128
buffer_load_dwordx4 v33, s[8:11], s61 offen lds
s_add_u32 m0, s93, 88064
s_add_u32 s61, s92, 688128
buffer_load_dwordx4 v34, s[8:11], s61 offen lds
s_add_u32 m0, s93, 89088
s_add_u32 s61, s92, 737280
buffer_load_dwordx4 v32, s[8:11], s61 offen lds
s_add_u32 m0, s93, 90112
s_add_u32 s61, s92, 737280
buffer_load_dwordx4 v33, s[8:11], s61 offen lds
s_add_u32 m0, s93, 91136
s_add_u32 s61, s92, 737280
buffer_load_dwordx4 v34, s[8:11], s61 offen lds
s_waitcnt vmcnt(36)
s_barrier
s_waitcnt vmcnt(24)
s_barrier
s_add_u32 m0, s93, 98304
s_add_u32 s61, s92, 786432
buffer_load_dwordx4 v32, s[8:11], s61 offen lds
s_add_u32 m0, s93, 99328
s_add_u32 s61, s92, 786432
buffer_load_dwordx4 v33, s[8:11], s61 offen lds
s_add_u32 m0, s93, 100352
s_add_u32 s61, s92, 786432
buffer_load_dwordx4 v34, s[8:11], s61 offen lds
s_add_u32 m0, s93, 101376
s_add_u32 s61, s92, 835584
buffer_load_dwordx4 v32, s[8:11], s61 offen lds
s_add_u32 m0, s93, 102400
s_add_u32 s61, s92, 835584
buffer_load_dwordx4 v33, s[8:11], s61 offen lds
s_add_u32 m0, s93, 103424
s_add_u32 s61, s92, 835584
buffer_load_dwordx4 v34, s[8:11], s61 offen lds
s_add_u32 m0, s93, 110592
s_add_u32 s61, s92, 884736
buffer_load_dwordx4 v32, s[8:11], s61 offen lds
s_add_u32 m0, s93, 111616
s_add_u32 s61, s92, 884736
buffer_load_dwordx4 v33, s[8:11], s61 offen lds
s_add_u32 m0, s93, 112640
s_add_u32 s61, s92, 884736
buffer_load_dwordx4 v34, s[8:11], s61 offen lds
s_add_u32 m0, s93, 113664
s_add_u32 s61, s92, 933888
buffer_load_dwordx4 v32, s[8:11], s61 offen lds
s_add_u32 m0, s93, 114688
s_add_u32 s61, s92, 933888
buffer_load_dwordx4 v33, s[8:11], s61 offen lds
s_add_u32 m0, s93, 115712
s_add_u32 s61, s92, 933888
buffer_load_dwordx4 v34, s[8:11], s61 offen lds
s_waitcnt vmcnt(24)
s_barrier
s_add_u32 m0, s93, 122880
s_add_u32 s61, s94, 983040
buffer_load_dwordx4 v32, s[8:11], s61 offen lds
s_add_u32 m0, s93, 123904
s_add_u32 s61, s94, 983040
buffer_load_dwordx4 v33, s[8:11], s61 offen lds
s_add_u32 m0, s93, 124928
s_add_u32 s61, s94, 983040
buffer_load_dwordx4 v34, s[8:11], s61 offen lds
s_add_u32 m0, s93, 125952
s_add_u32 s61, s94, 1032192
buffer_load_dwordx4 v32, s[8:11], s61 offen lds
s_add_u32 m0, s93, 126976
s_add_u32 s61, s94, 1032192
buffer_load_dwordx4 v33, s[8:11], s61 offen lds
s_add_u32 m0, s93, 128000
s_add_u32 s61, s94, 1032192
buffer_load_dwordx4 v34, s[8:11], s61 offen lds
s_add_u32 m0, s93, 135168
s_add_u32 s61, s94, 1081344
buffer_load_dwordx4 v32, s[8:11], s61 offen lds
s_add_u32 m0, s93, 136192
s_add_u32 s61, s94, 1081344
buffer_load_dwordx4 v33, s[8:11], s61 offen lds
s_add_u32 m0, s93, 137216
s_add_u32 s61, s94, 1081344
buffer_load_dwordx4 v34, s[8:11], s61 offen lds
s_add_u32 m0, s93, 138240
s_add_u32 s61, s94, 1130496
buffer_load_dwordx4 v32, s[8:11], s61 offen lds
s_add_u32 m0, s93, 139264
s_add_u32 s61, s94, 1130496
buffer_load_dwordx4 v33, s[8:11], s61 offen lds
s_add_u32 m0, s93, 140288
s_add_u32 s61, s94, 1130496
buffer_load_dwordx4 v34, s[8:11], s61 offen lds
s_waitcnt vmcnt(24)
s_barrier
s_add_u32 m0, s93, 0
s_add_u32 s61, s94, 1179648
buffer_load_dwordx4 v32, s[8:11], s61 offen lds
s_add_u32 m0, s93, 1024
s_add_u32 s61, s94, 1179648
buffer_load_dwordx4 v33, s[8:11], s61 offen lds
s_add_u32 m0, s93, 2048
s_add_u32 s61, s94, 1179648
buffer_load_dwordx4 v34, s[8:11], s61 offen lds
s_add_u32 m0, s93, 3072
s_add_u32 s61, s94, 1228800
buffer_load_dwordx4 v32, s[8:11], s61 offen lds
s_add_u32 m0, s93, 4096
s_add_u32 s61, s94, 1228800
buffer_load_dwordx4 v33, s[8:11], s61 offen lds
s_add_u32 m0, s93, 5120
s_add_u32 s61, s94, 1228800
buffer_load_dwordx4 v34, s[8:11], s61 offen lds
s_add_u32 m0, s93, 12288
s_add_u32 s61, s94, 1277952
buffer_load_dwordx4 v32, s[8:11], s61 offen lds
s_add_u32 m0, s93, 13312
s_add_u32 s61, s94, 1277952
buffer_load_dwordx4 v33, s[8:11], s61 offen lds
s_add_u32 m0, s93, 14336
s_add_u32 s61, s94, 1277952
buffer_load_dwordx4 v34, s[8:11], s61 offen lds
s_add_u32 m0, s93, 15360
s_add_u32 s61, s94, 1327104
buffer_load_dwordx4 v32, s[8:11], s61 offen lds
s_add_u32 m0, s93, 16384
s_add_u32 s61, s94, 1327104
buffer_load_dwordx4 v33, s[8:11], s61 offen lds
s_add_u32 m0, s93, 17408
s_add_u32 s61, s94, 1327104
buffer_load_dwordx4 v34, s[8:11], s61 offen lds
s_waitcnt vmcnt(24)
s_barrier
s_add_u32 m0, s93, 24576
s_add_u32 s61, s94, 1376256
buffer_load_dwordx4 v32, s[8:11], s61 offen lds
s_add_u32 m0, s93, 25600
s_add_u32 s61, s94, 1376256
buffer_load_dwordx4 v33, s[8:11], s61 offen lds
s_add_u32 m0, s93, 26624
s_add_u32 s61, s94, 1376256
buffer_load_dwordx4 v34, s[8:11], s61 offen lds
s_add_u32 m0, s93, 27648
s_add_u32 s61, s94, 1425408
buffer_load_dwordx4 v32, s[8:11], s61 offen lds
s_add_u32 m0, s93, 28672
s_add_u32 s61, s94, 1425408
buffer_load_dwordx4 v33, s[8:11], s61 offen lds
s_add_u32 m0, s93, 29696
s_add_u32 s61, s94, 1425408
buffer_load_dwordx4 v34, s[8:11], s61 offen lds
s_add_u32 m0, s93, 36864
s_add_u32 s61, s94, 1474560
buffer_load_dwordx4 v32, s[8:11], s61 offen lds
s_add_u32 m0, s93, 37888
s_add_u32 s61, s94, 1474560
buffer_load_dwordx4 v33, s[8:11], s61 offen lds
s_add_u32 m0, s93, 38912
s_add_u32 s61, s94, 1474560
buffer_load_dwordx4 v34, s[8:11], s61 offen lds
s_add_u32 m0, s93, 39936
s_add_u32 s61, s94, 1523712
buffer_load_dwordx4 v32, s[8:11], s61 offen lds
s_add_u32 m0, s93, 40960
s_add_u32 s61, s94, 1523712
buffer_load_dwordx4 v33, s[8:11], s61 offen lds
s_add_u32 m0, s93, 41984
s_add_u32 s61, s94, 1523712
buffer_load_dwordx4 v34, s[8:11], s61 offen lds
s_waitcnt vmcnt(24)
s_barrier
s_add_u32 m0, s93, 49152
s_add_u32 s61, s94, 1572864
buffer_load_dwordx4 v32, s[8:11], s61 offen lds
s_add_u32 m0, s93, 50176
s_add_u32 s61, s94, 1572864
buffer_load_dwordx4 v33, s[8:11], s61 offen lds
s_add_u32 m0, s93, 51200
s_add_u32 s61, s94, 1572864
buffer_load_dwordx4 v34, s[8:11], s61 offen lds
s_add_u32 m0, s93, 52224
s_add_u32 s61, s94, 1622016
buffer_load_dwordx4 v32, s[8:11], s61 offen lds
s_add_u32 m0, s93, 53248
s_add_u32 s61, s94, 1622016
buffer_load_dwordx4 v33, s[8:11], s61 offen lds
s_add_u32 m0, s93, 54272
s_add_u32 s61, s94, 1622016
buffer_load_dwordx4 v34, s[8:11], s61 offen lds
s_add_u32 m0, s93, 61440
s_add_u32 s61, s94, 1671168
buffer_load_dwordx4 v32, s[8:11], s61 offen lds
s_add_u32 m0, s93, 62464
s_add_u32 s61, s94, 1671168
buffer_load_dwordx4 v33, s[8:11], s61 offen lds
s_add_u32 m0, s93, 63488
s_add_u32 s61, s94, 1671168
buffer_load_dwordx4 v34, s[8:11], s61 offen lds
s_add_u32 m0, s93, 64512
s_add_u32 s61, s94, 1720320
buffer_load_dwordx4 v32, s[8:11], s61 offen lds
s_add_u32 m0, s93, 65536
s_add_u32 s61, s94, 1720320
buffer_load_dwordx4 v33, s[8:11], s61 offen lds
s_add_u32 m0, s93, 66560
s_add_u32 s61, s94, 1720320
buffer_load_dwordx4 v34, s[8:11], s61 offen lds
s_add_u32 m0, s97, 102400
s_nop 0
buffer_load_dwordx4 v35, s[12:15], s96 offen sc1 lds
s_add_u32 m0, s97, 103424
s_add_u32 s61, s96, 1024
buffer_load_dwordx4 v35, s[12:15], s61 offen sc1 lds
s_add_u32 m0, s97, 104448
s_add_u32 s61, s96, 2048
buffer_load_dwordx4 v35, s[12:15], s61 offen sc1 lds
s_add_u32 m0, s97, 105472
s_add_u32 s61, s96, 3072
buffer_load_dwordx4 v35, s[12:15], s61 offen sc1 lds
s_add_u32 m0, s97, 106496
s_add_u32 s61, s96, 4096
buffer_load_dwordx4 v35, s[12:15], s61 offen sc1 lds
s_add_u32 m0, s97, 107520
s_add_u32 s61, s96, 5120
buffer_load_dwordx4 v35, s[12:15], s61 offen sc1 lds
s_add_u32 m0, s97, 108544
s_add_u32 s61, s96, 6144
buffer_load_dwordx4 v35, s[12:15], s61 offen sc1 lds
s_add_u32 m0, s97, 109568
s_add_u32 s61, s96, 7168
buffer_load_dwordx4 v35, s[12:15], s61 offen sc1 lds
s_add_u32 m0, s97, 110592
s_add_u32 s61, s96, 8192
buffer_load_dwordx4 v35, s[12:15], s61 offen sc1 lds
s_add_u32 m0, s97, 111616
s_add_u32 s61, s96, 9216
buffer_load_dwordx4 v35, s[12:15], s61 offen sc1 lds
s_waitcnt vmcnt(34)
s_barrier
s_add_u32 m0, s93, 73728
s_add_u32 s61, s94, 1769472
buffer_load_dwordx4 v32, s[8:11], s61 offen lds
s_add_u32 m0, s93, 74752
s_add_u32 s61, s94, 1769472
buffer_load_dwordx4 v33, s[8:11], s61 offen lds
s_add_u32 m0, s93, 75776
s_add_u32 s61, s94, 1769472
buffer_load_dwordx4 v34, s[8:11], s61 offen lds
s_add_u32 m0, s93, 76800
s_add_u32 s61, s94, 1818624
buffer_load_dwordx4 v32, s[8:11], s61 offen lds
s_add_u32 m0, s93, 77824
s_add_u32 s61, s94, 1818624
buffer_load_dwordx4 v33, s[8:11], s61 offen lds
s_add_u32 m0, s93, 78848
s_add_u32 s61, s94, 1818624
buffer_load_dwordx4 v34, s[8:11], s61 offen lds
s_add_u32 m0, s93, 86016
s_add_u32 s61, s94, 1867776
buffer_load_dwordx4 v32, s[8:11], s61 offen lds
s_add_u32 m0, s93, 87040
s_add_u32 s61, s94, 1867776
buffer_load_dwordx4 v33, s[8:11], s61 offen lds
s_add_u32 m0, s93, 88064
s_add_u32 s61, s94, 1867776
buffer_load_dwordx4 v34, s[8:11], s61 offen lds
s_add_u32 m0, s93, 89088
s_add_u32 s61, s94, 1916928
buffer_load_dwordx4 v32, s[8:11], s61 offen lds
s_add_u32 m0, s93, 90112
s_add_u32 s61, s94, 1916928
buffer_load_dwordx4 v33, s[8:11], s61 offen lds
s_add_u32 m0, s93, 91136
s_add_u32 s61, s94, 1916928
buffer_load_dwordx4 v34, s[8:11], s61 offen lds
s_add_u32 m0, s97, 122880
s_add_u32 s61, s96, 10240
buffer_load_dwordx4 v35, s[12:15], s61 offen sc1 lds
s_add_u32 m0, s97, 123904
s_add_u32 s61, s96, 11264
buffer_load_dwordx4 v35, s[12:15], s61 offen sc1 lds
s_add_u32 m0, s97, 124928
s_add_u32 s61, s96, 12288
buffer_load_dwordx4 v35, s[12:15], s61 offen sc1 lds
s_add_u32 m0, s97, 125952
s_add_u32 s61, s96, 13312
buffer_load_dwordx4 v35, s[12:15], s61 offen sc1 lds
s_add_u32 m0, s97, 126976
s_add_u32 s61, s96, 14336
buffer_load_dwordx4 v35, s[12:15], s61 offen sc1 lds
s_add_u32 m0, s97, 128000
s_add_u32 s61, s96, 15360
buffer_load_dwordx4 v35, s[12:15], s61 offen sc1 lds
s_add_u32 m0, s97, 129024
s_add_u32 s61, s96, 16384
buffer_load_dwordx4 v35, s[12:15], s61 offen sc1 lds
s_add_u32 m0, s97, 130048
s_add_u32 s61, s96, 17408
buffer_load_dwordx4 v35, s[12:15], s61 offen sc1 lds
s_add_u32 m0, s97, 131072
s_add_u32 s61, s96, 18432
buffer_load_dwordx4 v35, s[12:15], s61 offen sc1 lds
s_add_u32 m0, s97, 132096
s_add_u32 s61, s96, 19456
buffer_load_dwordx4 v35, s[12:15], s61 offen sc1 lds
s_waitcnt vmcnt(44)
s_barrier
s_add_u32 m0, s97, 143360
s_add_u32 s61, s96, 20480
buffer_load_dwordx4 v35, s[12:15], s61 offen sc1 lds
s_add_u32 m0, s97, 144384
s_add_u32 s61, s96, 21504
buffer_load_dwordx4 v35, s[12:15], s61 offen sc1 lds
s_add_u32 m0, s97, 145408
s_add_u32 s61, s96, 22528
buffer_load_dwordx4 v35, s[12:15], s61 offen sc1 lds
s_add_u32 m0, s97, 146432
s_add_u32 s61, s96, 23552
buffer_load_dwordx4 v35, s[12:15], s61 offen sc1 lds
s_add_u32 m0, s97, 147456
s_add_u32 s61, s96, 24576
buffer_load_dwordx4 v35, s[12:15], s61 offen sc1 lds
s_add_u32 m0, s97, 148480
s_add_u32 s61, s96, 25600
buffer_load_dwordx4 v35, s[12:15], s61 offen sc1 lds
s_add_u32 m0, s97, 149504
s_add_u32 s61, s96, 26624
buffer_load_dwordx4 v35, s[12:15], s61 offen sc1 lds
s_add_u32 m0, s97, 150528
s_add_u32 s61, s96, 27648
buffer_load_dwordx4 v35, s[12:15], s61 offen sc1 lds
s_add_u32 m0, s97, 151552
s_add_u32 s61, s96, 28672
buffer_load_dwordx4 v35, s[12:15], s61 offen sc1 lds
s_add_u32 m0, s97, 152576
s_add_u32 s61, s96, 29696
buffer_load_dwordx4 v35, s[12:15], s61 offen sc1 lds
s_waitcnt vmcnt(42)
s_barrier
s_add_u32 m0, s97, 0
s_add_u32 s61, s96, 30720
buffer_load_dwordx4 v35, s[12:15], s61 offen sc1 lds
s_add_u32 m0, s97, 1024
s_add_u32 s61, s96, 31744
buffer_load_dwordx4 v35, s[12:15], s61 offen sc1 lds
s_add_u32 m0, s97, 2048
s_add_u32 s61, s96, 32768
buffer_load_dwordx4 v35, s[12:15], s61 offen sc1 lds
s_add_u32 m0, s97, 3072
s_add_u32 s61, s96, 33792
buffer_load_dwordx4 v35, s[12:15], s61 offen sc1 lds
s_add_u32 m0, s97, 4096
s_add_u32 s61, s96, 34816
buffer_load_dwordx4 v35, s[12:15], s61 offen sc1 lds
s_add_u32 m0, s97, 5120
s_add_u32 s61, s96, 35840
buffer_load_dwordx4 v35, s[12:15], s61 offen sc1 lds
s_add_u32 m0, s97, 6144
s_add_u32 s61, s96, 36864
buffer_load_dwordx4 v35, s[12:15], s61 offen sc1 lds
s_add_u32 m0, s97, 7168
s_add_u32 s61, s96, 37888
buffer_load_dwordx4 v35, s[12:15], s61 offen sc1 lds
s_add_u32 m0, s97, 8192
s_add_u32 s61, s96, 38912
buffer_load_dwordx4 v35, s[12:15], s61 offen sc1 lds
s_add_u32 m0, s97, 9216
s_add_u32 s61, s96, 39936
buffer_load_dwordx4 v35, s[12:15], s61 offen sc1 lds
s_waitcnt vmcnt(30)
s_barrier
s_add_u32 m0, s97, 20480
s_add_u32 s61, s96, 40960
buffer_load_dwordx4 v35, s[12:15], s61 offen sc1 lds
s_add_u32 m0, s97, 21504
s_add_u32 s61, s96, 41984
buffer_load_dwordx4 v35, s[12:15], s61 offen sc1 lds
s_add_u32 m0, s97, 22528
s_add_u32 s61, s96, 43008
buffer_load_dwordx4 v35, s[12:15], s61 offen sc1 lds
s_add_u32 m0, s97, 23552
s_add_u32 s61, s96, 44032
buffer_load_dwordx4 v35, s[12:15], s61 offen sc1 lds
s_add_u32 m0, s97, 24576
s_add_u32 s61, s96, 45056
buffer_load_dwordx4 v35, s[12:15], s61 offen sc1 lds
s_add_u32 m0, s97, 25600
s_add_u32 s61, s96, 46080
buffer_load_dwordx4 v35, s[12:15], s61 offen sc1 lds
s_add_u32 m0, s97, 26624
s_add_u32 s61, s96, 47104
buffer_load_dwordx4 v35, s[12:15], s61 offen sc1 lds
s_add_u32 m0, s97, 27648
s_add_u32 s61, s96, 48128
buffer_load_dwordx4 v35, s[12:15], s61 offen sc1 lds
s_add_u32 m0, s97, 28672
s_add_u32 s61, s96, 49152
buffer_load_dwordx4 v35, s[12:15], s61 offen sc1 lds
s_add_u32 m0, s97, 29696
s_add_u32 s61, s96, 50176
buffer_load_dwordx4 v35, s[12:15], s61 offen sc1 lds
s_barrier
s_add_u32 m0, s97, 40960
s_add_u32 s61, s96, 51200
buffer_load_dwordx4 v35, s[12:15], s61 offen sc1 lds
s_add_u32 m0, s97, 41984
s_add_u32 s61, s96, 52224
buffer_load_dwordx4 v35, s[12:15], s61 offen sc1 lds
s_add_u32 m0, s97, 43008
s_add_u32 s61, s96, 53248
buffer_load_dwordx4 v35, s[12:15], s61 offen sc1 lds
s_add_u32 m0, s97, 44032
s_add_u32 s61, s96, 54272
buffer_load_dwordx4 v35, s[12:15], s61 offen sc1 lds
s_add_u32 m0, s97, 45056
s_add_u32 s61, s96, 55296
buffer_load_dwordx4 v35, s[12:15], s61 offen sc1 lds
s_add_u32 m0, s97, 46080
s_add_u32 s61, s96, 56320
buffer_load_dwordx4 v35, s[12:15], s61 offen sc1 lds
s_add_u32 m0, s97, 47104
s_add_u32 s61, s96, 57344
buffer_load_dwordx4 v35, s[12:15], s61 offen sc1 lds
s_add_u32 m0, s97, 48128
s_add_u32 s61, s96, 58368
buffer_load_dwordx4 v35, s[12:15], s61 offen sc1 lds
s_add_u32 m0, s97, 49152
s_add_u32 s61, s96, 59392
buffer_load_dwordx4 v35, s[12:15], s61 offen sc1 lds
s_add_u32 m0, s97, 50176
s_add_u32 s61, s96, 60416
buffer_load_dwordx4 v35, s[12:15], s61 offen sc1 lds
s_add_u32 m0, s97, 61440
s_add_u32 s61, s95, 61440
buffer_load_dwordx4 v35, s[12:15], s61 offen sc1 lds
s_add_u32 m0, s97, 62464
s_add_u32 s61, s95, 62464
buffer_load_dwordx4 v35, s[12:15], s61 offen sc1 lds
s_add_u32 m0, s97, 63488
s_add_u32 s61, s95, 63488
buffer_load_dwordx4 v35, s[12:15], s61 offen sc1 lds
s_add_u32 m0, s97, 64512
s_add_u32 s61, s95, 64512
buffer_load_dwordx4 v35, s[12:15], s61 offen sc1 lds
s_add_u32 m0, s97, 65536
s_add_u32 s61, s95, 65536
buffer_load_dwordx4 v35, s[12:15], s61 offen sc1 lds
s_add_u32 m0, s97, 66560
s_add_u32 s61, s95, 66560
buffer_load_dwordx4 v35, s[12:15], s61 offen sc1 lds
s_add_u32 m0, s97, 67584
s_add_u32 s61, s95, 67584
buffer_load_dwordx4 v35, s[12:15], s61 offen sc1 lds
s_add_u32 m0, s97, 68608
s_add_u32 s61, s95, 68608
buffer_load_dwordx4 v35, s[12:15], s61 offen sc1 lds
s_add_u32 m0, s97, 69632
s_add_u32 s61, s95, 69632
buffer_load_dwordx4 v35, s[12:15], s61 offen sc1 lds
s_add_u32 m0, s97, 70656
s_add_u32 s61, s95, 70656
buffer_load_dwordx4 v35, s[12:15], s61 offen sc1 lds
s_add_u32 m0, s97, 81920
s_add_u32 s61, s95, 71680
buffer_load_dwordx4 v35, s[12:15], s61 offen sc1 lds
s_add_u32 m0, s97, 82944
s_add_u32 s61, s95, 72704
buffer_load_dwordx4 v35, s[12:15], s61 offen sc1 lds
s_add_u32 m0, s97, 83968
s_add_u32 s61, s95, 73728
buffer_load_dwordx4 v35, s[12:15], s61 offen sc1 lds
s_add_u32 m0, s97, 84992
s_add_u32 s61, s95, 74752
buffer_load_dwordx4 v35, s[12:15], s61 offen sc1 lds
s_add_u32 m0, s97, 86016
s_add_u32 s61, s95, 75776
buffer_load_dwordx4 v35, s[12:15], s61 offen sc1 lds
s_add_u32 m0, s97, 87040
s_add_u32 s61, s95, 76800
buffer_load_dwordx4 v35, s[12:15], s61 offen sc1 lds
s_add_u32 m0, s97, 88064
s_add_u32 s61, s95, 77824
buffer_load_dwordx4 v35, s[12:15], s61 offen sc1 lds
s_add_u32 m0, s97, 89088
s_add_u32 s61, s95, 78848
buffer_load_dwordx4 v35, s[12:15], s61 offen sc1 lds
s_add_u32 m0, s97, 90112
s_add_u32 s61, s95, 79872
buffer_load_dwordx4 v35, s[12:15], s61 offen sc1 lds
s_add_u32 m0, s97, 91136
s_add_u32 s61, s95, 80896
buffer_load_dwordx4 v35, s[12:15], s61 offen sc1 lds
s_waitcnt vmcnt(0)
s_barrier
s_barrier
s_barrier
s_barrier
s_add_u32 m0, s97, 102400
s_add_u32 s61, s95, 81920
buffer_load_dwordx4 v35, s[12:15], s61 offen sc1 lds
s_add_u32 m0, s97, 103424
s_add_u32 s61, s95, 82944
buffer_load_dwordx4 v35, s[12:15], s61 offen sc1 lds
s_add_u32 m0, s97, 104448
s_add_u32 s61, s95, 83968
buffer_load_dwordx4 v35, s[12:15], s61 offen sc1 lds
s_add_u32 m0, s97, 105472
s_add_u32 s61, s95, 84992
buffer_load_dwordx4 v35, s[12:15], s61 offen sc1 lds
s_add_u32 m0, s97, 106496
s_add_u32 s61, s95, 86016
buffer_load_dwordx4 v35, s[12:15], s61 offen sc1 lds
s_add_u32 m0, s97, 107520
s_add_u32 s61, s95, 87040
buffer_load_dwordx4 v35, s[12:15], s61 offen sc1 lds
s_add_u32 m0, s97, 108544
s_add_u32 s61, s95, 88064
buffer_load_dwordx4 v35, s[12:15], s61 offen sc1 lds
s_add_u32 m0, s97, 109568
s_add_u32 s61, s95, 89088
buffer_load_dwordx4 v35, s[12:15], s61 offen sc1 lds
s_add_u32 m0, s97, 110592
s_add_u32 s61, s95, 90112
buffer_load_dwordx4 v35, s[12:15], s61 offen sc1 lds
s_add_u32 m0, s97, 111616
s_add_u32 s61, s95, 91136
buffer_load_dwordx4 v35, s[12:15], s61 offen sc1 lds
s_barrier
s_add_u32 m0, s97, 122880
s_add_u32 s61, s95, 92160
buffer_load_dwordx4 v35, s[12:15], s61 offen sc1 lds
s_add_u32 m0, s97, 123904
s_add_u32 s61, s95, 93184
buffer_load_dwordx4 v35, s[12:15], s61 offen sc1 lds
s_add_u32 m0, s97, 124928
s_add_u32 s61, s95, 94208
buffer_load_dwordx4 v35, s[12:15], s61 offen sc1 lds
s_add_u32 m0, s97, 125952
s_add_u32 s61, s95, 95232
buffer_load_dwordx4 v35, s[12:15], s61 offen sc1 lds
s_add_u32 m0, s97, 126976
s_add_u32 s61, s95, 96256
buffer_load_dwordx4 v35, s[12:15], s61 offen sc1 lds
s_add_u32 m0, s97, 128000
s_add_u32 s61, s95, 97280
buffer_load_dwordx4 v35, s[12:15], s61 offen sc1 lds
s_add_u32 m0, s97, 129024
s_add_u32 s61, s95, 98304
buffer_load_dwordx4 v35, s[12:15], s61 offen sc1 lds
s_add_u32 m0, s97, 130048
s_add_u32 s61, s95, 99328
buffer_load_dwordx4 v35, s[12:15], s61 offen sc1 lds
s_add_u32 m0, s97, 131072
s_add_u32 s61, s95, 100352
buffer_load_dwordx4 v35, s[12:15], s61 offen sc1 lds
s_add_u32 m0, s97, 132096
s_add_u32 s61, s95, 101376
buffer_load_dwordx4 v35, s[12:15], s61 offen sc1 lds
s_add_u32 m0, s97, 143360
s_add_u32 s61, s95, 102400
buffer_load_dwordx4 v35, s[12:15], s61 offen sc1 lds
s_add_u32 m0, s97, 144384
s_add_u32 s61, s95, 103424
buffer_load_dwordx4 v35, s[12:15], s61 offen sc1 lds
s_add_u32 m0, s97, 145408
s_add_u32 s61, s95, 104448
buffer_load_dwordx4 v35, s[12:15], s61 offen sc1 lds
s_add_u32 m0, s97, 146432
s_add_u32 s61, s95, 105472
buffer_load_dwordx4 v35, s[12:15], s61 offen sc1 lds
s_add_u32 m0, s97, 147456
s_add_u32 s61, s95, 106496
buffer_load_dwordx4 v35, s[12:15], s61 offen sc1 lds
s_add_u32 m0, s97, 148480
s_add_u32 s61, s95, 107520
buffer_load_dwordx4 v35, s[12:15], s61 offen sc1 lds
s_add_u32 m0, s97, 149504
s_add_u32 s61, s95, 108544
buffer_load_dwordx4 v35, s[12:15], s61 offen sc1 lds
s_add_u32 m0, s97, 150528
s_add_u32 s61, s95, 109568
buffer_load_dwordx4 v35, s[12:15], s61 offen sc1 lds
s_add_u32 m0, s97, 151552
s_add_u32 s61, s95, 110592
buffer_load_dwordx4 v35, s[12:15], s61 offen sc1 lds
s_add_u32 m0, s97, 152576
s_add_u32 s61, s95, 111616
buffer_load_dwordx4 v35, s[12:15], s61 offen sc1 lds
s_add_u32 m0, s97, 0
s_add_u32 s61, s95, 112640
buffer_load_dwordx4 v35, s[12:15], s61 offen sc1 lds
s_add_u32 m0, s97, 1024
s_add_u32 s61, s95, 113664
buffer_load_dwordx4 v35, s[12:15], s61 offen sc1 lds
s_add_u32 m0, s97, 2048
s_add_u32 s61, s95, 114688
buffer_load_dwordx4 v35, s[12:15], s61 offen sc1 lds
s_add_u32 m0, s97, 3072
s_add_u32 s61, s95, 115712
buffer_load_dwordx4 v35, s[12:15], s61 offen sc1 lds
s_add_u32 m0, s97, 4096
s_add_u32 s61, s95, 116736
buffer_load_dwordx4 v35, s[12:15], s61 offen sc1 lds
s_add_u32 m0, s97, 5120
s_add_u32 s61, s95, 117760
buffer_load_dwordx4 v35, s[12:15], s61 offen sc1 lds
s_add_u32 m0, s97, 6144
s_add_u32 s61, s95, 118784
buffer_load_dwordx4 v35, s[12:15], s61 offen sc1 lds
s_add_u32 m0, s97, 7168
s_add_u32 s61, s95, 119808
buffer_load_dwordx4 v35, s[12:15], s61 offen sc1 lds
s_add_u32 m0, s97, 8192
s_add_u32 s61, s95, 120832
buffer_load_dwordx4 v35, s[12:15], s61 offen sc1 lds
s_add_u32 m0, s97, 9216
s_add_u32 s61, s95, 121856
buffer_load_dwordx4 v35, s[12:15], s61 offen sc1 lds
s_waitcnt vmcnt(20)
s_barrier
s_waitcnt vmcnt(0)
s_barrier
s_barrier
s_barrier
s_waitcnt vmcnt(0)
s_endpgm
L_stat:
s_memrealtime s[62:63]
s_waitcnt lgkmcnt(0)
s_mov_b32 s4, s68
s_mov_b32 s5, s69
s_mov_b32 s6, 0x280000
s_mov_b32 s7, 0x20000
s_mov_b32 s8, s70
s_mov_b32 s9, s71
s_mov_b32 s10, 0x258000
s_mov_b32 s11, 0x20000
s_mov_b32 s12, s86
s_mov_b32 s13, s87
s_mov_b32 s14, 0x3000000
s_mov_b32 s15, 0x20000
s_mov_b32 s20, s84
s_mov_b32 s21, s85
s_mov_b32 s22, 0x100
s_mov_b32 s23, 0x20000
s_mov_b32 s16, s82
s_mov_b32 s17, s83
s_mov_b32 s18, 0x280000
s_mov_b32 s19, 0x20000
s_getpc_b64 s[56:57]
L_pc_here:
s_add_u32 s56, s56, L_code_begin-L_pc_here
s_addc_u32 s57, s57, -1
s_lshr_b32 s42, s2, 3
s_mul_i32 s42, s42, (L_code_end-L_code_begin+4095)/4096
v_min_u32 v4, (L_code_end-L_code_begin+4095)/4096-1, v1
v_add_u32 v4, s42, v4
v_lshlrev_b32 v4, 7, v4
v_min_u32 v4, L_code_end-L_code_begin-4, v4
global_load_dword v245, v4, s[56:57]
s_mul_i32 s3, s37, 9
s_lshl_b32 s42, s36, 7
s_sub_u32 s42, s42, 16
s_add_u32 s42, s42, s3
v_lshlrev_b32 v12, 4, v2
s_movk_i32 s43, 1280
v_add_u32 v6, 0, v3
v_add_u32 v6, s42, v6
v_max_i32 v6, 0, v6
v_mad_u32_u24 v6, v6, s43, v12
buffer_load_dwordx4 v[64:67], v6, s[4:7], 0 offen offset:0
buffer_load_dwordx4 v[68:71], v6, s[4:7], 0 offen offset:256
buffer_load_dwordx4 v[72:75], v6, s[4:7], 0 offen offset:512
buffer_load_dwordx4 v[76:79], v6, s[4:7], 0 offen offset:768
buffer_load_dwordx4 v[80:83], v6, s[4:7], 0 offen offset:1024
v_add_u32 v6, 4, v3
v_add_u32 v6, s42, v6
v_max_i32 v6, 0, v6
v_mad_u32_u24 v6, v6, s43, v12
buffer_load_dwordx4 v[84:87], v6, s[4:7], 0 offen offset:0
buffer_load_dwordx4 v[88:91], v6, s[4:7], 0 offen offset:256
buffer_load_dwordx4 v[92:95], v6, s[4:7], 0 offen offset:512
buffer_load_dwordx4 v[96:99], v6, s[4:7], 0 offen offset:768
buffer_load_dwordx4 v[100:103], v6, s[4:7], 0 offen offset:1024
v_subrev_u32 v7, 1, v3
v_lshl_add_u32 v7, v7, 8, s2
v_cmp_eq_u32 s[64:65], 0, v3
v_min_u32 v8, 639, v7
s_add_u32 s88, s42, 8
s_max_i32 s88, s88, 0
v_mov_b32 v9, s88
v_cndmask_b32 v8, v8, v9, s[64:65]
v_mad_u32_u24 v10, v8, s43, v12
v_mov_b32 v8, s72
v_mov_b32 v9, s73
v_mov_b32 v14, s68
v_mov_b32 v15, s69
v_cndmask_b32 v8, v8, v14, s[64:65]
v_cndmask_b32 v9, v9, v15, s[64:65]
v_add_co_u32 v8, vcc, v8, v10
s_nop 1
v_addc_co_u32 v9, vcc, 0, v9, vcc
global_load_dwordx4 v[104:107], v[8:9], off offset:0
global_load_dwordx4 v[108:111], v[8:9], off offset:256
global_load_dwordx4 v[112:115], v[8:9], off offset:512
global_load_dwordx4 v[116:119], v[8:9], off offset:768
global_load_dwordx4 v[120:123], v[8:9], off offset:1024
v_mov_b32 v56, 0
buffer_load_dword v57, v56, s[20:23], 0 offen sc1
s_mul_i32 s3, s37, 9
s_lshl_b32 s43, s36, 12
s_add_u32 s43, s43, 8192
v_add_u32 v5, 0, v3
v_add_u32 v5, s3, v5
v_lshlrev_b32 v5, 4, v5
v_add_u32 v40, s43, v5
v_cmp_eq_u32 s[44:45], 0, v2
v_add_u32 v5, 4, v3
v_add_u32 v5, s3, v5
v_lshlrev_b32 v5, 4, v5
v_add_u32 v41, s43, v5
v_cmp_eq_u32 s[46:47], 0, v2
v_add_u32 v5, 8, v3
v_add_u32 v5, s3, v5
v_lshlrev_b32 v5, 4, v5
v_add_u32 v42, s43, v5
v_cmp_eq_u32 s[48:49], 0, v2
v_lshlrev_b32 v5, 4, v7
v_add_u32 v5, 73728, v5
v_cndmask_b32 v42, v5, v42, s[64:65]
s_movk_i32 s3, 640
v_cmp_gt_u32 vcc, s3, v7
s_nop 1
s_or_b64 vcc, vcc, s[64:65]
s_and_b64 s[48:49], s[48:49], vcc
s_waitcnt vmcnt(11)
v_lshlrev_b32 v14, 16, v64
v_and_b32 v15, 0xffff0000, v64
v_pk_mul_f32 v[12:13], v[14:15], v[14:15]
v_mov_b32 v10, v14
v_mov_b32 v11, v15
v_lshlrev_b32 v16, 16, v65
v_and_b32 v17, 0xffff0000, v65
v_pk_add_f32 v[10:11], v[10:11], v[16:17]
v_pk_fma_f32 v[12:13], v[16:17], v[16:17], v[12:13]
v_lshlrev_b32 v14, 16, v66
v_and_b32 v15, 0xffff0000, v66
v_pk_add_f32 v[10:11], v[10:11], v[14:15]
v_pk_fma_f32 v[12:13], v[14:15], v[14:15], v[12:13]
v_lshlrev_b32 v16, 16, v67
v_and_b32 v17, 0xffff0000, v67
v_pk_add_f32 v[10:11], v[10:11], v[16:17]
v_pk_fma_f32 v[12:13], v[16:17], v[16:17], v[12:13]
v_lshlrev_b32 v14, 16, v68
v_and_b32 v15, 0xffff0000, v68
v_pk_add_f32 v[10:11], v[10:11], v[14:15]
v_pk_fma_f32 v[12:13], v[14:15], v[14:15], v[12:13]
v_lshlrev_b32 v16, 16, v69
v_and_b32 v17, 0xffff0000, v69
v_pk_add_f32 v[10:11], v[10:11], v[16:17]
v_pk_fma_f32 v[12:13], v[16:17], v[16:17], v[12:13]
v_lshlrev_b32 v14, 16, v70
v_and_b32 v15, 0xffff0000, v70
v_pk_add_f32 v[10:11], v[10:11], v[14:15]
v_pk_fma_f32 v[12:13], v[14:15], v[14:15], v[12:13]
v_lshlrev_b32 v16, 16, v71
v_and_b32 v17, 0xffff0000, v71
v_pk_add_f32 v[10:11], v[10:11], v[16:17]
v_pk_fma_f32 v[12:13], v[16:17], v[16:17], v[12:13]
v_lshlrev_b32 v14, 16, v72
v_and_b32 v15, 0xffff0000, v72
v_pk_add_f32 v[10:11], v[10:11], v[14:15]
v_pk_fma_f32 v[12:13], v[14:15], v[14:15], v[12:13]
v_lshlrev_b32 v16, 16, v73
v_and_b32 v17, 0xffff0000, v73
v_pk_add_f32 v[10:11], v[10:11], v[16:17]
v_pk_fma_f32 v[12:13], v[16:17], v[16:17], v[12:13]
v_lshlrev_b32 v14, 16, v74
v_and_b32 v15, 0xffff0000, v74
v_pk_add_f32 v[10:11], v[10:11], v[14:15]
v_pk_fma_f32 v[12:13], v[14:15], v[14:15], v[12:13]
v_lshlrev_b32 v16, 16, v75
v_and_b32 v17, 0xffff0000, v75
v_pk_add_f32 v[10:11], v[10:11], v[16:17]
v_pk_fma_f32 v[12:13], v[16:17], v[16:17], v[12:13]
v_lshlrev_b32 v14, 16, v76
v_and_b32 v15, 0xffff0000, v76
v_pk_add_f32 v[10:11], v[10:11], v[14:15]
v_pk_fma_f32 v[12:13], v[14:15], v[14:15], v[12:13]
v_lshlrev_b32 v16, 16, v77
v_and_b32 v17, 0xffff0000, v77
v_pk_add_f32 v[10:11], v[10:11], v[16:17]
v_pk_fma_f32 v[12:13], v[16:17], v[16:17], v[12:13]
v_lshlrev_b32 v14, 16, v78
v_and_b32 v15, 0xffff0000, v78
v_pk_add_f32 v[10:11], v[10:11], v[14:15]
v_pk_fma_f32 v[12:13], v[14:15], v[14:15], v[12:13]
v_lshlrev_b32 v16, 16, v79
v_and_b32 v17, 0xffff0000, v79
v_pk_add_f32 v[10:11], v[10:11], v[16:17]
v_pk_fma_f32 v[12:13], v[16:17], v[16:17], v[12:13]
v_lshlrev_b32 v14, 16, v80
v_and_b32 v15, 0xffff0000, v80
v_pk_add_f32 v[10:11], v[10:11], v[14:15]
v_pk_fma_f32 v[12:13], v[14:15], v[14:15], v[12:13]
v_lshlrev_b32 v16, 16, v81
v_and_b32 v17, 0xffff0000, v81
v_pk_add_f32 v[10:11], v[10:11], v[16:17]
v_pk_fma_f32 v[12:13], v[16:17], v[16:17], v[12:13]
v_lshlrev_b32 v14, 16, v82
v_and_b32 v15, 0xffff0000, v82
v_pk_add_f32 v[10:11], v[10:11], v[14:15]
v_pk_fma_f32 v[12:13], v[14:15], v[14:15], v[12:13]
v_lshlrev_b32 v16, 16, v83
v_and_b32 v17, 0xffff0000, v83
v_pk_add_f32 v[10:11], v[10:11], v[16:17]
v_pk_fma_f32 v[12:13], v[16:17], v[16:17], v[12:13]
v_add_f32 v10, v10, v11
v_add_f32 v12, v12, v13
s_nop 0
s_nop 0
v_add_f32_dpp v10, v10, v10 row_ror:8 row_mask:0xf bank_mask:0xf
v_add_f32_dpp v12, v12, v12 row_ror:8 row_mask:0xf bank_mask:0xf
s_nop 0
v_add_f32_dpp v10, v10, v10 row_ror:4 row_mask:0xf bank_mask:0xf
v_add_f32_dpp v12, v12, v12 row_ror:4 row_mask:0xf bank_mask:0xf
s_nop 0
v_add_f32_dpp v10, v10, v10 row_ror:2 row_mask:0xf bank_mask:0xf
v_add_f32_dpp v12, v12, v12 row_ror:2 row_mask:0xf bank_mask:0xf
s_nop 0
v_add_f32_dpp v10, v10, v10 row_ror:1 row_mask:0xf bank_mask:0xf
v_add_f32_dpp v12, v12, v12 row_ror:1 row_mask:0xf bank_mask:0xf
v_mul_f32 v44, 0x3acccccd, v10
v_mul_f32 v12, 0x3acccccd, v12
v_fma_f32 v12, -v44, v44, v12
v_max_f32 v12, 0, v12
v_add_f32 v12, 0x3727c5ac, v12
v_rsq_f32 v45, v12
s_nop 0
s_barrier
s_waitcnt vmcnt(6)
v_lshlrev_b32 v14, 16, v84
v_and_b32 v15, 0xffff0000, v84
v_pk_mul_f32 v[12:13], v[14:15], v[14:15]
v_mov_b32 v10, v14
v_mov_b32 v11, v15
v_lshlrev_b32 v16, 16, v85
v_and_b32 v17, 0xffff0000, v85
v_pk_add_f32 v[10:11], v[10:11], v[16:17]
v_pk_fma_f32 v[12:13], v[16:17], v[16:17], v[12:13]
v_lshlrev_b32 v14, 16, v86
v_and_b32 v15, 0xffff0000, v86
v_pk_add_f32 v[10:11], v[10:11], v[14:15]
v_pk_fma_f32 v[12:13], v[14:15], v[14:15], v[12:13]
v_lshlrev_b32 v16, 16, v87
v_and_b32 v17, 0xffff0000, v87
v_pk_add_f32 v[10:11], v[10:11], v[16:17]
v_pk_fma_f32 v[12:13], v[16:17], v[16:17], v[12:13]
v_lshlrev_b32 v14, 16, v88
v_and_b32 v15, 0xffff0000, v88
v_pk_add_f32 v[10:11], v[10:11], v[14:15]
v_pk_fma_f32 v[12:13], v[14:15], v[14:15], v[12:13]
v_lshlrev_b32 v16, 16, v89
v_and_b32 v17, 0xffff0000, v89
v_pk_add_f32 v[10:11], v[10:11], v[16:17]
v_pk_fma_f32 v[12:13], v[16:17], v[16:17], v[12:13]
v_lshlrev_b32 v14, 16, v90
v_and_b32 v15, 0xffff0000, v90
v_pk_add_f32 v[10:11], v[10:11], v[14:15]
v_pk_fma_f32 v[12:13], v[14:15], v[14:15], v[12:13]
v_lshlrev_b32 v16, 16, v91
v_and_b32 v17, 0xffff0000, v91
v_pk_add_f32 v[10:11], v[10:11], v[16:17]
v_pk_fma_f32 v[12:13], v[16:17], v[16:17], v[12:13]
v_lshlrev_b32 v14, 16, v92
v_and_b32 v15, 0xffff0000, v92
v_pk_add_f32 v[10:11], v[10:11], v[14:15]
v_pk_fma_f32 v[12:13], v[14:15], v[14:15], v[12:13]
v_lshlrev_b32 v16, 16, v93
v_and_b32 v17, 0xffff0000, v93
v_pk_add_f32 v[10:11], v[10:11], v[16:17]
v_pk_fma_f32 v[12:13], v[16:17], v[16:17], v[12:13]
v_lshlrev_b32 v14, 16, v94
v_and_b32 v15, 0xffff0000, v94
v_pk_add_f32 v[10:11], v[10:11], v[14:15]
v_pk_fma_f32 v[12:13], v[14:15], v[14:15], v[12:13]
v_lshlrev_b32 v16, 16, v95
v_and_b32 v17, 0xffff0000, v95
v_pk_add_f32 v[10:11], v[10:11], v[16:17]
v_pk_fma_f32 v[12:13], v[16:17], v[16:17], v[12:13]
v_lshlrev_b32 v14, 16, v96
v_and_b32 v15, 0xffff0000, v96
v_pk_add_f32 v[10:11], v[10:11], v[14:15]
v_pk_fma_f32 v[12:13], v[14:15], v[14:15], v[12:13]
v_lshlrev_b32 v16, 16, v97
v_and_b32 v17, 0xffff0000, v97
v_pk_add_f32 v[10:11], v[10:11], v[16:17]
v_pk_fma_f32 v[12:13], v[16:17], v[16:17], v[12:13]
v_lshlrev_b32 v14, 16, v98
v_and_b32 v15, 0xffff0000, v98
v_pk_add_f32 v[10:11], v[10:11], v[14:15]
v_pk_fma_f32 v[12:13], v[14:15], v[14:15], v[12:13]
v_lshlrev_b32 v16, 16, v99
v_and_b32 v17, 0xffff0000, v99
v_pk_add_f32 v[10:11], v[10:11], v[16:17]
v_pk_fma_f32 v[12:13], v[16:17], v[16:17], v[12:13]
v_lshlrev_b32 v14, 16, v100
v_and_b32 v15, 0xffff0000, v100
v_pk_add_f32 v[10:11], v[10:11], v[14:15]
v_pk_fma_f32 v[12:13], v[14:15], v[14:15], v[12:13]
v_lshlrev_b32 v16, 16, v101
v_and_b32 v17, 0xffff0000, v101
v_pk_add_f32 v[10:11], v[10:11], v[16:17]
v_pk_fma_f32 v[12:13], v[16:17], v[16:17], v[12:13]
v_lshlrev_b32 v14, 16, v102
v_and_b32 v15, 0xffff0000, v102
v_pk_add_f32 v[10:11], v[10:11], v[14:15]
v_pk_fma_f32 v[12:13], v[14:15], v[14:15], v[12:13]
v_lshlrev_b32 v16, 16, v103
v_and_b32 v17, 0xffff0000, v103
v_pk_add_f32 v[10:11], v[10:11], v[16:17]
v_pk_fma_f32 v[12:13], v[16:17], v[16:17], v[12:13]
v_add_f32 v10, v10, v11
v_add_f32 v12, v12, v13
s_nop 0
s_nop 0
v_add_f32_dpp v10, v10, v10 row_ror:8 row_mask:0xf bank_mask:0xf
v_add_f32_dpp v12, v12, v12 row_ror:8 row_mask:0xf bank_mask:0xf
s_nop 0
v_add_f32_dpp v10, v10, v10 row_ror:4 row_mask:0xf bank_mask:0xf
v_add_f32_dpp v12, v12, v12 row_ror:4 row_mask:0xf bank_mask:0xf
s_nop 0
v_add_f32_dpp v10, v10, v10 row_ror:2 row_mask:0xf bank_mask:0xf
v_add_f32_dpp v12, v12, v12 row_ror:2 row_mask:0xf bank_mask:0xf
s_nop 0
v_add_f32_dpp v10, v10, v10 row_ror:1 row_mask:0xf bank_mask:0xf
v_add_f32_dpp v12, v12, v12 row_ror:1 row_mask:0xf bank_mask:0xf
v_mul_f32 v46, 0x3acccccd, v10
v_mul_f32 v12, 0x3acccccd, v12
v_fma_f32 v12, -v46, v46, v12
v_max_f32 v12, 0, v12
v_add_f32 v12, 0x3727c5ac, v12
v_rsq_f32 v47, v12
s_nop 0
s_waitcnt vmcnt(1)
v_lshlrev_b32 v14, 16, v104
v_and_b32 v15, 0xffff0000, v104
v_pk_mul_f32 v[12:13], v[14:15], v[14:15]
v_mov_b32 v10, v14
v_mov_b32 v11, v15
v_lshlrev_b32 v16, 16, v105
v_and_b32 v17, 0xffff0000, v105
v_pk_add_f32 v[10:11], v[10:11], v[16:17]
v_pk_fma_f32 v[12:13], v[16:17], v[16:17], v[12:13]
v_lshlrev_b32 v14, 16, v106
v_and_b32 v15, 0xffff0000, v106
v_pk_add_f32 v[10:11], v[10:11], v[14:15]
v_pk_fma_f32 v[12:13], v[14:15], v[14:15], v[12:13]
v_lshlrev_b32 v16, 16, v107
v_and_b32 v17, 0xffff0000, v107
v_pk_add_f32 v[10:11], v[10:11], v[16:17]
v_pk_fma_f32 v[12:13], v[16:17], v[16:17], v[12:13]
v_lshlrev_b32 v14, 16, v108
v_and_b32 v15, 0xffff0000, v108
v_pk_add_f32 v[10:11], v[10:11], v[14:15]
v_pk_fma_f32 v[12:13], v[14:15], v[14:15], v[12:13]
v_lshlrev_b32 v16, 16, v109
v_and_b32 v17, 0xffff0000, v109
v_pk_add_f32 v[10:11], v[10:11], v[16:17]
v_pk_fma_f32 v[12:13], v[16:17], v[16:17], v[12:13]
v_lshlrev_b32 v14, 16, v110
v_and_b32 v15, 0xffff0000, v110
v_pk_add_f32 v[10:11], v[10:11], v[14:15]
v_pk_fma_f32 v[12:13], v[14:15], v[14:15], v[12:13]
v_lshlrev_b32 v16, 16, v111
v_and_b32 v17, 0xffff0000, v111
v_pk_add_f32 v[10:11], v[10:11], v[16:17]
v_pk_fma_f32 v[12:13], v[16:17], v[16:17], v[12:13]
v_lshlrev_b32 v14, 16, v112
v_and_b32 v15, 0xffff0000, v112
v_pk_add_f32 v[10:11], v[10:11], v[14:15]
v_pk_fma_f32 v[12:13], v[14:15], v[14:15], v[12:13]
v_lshlrev_b32 v16, 16, v113
v_and_b32 v17, 0xffff0000, v113
v_pk_add_f32 v[10:11], v[10:11], v[16:17]
v_pk_fma_f32 v[12:13], v[16:17], v[16:17], v[12:13]
v_lshlrev_b32 v14, 16, v114
v_and_b32 v15, 0xffff0000, v114
v_pk_add_f32 v[10:11], v[10:11], v[14:15]
v_pk_fma_f32 v[12:13], v[14:15], v[14:15], v[12:13]
v_lshlrev_b32 v16, 16, v115
v_and_b32 v17, 0xffff0000, v115
v_pk_add_f32 v[10:11], v[10:11], v[16:17]
v_pk_fma_f32 v[12:13], v[16:17], v[16:17], v[12:13]
v_lshlrev_b32 v14, 16, v116
v_and_b32 v15, 0xffff0000, v116
v_pk_add_f32 v[10:11], v[10:11], v[14:15]
v_pk_fma_f32 v[12:13], v[14:15], v[14:15], v[12:13]
v_lshlrev_b32 v16, 16, v117
v_and_b32 v17, 0xffff0000, v117
v_pk_add_f32 v[10:11], v[10:11], v[16:17]
v_pk_fma_f32 v[12:13], v[16:17], v[16:17], v[12:13]
v_lshlrev_b32 v14, 16, v118
v_and_b32 v15, 0xffff0000, v118
v_pk_add_f32 v[10:11], v[10:11], v[14:15]
v_pk_fma_f32 v[12:13], v[14:15], v[14:15], v[12:13]
v_lshlrev_b32 v16, 16, v119
v_and_b32 v17, 0xffff0000, v119
v_pk_add_f32 v[10:11], v[10:11], v[16:17]
v_pk_fma_f32 v[12:13], v[16:17], v[16:17], v[12:13]
v_lshlrev_b32 v14, 16, v120
v_and_b32 v15, 0xffff0000, v120
v_pk_add_f32 v[10:11], v[10:11], v[14:15]
v_pk_fma_f32 v[12:13], v[14:15], v[14:15], v[12:13]
v_lshlrev_b32 v16, 16, v121
v_and_b32 v17, 0xffff0000, v121
v_pk_add_f32 v[10:11], v[10:11], v[16:17]
v_pk_fma_f32 v[12:13], v[16:17], v[16:17], v[12:13]
v_lshlrev_b32 v14, 16, v122
v_and_b32 v15, 0xffff0000, v122
v_pk_add_f32 v[10:11], v[10:11], v[14:15]
v_pk_fma_f32 v[12:13], v[14:15], v[14:15], v[12:13]
v_lshlrev_b32 v16, 16, v123
v_and_b32 v17, 0xffff0000, v123
v_pk_add_f32 v[10:11], v[10:11], v[16:17]
v_pk_fma_f32 v[12:13], v[16:17], v[16:17], v[12:13]
v_add_f32 v10, v10, v11
v_add_f32 v12, v12, v13
s_nop 0
s_nop 0
v_add_f32_dpp v10, v10, v10 row_ror:8 row_mask:0xf bank_mask:0xf
v_add_f32_dpp v12, v12, v12 row_ror:8 row_mask:0xf bank_mask:0xf
s_nop 0
v_add_f32_dpp v10, v10, v10 row_ror:4 row_mask:0xf bank_mask:0xf
v_add_f32_dpp v12, v12, v12 row_ror:4 row_mask:0xf bank_mask:0xf
s_nop 0
v_add_f32_dpp v10, v10, v10 row_ror:2 row_mask:0xf bank_mask:0xf
v_add_f32_dpp v12, v12, v12 row_ror:2 row_mask:0xf bank_mask:0xf
s_nop 0
v_add_f32_dpp v10, v10, v10 row_ror:1 row_mask:0xf bank_mask:0xf
v_add_f32_dpp v12, v12, v12 row_ror:1 row_mask:0xf bank_mask:0xf
v_mul_f32 v48, 0x3acccccd, v10
v_mul_f32 v12, 0x3acccccd, v12
v_fma_f32 v12, -v48, v48, v12
v_max_f32 v12, 0, v12
v_add_f32 v12, 0x3727c5ac, v12
v_rsq_f32 v49, v12
s_nop 0
s_waitcnt vmcnt(0)
s_mov_b32 s42, 100000
L_ntop_16:
v_readfirstlane_b32 s39, v57
s_nop 2
s_cmp_eq_u32 s39, 0
s_cbranch_scc1 L_nagain_18
s_sub_u32 s43, s62, s39
s_cmp_lt_i32 s43, 2000
s_cbranch_scc1 L_nokay_17
L_nagain_18:
s_sub_u32 s42, s42, 1
s_cmp_eq_u32 s42, 0
s_cbranch_scc1 L_nokay_17
buffer_load_dword v57, v56, s[20:23], 0 offen sc1
s_waitcnt vmcnt(0)
s_branch L_ntop_16
L_nokay_17:
v_mov_b32 v8, v44
v_mov_b32 v9, v45
v_mov_b32 v10, s39
v_mov_b32 v11, s41
s_mov_b64 exec, s[44:45]
buffer_store_dwordx4 v[8:11], v40, s[12:15], 0 offen sc1
s_mov_b64 exec, -1
s_nop 1
v_mov_b32 v8, v46
v_mov_b32 v9, v47
v_mov_b32 v10, s39
v_mov_b32 v11, s41
s_mov_b64 exec, s[46:47]
buffer_store_dwordx4 v[8:11], v41, s[12:15], 0 offen sc1
s_mov_b64 exec, -1
s_nop 1
v_mov_b32 v8, v48
v_mov_b32 v9, v49
v_mov_b32 v10, s39
v_mov_b32 v11, s41
s_mov_b64 exec, s[48:49]
buffer_store_dwordx4 v[8:11], v42, s[12:15], 0 offen sc1
s_mov_b64 exec, -1
s_nop 1
s_barrier
s_barrier
s_barrier
s_barrier
s_barrier
s_barrier
s_barrier
s_barrier
v_lshlrev_b32 v21, 4, v1
v_add_u32 v22, 1024, v21
v_add_u32 v23, 128, v1
v_min_u32 v23, 143, v23
v_lshlrev_b32 v23, 4, v23
s_lshl_b32 s60, s36, 12
s_add_u32 s60, s60, 8192
buffer_load_dwordx4 v[124:127], v21, s[12:15], s60 offen sc1
buffer_load_dwordx4 v[128:131], v22, s[12:15], s60 offen sc1
buffer_load_dwordx4 v[132:135], v23, s[12:15], s60 offen sc1
v_lshlrev_b32 v20, 4, v1
s_mov_b32 s51, 73728
s_mov_b32 s52, 77824
s_mov_b32 s53, 81920
buffer_load_dwordx4 v[64:67], v20, s[12:15], s51 offen offset:0 sc1
buffer_load_dwordx4 v[68:71], v20, s[12:15], s51 offen offset:1024 sc1
buffer_load_dwordx4 v[72:75], v20, s[12:15], s51 offen offset:2048 sc1
buffer_load_dwordx4 v[76:79], v20, s[12:15], s51 offen offset:3072 sc1
buffer_load_dwordx4 v[80:83], v20, s[12:15], s52 offen offset:0 sc1
buffer_load_dwordx4 v[84:87], v20, s[12:15], s52 offen offset:1024 sc1
buffer_load_dwordx4 v[88:91], v20, s[12:15], s52 offen offset:2048 sc1
buffer_load_dwordx4 v[92:95], v20, s[12:15], s52 offen offset:3072 sc1
buffer_load_dwordx4 v[96:99], v20, s[12:15], s53 offen offset:0 sc1
buffer_load_dwordx4 v[100:103], v20, s[12:15], s53 offen offset:1024 sc1
s_barrier
s_waitcnt vmcnt(10)
s_mov_b32 s42, 100000
L_gtop_22:
v_xor_b32 v4, s39, v126
v_xor_b32 v5, s39, v130
v_xor_b32 v6, s39, v134
v_or3_b32 v4, v4, v5, v6
v_cmp_ne_u32 vcc, 0, v4
s_nop 1
s_cmp_eq_u64 vcc, 0
s_cbranch_scc1 L_gdone_23
s_sub_u32 s42, s42, 1
s_cmp_eq_u32 s42, 0
s_cbranch_scc1 L_gdone_23
s_sleep 2
buffer_load_dwordx4 v[124:127], v21, s[12:15], s60 offen sc1
buffer_load_dwordx4 v[128:131], v22, s[12:15], s60 offen sc1
buffer_load_dwordx4 v[132:135], v23, s[12:15], s60 offen sc1
s_waitcnt vmcnt(0)
s_branch L_gtop_22
L_gdone_23:
v_xor_b32 v4, s41, v127
v_xor_b32 v5, s41, v131
v_xor_b32 v6, s41, v135
v_or3_b32 v4, v4, v5, v6
v_cmp_ne_u32 vcc, 0, v4
v_lshrrev_b32 v7, 1, v21
v_add_u32 v7, 139328, v7
s_nop 0
s_cmp_eq_u64 vcc, 0
s_cselect_b32 s40, 1, 0
v_lshrrev_b32 v8, 1, v23
v_add_u32 v8, 139328, v8
v_mov_b32 v10, s39
v_mov_b32 v11, s40
v_mov_b32 v9, 139264
ds_write_b64 v7, v[124:125]
ds_write_b64 v7, v[128:129] offset:512
ds_write_b64 v8, v[132:133]
ds_write_b64 v9, v[10:11]
s_waitcnt lgkmcnt(0)
s_barrier
s_waitcnt vmcnt(0)
s_mov_b32 s42, 100000
L_rmtop_24:
v_xor_b32 v4, s39, v66
v_xor_b32 v5, s39, v70
v_or_b32 v4, v4, v5
v_xor_b32 v5, s39, v74
v_or_b32 v4, v4, v5
v_xor_b32 v5, s39, v78
v_or_b32 v4, v4, v5
v_xor_b32 v5, s39, v82
v_or_b32 v4, v4, v5
v_xor_b32 v5, s39, v86
v_or_b32 v4, v4, v5
v_xor_b32 v5, s39, v90
v_or_b32 v4, v4, v5
v_xor_b32 v5, s39, v94
v_or_b32 v4, v4, v5
v_xor_b32 v5, s39, v98
v_or_b32 v4, v4, v5
v_xor_b32 v5, s39, v102
v_or_b32 v4, v4, v5
v_cmp_ne_u32 vcc, 0, v4
s_nop 1
s_cmp_eq_u64 vcc, 0
s_cbranch_scc1 L_rmdone_25
s_sub_u32 s42, s42, 1
s_cmp_eq_u32 s42, 0
s_cbranch_scc1 L_rmdone_25
s_sleep 2
buffer_load_dwordx4 v[64:67], v20, s[12:15], s51 offen offset:0 sc1
buffer_load_dwordx4 v[68:71], v20, s[12:15], s51 offen offset:1024 sc1
buffer_load_dwordx4 v[72:75], v20, s[12:15], s51 offen offset:2048 sc1
buffer_load_dwordx4 v[76:79], v20, s[12:15], s51 offen offset:3072 sc1
buffer_load_dwordx4 v[80:83], v20, s[12:15], s52 offen offset:0 sc1
buffer_load_dwordx4 v[84:87], v20, s[12:15], s52 offen offset:1024 sc1
buffer_load_dwordx4 v[88:91], v20, s[12:15], s52 offen offset:2048 sc1
buffer_load_dwordx4 v[92:95], v20, s[12:15], s52 offen offset:3072 sc1
buffer_load_dwordx4 v[96:99], v20, s[12:15], s53 offen offset:0 sc1
buffer_load_dwordx4 v[100:103], v20, s[12:15], s53 offen offset:1024 sc1
s_waitcnt vmcnt(0)
s_branch L_rmtop_24
L_rmdone_25:
v_lshlrev_b32 v7, 1, v1
v_add_u32 v7, 49152, v7
v_cvt_pk_bf16_f32 v8, v64, v64
v_cvt_pk_bf16_f32 v9, v68, v68
v_cvt_pk_bf16_f32 v10, v72, v72
v_cvt_pk_bf16_f32 v11, v76, v76
v_cvt_pk_bf16_f32 v12, v80, v80
v_cvt_pk_bf16_f32 v13, v84, v84
v_cvt_pk_bf16_f32 v14, v88, v88
v_cvt_pk_bf16_f32 v15, v92, v92
v_cvt_pk_bf16_f32 v16, v96, v96
v_cvt_pk_bf16_f32 v17, v100, v100
ds_write_b16 v7, v8 offset:0
ds_write_b16 v7, v9 offset:128
ds_write_b16 v7, v10 offset:256
ds_write_b16 v7, v11 offset:384
ds_write_b16 v7, v12 offset:512
ds_write_b16 v7, v13 offset:640
ds_write_b16 v7, v14 offset:768
ds_write_b16 v7, v15 offset:896
ds_write_b16 v7, v16 offset:1024
ds_write_b16 v7, v17 offset:1152
s_and_b32 s42, s37, 7
s_lshr_b32 s43, 0xa5, s42
s_bitcmp1_b32 s43, 0
s_cbranch_scc0 L_chores_26
s_lshl_b32 s43, 1, s42
s_sub_u32 s43, s43, 1
s_and_b32 s43, s43, 0xa5
s_bcnt1_i32_b32 s43, s43
s_lshr_b32 s44, s37, 3
s_lshl_b32 s44, s44, 2
s_add_u32 s43, s43, s44
s_lshl_b32 s44, s36, 3
s_add_u32 s61, s43, s44
s_cmp_eq_u32 s40, 0
s_cbranch_scc1 L_nooh_27
s_mul_i32 s43, s36, 630784
s_mul_i32 s42, s37, 11520
s_add_u32 s42, s42, s43
s_add_u32 s42, s42, 1048832
v_add_u32 v4, 0, v1
v_min_u32 v4, 79, v4
v_lshrrev_b32 v5, 4, v4
v_mul_u32_u24 v5, 2304, v5
v_and_b32 v4, 15, v4
v_lshl_add_u32 v4, v4, 7, v5
buffer_load_dword v246, v4, s[12:15], s42 offen
v_add_u32 v4, 64, v1
v_min_u32 v4, 79, v4
v_lshrrev_b32 v5, 4, v4
v_mul_u32_u24 v5, 2304, v5
v_and_b32 v4, 15, v4
v_lshl_add_u32 v4, v4, 7, v5
buffer_load_dword v247, v4, s[12:15], s42 offen
s_and_b32 s42, s37, 7
s_mul_i32 s42, s42, 23040
s_add_u32 s42, s42, s43
s_lshr_b32 s44, s37, 3
s_lshl_b32 s44, s44, 10
s_add_u32 s42, s42, s44
s_add_u32 s42, s42, 1233152
v_add_u32 v4, 0, v1
v_min_u32 v4, 79, v4
v_lshrrev_b32 v5, 3, v4
v_mul_u32_u24 v5, 2304, v5
v_and_b32 v4, 7, v4
v_lshl_add_u32 v4, v4, 7, v5
buffer_load_dword v248, v4, s[12:15], s42 offen
v_add_u32 v4, 64, v1
v_min_u32 v4, 79, v4
v_lshrrev_b32 v5, 3, v4
v_mul_u32_u24 v5, 2304, v5
v_and_b32 v4, 7, v4
v_lshl_add_u32 v4, v4, 7, v5
buffer_load_dword v249, v4, s[12:15], s42 offen
s_xor_b32 s60, s37, 1
s_mul_i32 s43, s36, 630784
s_mul_i32 s42, s60, 11520
s_add_u32 s42, s42, s43
s_add_u32 s42, s42, 1048832
v_add_u32 v4, 0, v1
v_min_u32 v4, 79, v4
v_lshrrev_b32 v5, 4, v4
v_mul_u32_u24 v5, 2304, v5
v_and_b32 v4, 15, v4
v_lshl_add_u32 v4, v4, 7, v5
buffer_load_dword v246, v4, s[12:15], s42 offen
v_add_u32 v4, 64, v1
v_min_u32 v4, 79, v4
v_lshrrev_b32 v5, 4, v4
v_mul_u32_u24 v5, 2304, v5
v_and_b32 v4, 15, v4
v_lshl_add_u32 v4, v4, 7, v5
buffer_load_dword v247, v4, s[12:15], s42 offen
s_and_b32 s42, s60, 7
s_mul_i32 s42, s42, 23040
s_add_u32 s42, s42, s43
s_lshr_b32 s44, s60, 3
s_lshl_b32 s44, s44, 10
s_add_u32 s42, s42, s44
s_add_u32 s42, s42, 1233152
v_add_u32 v4, 0, v1
v_min_u32 v4, 79, v4
v_lshrrev_b32 v5, 3, v4
v_mul_u32_u24 v5, 2304, v5
v_and_b32 v4, 7, v4
v_lshl_add_u32 v4, v4, 7, v5
buffer_load_dword v248, v4, s[12:15], s42 offen
v_add_u32 v4, 64, v1
v_min_u32 v4, 79, v4
v_lshrrev_b32 v5, 3, v4
v_mul_u32_u24 v5, 2304, v5
v_and_b32 v4, 7, v4
v_lshl_add_u32 v4, v4, 7, v5
buffer_load_dword v249, v4, s[12:15], s42 offen
L_nooh_27:
s_mov_b32 s56, s76
s_mov_b32 s57, s77
s_mov_b32 s58, 0x1e0000
s_mov_b32 s59, 0x20000
s_mul_i32 s42, s61, 15360
v_add_u32 v4, 0, v1
v_min_u32 v4, 119, v4
v_lshlrev_b32 v4, 7, v4
buffer_load_dword v250, v4, s[56:59], s42 offen
v_add_u32 v4, 64, v1
v_min_u32 v4, 119, v4
v_lshlrev_b32 v4, 7, v4
buffer_load_dword v251, v4, s[56:59], s42 offen
s_mov_b32 s56, s78
s_mov_b32 s57, s79
s_mov_b32 s58, 0x1e0000
s_mov_b32 s59, 0x20000
s_mul_i32 s42, s61, 15360
v_add_u32 v4, 0, v1
v_min_u32 v4, 119, v4
v_lshlrev_b32 v4, 7, v4
buffer_load_dword v252, v4, s[56:59], s42 offen
v_add_u32 v4, 64, v1
v_min_u32 v4, 119, v4
v_lshlrev_b32 v4, 7, v4
buffer_load_dword v253, v4, s[56:59], s42 offen
s_mov_b32 s56, s80
s_mov_b32 s57, s81
s_mov_b32 s58, 0x1e0000
s_mov_b32 s59, 0x20000
s_mul_i32 s42, s61, 15360
v_add_u32 v4, 0, v1
v_min_u32 v4, 119, v4
v_lshlrev_b32 v4, 7, v4
buffer_load_dword v232, v4, s[56:59], s42 offen
v_add_u32 v4, 64, v1
v_min_u32 v4, 119, v4
v_lshlrev_b32 v4, 7, v4
buffer_load_dword v233, v4, s[56:59], s42 offen
L_chores_26:
s_waitcnt lgkmcnt(0)
s_barrier
s_barrier
s_barrier
s_barrier
s_barrier
s_barrier
s_barrier
s_barrier
s_barrier
s_barrier
s_barrier
s_barrier
s_barrier
s_barrier
s_barrier
s_barrier
s_barrier
s_barrier
s_mul_i32 s42, s37, 12
s_mul_i32 s43, s36, 630784
s_add_u32 s43, s43, 1048832
v_lshrrev_b32 v5, 4, v1
v_add_u32 v5, 0, v5
v_add_u32 v5, s42, v5
v_cmp_le_u32 vcc, 80, v5
v_add_u32 v6, 80, v5
s_nop 0
v_cndmask_b32 v5, v5, v6, vcc
v_mul_u32_u24 v5, 2304, v5
v_lshl_add_u32 v4, v2, 7, v5
buffer_load_dword v250, v4, s[12:15], s43 offen
v_lshrrev_b32 v5, 4, v1
v_add_u32 v5, 4, v5
v_add_u32 v5, s42, v5
v_cmp_le_u32 vcc, 80, v5
v_add_u32 v6, 80, v5
s_nop 0
v_cndmask_b32 v5, v5, v6, vcc
v_mul_u32_u24 v5, 2304, v5
v_lshl_add_u32 v4, v2, 7, v5
buffer_load_dword v251, v4, s[12:15], s43 offen
v_lshrrev_b32 v5, 4, v1
v_add_u32 v5, 8, v5
v_add_u32 v5, s42, v5
v_cmp_le_u32 vcc, 80, v5
v_add_u32 v6, 80, v5
s_nop 0
v_cndmask_b32 v5, v5, v6, vcc
v_mul_u32_u24 v5, 2304, v5
v_lshl_add_u32 v4, v2, 7, v5
buffer_load_dword v252, v4, s[12:15], s43 offen
s_barrier
s_barrier
s_barrier
s_barrier
s_barrier
s_barrier
s_barrier
s_barrier
s_barrier
s_barrier
s_barrier
s_waitcnt vmcnt(0)
s_endpgm
L_poll:
s_mov_b32 s51, 6
s_lshl_b32 s42, s51, 3
v_lshrrev_b32 v4, 3, v1
v_and_b32 v5, 7, v1
v_add_u32 v6, s42, v4
v_bfe_u32 v7, v6, 1, 3
v_xor_b32 v7, v7, v5
v_lshlrev_b32 v7, 4, v7
v_xor_b32 v8, 64, v7
s_lshl_b32 s43, s36, 7
s_sub_u32 s43, s43, 16
v_add_u32 v6, s43, v6
s_movk_i32 s44, 1280
v_add_u32 v9, 0, v6
v_max_i32 v9, 0, v9
v_mad_u32_u24 v36, v9, s44, v7
v_add_u32 v9, 8, v6
v_max_i32 v9, 0, v9
v_mad_u32_u24 v37, v9, s44, v8
v_add_u32 v9, 16, v6
v_max_i32 v9, 0, v9
v_mad_u32_u24 v38, v9, s44, v7
v_add_u32 v9, 24, v6
v_max_i32 v9, 0, v9
v_mad_u32_u24 v39, v9, s44, v8
v_add_u32 v9, 32, v6
v_max_i32 v9, 0, v9
v_mad_u32_u24 v40, v9, s44, v7
v_add_u32 v9, 40, v6
v_max_i32 v9, 0, v9
v_mad_u32_u24 v41, v9, s44, v8
v_add_u32 v9, 48, v6
v_max_i32 v9, 0, v9
v_mad_u32_u24 v42, v9, s44, v7
v_add_u32 v9, 56, v6
v_max_i32 v9, 0, v9
v_mad_u32_u24 v43, v9, s44, v8
v_add_u32 v9, 64, v6
v_max_i32 v9, 0, v9
v_mad_u32_u24 v44, v9, s44, v7
v_add_u32 v9, 72, v6
v_max_i32 v9, 0, v9
v_mad_u32_u24 v45, v9, s44, v8
v_add_u32 v9, 80, v6
v_max_i32 v9, 0, v9
v_mad_u32_u24 v46, v9, s44, v7
v_add_u32 v9, 88, v6
v_max_i32 v9, 0, v9
v_mad_u32_u24 v47, v9, s44, v8
s_lshl_b32 s92, s51, 10
s_lshr_b32 s42, s36, 3
s_mul_i32 s42, s42, 5
s_add_u32 s42, s42, s37
s_and_b32 s43, s36, 7
s_add_u32 s42, s42, s43
s_mul_i32 s43, s42, 26
s_lshr_b32 s43, s43, 8
s_mul_i32 s43, s43, 10
s_sub_u32 s95, s42, s43
s_waitcnt lgkmcnt(0)
s_mov_b32 s4, s68
s_mov_b32 s5, s69
s_mov_b32 s6, 0x280000
s_mov_b32 s7, 0x20000
s_mov_b32 s8, s70
s_mov_b32 s9, s71
s_mov_b32 s10, 0x258000
s_mov_b32 s11, 0x20000
s_mov_b32 s12, s86
s_mov_b32 s13, s87
s_mov_b32 s14, 0x3000000
s_mov_b32 s15, 0x20000
s_mov_b32 s20, s84
s_mov_b32 s21, s85
s_mov_b32 s22, 0x100
s_mov_b32 s23, 0x20000
s_mov_b32 s16, s82
s_mov_b32 s17, s83
s_mov_b32 s18, 0x280000
s_mov_b32 s19, 0x20000
s_cmp_lg_u32 s2, 0
s_cbranch_scc1 L_nolead_28
s_memrealtime s[42:43]
s_waitcnt lgkmcnt(0)
s_or_b32 s42, s42, 1
v_mov_b32 v4, s42
v_mov_b32 v5, 0
s_mov_b64 exec, 1
buffer_store_dword v4, v5, s[20:23], 0 offen sc1
s_mov_b64 exec, -1
L_nolead_28:
s_lshl_b32 s48, s95, 7
s_add_u32 s95, s95, 1
s_cmp_eq_u32 s95, 10
s_cselect_b32 s95, 0, s95
s_add_u32 m0, s92, 0
s_nop 0
buffer_load_dwordx4 v36, s[4:7], s48 offen lds
s_add_u32 m0, s92, 1024
s_nop 0
buffer_load_dwordx4 v37, s[4:7], s48 offen lds
s_add_u32 m0, s92, 2048
s_nop 0
buffer_load_dwordx4 v38, s[4:7], s48 offen lds
s_add_u32 m0, s92, 3072
s_nop 0
buffer_load_dwordx4 v39, s[4:7], s48 offen lds
s_add_u32 m0, s92, 4096
s_nop 0
buffer_load_dwordx4 v40, s[4:7], s48 offen lds
s_add_u32 m0, s92, 5120
s_nop 0
buffer_load_dwordx4 v41, s[4:7], s48 offen lds
s_add_u32 m0, s92, 6144
s_nop 0
buffer_load_dwordx4 v42, s[4:7], s48 offen lds
s_add_u32 m0, s92, 7168
s_nop 0
buffer_load_dwordx4 v43, s[4:7], s48 offen lds
s_add_u32 m0, s92, 8192
s_nop 0
buffer_load_dwordx4 v44, s[4:7], s48 offen lds
s_add_u32 m0, s92, 9216
s_nop 0
buffer_load_dwordx4 v45, s[4:7], s48 offen lds
s_add_u32 m0, s92, 10240
s_nop 0
buffer_load_dwordx4 v46, s[4:7], s48 offen lds
s_add_u32 m0, s92, 11264
s_nop 0
buffer_load_dwordx4 v47, s[4:7], s48 offen lds
s_waitcnt vmcnt(0)
s_barrier
s_lshl_b32 s48, s95, 7
s_add_u32 s95, s95, 1
s_cmp_eq_u32 s95, 10
s_cselect_b32 s95, 0, s95
s_add_u32 m0, s92, 18432
s_nop 0
buffer_load_dwordx4 v36, s[4:7], s48 offen lds
s_add_u32 m0, s92, 19456
s_nop 0
buffer_load_dwordx4 v37, s[4:7], s48 offen lds
s_add_u32 m0, s92, 20480
s_nop 0
buffer_load_dwordx4 v38, s[4:7], s48 offen lds
s_add_u32 m0, s92, 21504
s_nop 0
buffer_load_dwordx4 v39, s[4:7], s48 offen lds
s_add_u32 m0, s92, 22528
s_nop 0
buffer_load_dwordx4 v40, s[4:7], s48 offen lds
s_add_u32 m0, s92, 23552
s_nop 0
buffer_load_dwordx4 v41, s[4:7], s48 offen lds
s_add_u32 m0, s92, 24576
s_nop 0
buffer_load_dwordx4 v42, s[4:7], s48 offen lds
s_add_u32 m0, s92, 25600
s_nop 0
buffer_load_dwordx4 v43, s[4:7], s48 offen lds
s_add_u32 m0, s92, 26624
s_nop 0
buffer_load_dwordx4 v44, s[4:7], s48 offen lds
s_add_u32 m0, s92, 27648
s_nop 0
buffer_load_dwordx4 v45, s[4:7], s48 offen lds
s_add_u32 m0, s92, 28672
s_nop 0
buffer_load_dwordx4 v46, s[4:7], s48 offen lds
s_add_u32 m0, s92, 29696
s_nop 0
buffer_load_dwordx4 v47, s[4:7], s48 offen lds
s_lshl_b32 s48, s95, 7
s_add_u32 s95, s95, 1
s_cmp_eq_u32 s95, 10
s_cselect_b32 s95, 0, s95
s_add_u32 m0, s92, 102400
s_nop 0
buffer_load_dwordx4 v36, s[4:7], s48 offen lds
s_add_u32 m0, s92, 103424
s_nop 0
buffer_load_dwordx4 v37, s[4:7], s48 offen lds
s_add_u32 m0, s92, 104448
s_nop 0
buffer_load_dwordx4 v38, s[4:7], s48 offen lds
s_add_u32 m0, s92, 105472
s_nop 0
buffer_load_dwordx4 v39, s[4:7], s48 offen lds
s_add_u32 m0, s92, 106496
s_nop 0
buffer_load_dwordx4 v40, s[4:7], s48 offen lds
s_add_u32 m0, s92, 107520
s_nop 0
buffer_load_dwordx4 v41, s[4:7], s48 offen lds
s_add_u32 m0, s92, 108544
s_nop 0
buffer_load_dwordx4 v42, s[4:7], s48 offen lds
s_add_u32 m0, s92, 109568
s_nop 0
buffer_load_dwordx4 v43, s[4:7], s48 offen lds
s_add_u32 m0, s92, 110592
s_nop 0
buffer_load_dwordx4 v44, s[4:7], s48 offen lds
s_add_u32 m0, s92, 111616
s_nop 0
buffer_load_dwordx4 v45, s[4:7], s48 offen lds
s_add_u32 m0, s92, 112640
s_nop 0
buffer_load_dwordx4 v46, s[4:7], s48 offen lds
s_add_u32 m0, s92, 113664
s_nop 0
buffer_load_dwordx4 v47, s[4:7], s48 offen lds
s_waitcnt vmcnt(12)
s_barrier
s_lshl_b32 s48, s95, 7
s_add_u32 s95, s95, 1
s_cmp_eq_u32 s95, 10
s_cselect_b32 s95, 0, s95
s_add_u32 m0, s92, 120832
s_nop 0
buffer_load_dwordx4 v36, s[4:7], s48 offen lds
s_add_u32 m0, s92, 121856
s_nop 0
buffer_load_dwordx4 v37, s[4:7], s48 offen lds
s_add_u32 m0, s92, 122880
s_nop 0
buffer_load_dwordx4 v38, s[4:7], s48 offen lds
s_add_u32 m0, s92, 123904
s_nop 0
buffer_load_dwordx4 v39, s[4:7], s48 offen lds
s_add_u32 m0, s92, 124928
s_nop 0
buffer_load_dwordx4 v40, s[4:7], s48 offen lds
s_add_u32 m0, s92, 125952
s_nop 0
buffer_load_dwordx4 v41, s[4:7], s48 offen lds
s_add_u32 m0, s92, 126976
s_nop 0
buffer_load_dwordx4 v42, s[4:7], s48 offen lds
s_add_u32 m0, s92, 128000
s_nop 0
buffer_load_dwordx4 v43, s[4:7], s48 offen lds
s_add_u32 m0, s92, 129024
s_nop 0
buffer_load_dwordx4 v44, s[4:7], s48 offen lds
s_add_u32 m0, s92, 130048
s_nop 0
buffer_load_dwordx4 v45, s[4:7], s48 offen lds
s_add_u32 m0, s92, 131072
s_nop 0
buffer_load_dwordx4 v46, s[4:7], s48 offen lds
s_add_u32 m0, s92, 132096
s_nop 0
buffer_load_dwordx4 v47, s[4:7], s48 offen lds
s_waitcnt vmcnt(12)
s_barrier
s_lshl_b32 s48, s95, 7
s_add_u32 s95, s95, 1
s_cmp_eq_u32 s95, 10
s_cselect_b32 s95, 0, s95
s_add_u32 m0, s92, 0
s_nop 0
buffer_load_dwordx4 v36, s[4:7], s48 offen lds
s_add_u32 m0, s92, 1024
s_nop 0
buffer_load_dwordx4 v37, s[4:7], s48 offen lds
s_add_u32 m0, s92, 2048
s_nop 0
buffer_load_dwordx4 v38, s[4:7], s48 offen lds
s_add_u32 m0, s92, 3072
s_nop 0
buffer_load_dwordx4 v39, s[4:7], s48 offen lds
s_add_u32 m0, s92, 4096
s_nop 0
buffer_load_dwordx4 v40, s[4:7], s48 offen lds
s_add_u32 m0, s92, 5120
s_nop 0
buffer_load_dwordx4 v41, s[4:7], s48 offen lds
s_add_u32 m0, s92, 6144
s_nop 0
buffer_load_dwordx4 v42, s[4:7], s48 offen lds
s_add_u32 m0, s92, 7168
s_nop 0
buffer_load_dwordx4 v43, s[4:7], s48 offen lds
s_add_u32 m0, s92, 8192
s_nop 0
buffer_load_dwordx4 v44, s[4:7], s48 offen lds
s_add_u32 m0, s92, 9216
s_nop 0
buffer_load_dwordx4 v45, s[4:7], s48 offen lds
s_add_u32 m0, s92, 10240
s_nop 0
buffer_load_dwordx4 v46, s[4:7], s48 offen lds
s_add_u32 m0, s92, 11264
s_nop 0
buffer_load_dwordx4 v47, s[4:7], s48 offen lds
s_waitcnt vmcnt(12)
s_barrier
s_lshl_b32 s48, s95, 7
s_add_u32 s95, s95, 1
s_cmp_eq_u32 s95, 10
s_cselect_b32 s95, 0, s95
s_add_u32 m0, s92, 18432
s_nop 0
buffer_load_dwordx4 v36, s[4:7], s48 offen lds
s_add_u32 m0, s92, 19456
s_nop 0
buffer_load_dwordx4 v37, s[4:7], s48 offen lds
s_add_u32 m0, s92, 20480
s_nop 0
buffer_load_dwordx4 v38, s[4:7], s48 offen lds
s_add_u32 m0, s92, 21504
s_nop 0
buffer_load_dwordx4 v39, s[4:7], s48 offen lds
s_add_u32 m0, s92, 22528
s_nop 0
buffer_load_dwordx4 v40, s[4:7], s48 offen lds
s_add_u32 m0, s92, 23552
s_nop 0
buffer_load_dwordx4 v41, s[4:7], s48 offen lds
s_add_u32 m0, s92, 24576
s_nop 0
buffer_load_dwordx4 v42, s[4:7], s48 offen lds
s_add_u32 m0, s92, 25600
s_nop 0
buffer_load_dwordx4 v43, s[4:7], s48 offen lds
s_add_u32 m0, s92, 26624
s_nop 0
buffer_load_dwordx4 v44, s[4:7], s48 offen lds
s_add_u32 m0, s92, 27648
s_nop 0
buffer_load_dwordx4 v45, s[4:7], s48 offen lds
s_add_u32 m0, s92, 28672
s_nop 0
buffer_load_dwordx4 v46, s[4:7], s48 offen lds
s_add_u32 m0, s92, 29696
s_nop 0
buffer_load_dwordx4 v47, s[4:7], s48 offen lds
s_waitcnt vmcnt(12)
s_barrier
s_lshl_b32 s48, s95, 7
s_add_u32 s95, s95, 1
s_cmp_eq_u32 s95, 10
s_cselect_b32 s95, 0, s95
s_add_u32 m0, s92, 102400
s_nop 0
buffer_load_dwordx4 v36, s[4:7], s48 offen lds
s_add_u32 m0, s92, 103424
s_nop 0
buffer_load_dwordx4 v37, s[4:7], s48 offen lds
s_add_u32 m0, s92, 104448
s_nop 0
buffer_load_dwordx4 v38, s[4:7], s48 offen lds
s_add_u32 m0, s92, 105472
s_nop 0
buffer_load_dwordx4 v39, s[4:7], s48 offen lds
s_add_u32 m0, s92, 106496
s_nop 0
buffer_load_dwordx4 v40, s[4:7], s48 offen lds
s_add_u32 m0, s92, 107520
s_nop 0
buffer_load_dwordx4 v41, s[4:7], s48 offen lds
s_add_u32 m0, s92, 108544
s_nop 0
buffer_load_dwordx4 v42, s[4:7], s48 offen lds
s_add_u32 m0, s92, 109568
s_nop 0
buffer_load_dwordx4 v43, s[4:7], s48 offen lds
s_add_u32 m0, s92, 110592
s_nop 0
buffer_load_dwordx4 v44, s[4:7], s48 offen lds
s_add_u32 m0, s92, 111616
s_nop 0
buffer_load_dwordx4 v45, s[4:7], s48 offen lds
s_add_u32 m0, s92, 112640
s_nop 0
buffer_load_dwordx4 v46, s[4:7], s48 offen lds
s_add_u32 m0, s92, 113664
s_nop 0
buffer_load_dwordx4 v47, s[4:7], s48 offen lds
s_waitcnt vmcnt(12)
s_barrier
s_lshl_b32 s48, s95, 7
s_add_u32 s95, s95, 1
s_cmp_eq_u32 s95, 10
s_cselect_b32 s95, 0, s95
s_add_u32 m0, s92, 120832
s_nop 0
buffer_load_dwordx4 v36, s[4:7], s48 offen lds
s_add_u32 m0, s92, 121856
s_nop 0
buffer_load_dwordx4 v37, s[4:7], s48 offen lds
s_add_u32 m0, s92, 122880
s_nop 0
buffer_load_dwordx4 v38, s[4:7], s48 offen lds
s_add_u32 m0, s92, 123904
s_nop 0
buffer_load_dwordx4 v39, s[4:7], s48 offen lds
s_add_u32 m0, s92, 124928
s_nop 0
buffer_load_dwordx4 v40, s[4:7], s48 offen lds
s_add_u32 m0, s92, 125952
s_nop 0
buffer_load_dwordx4 v41, s[4:7], s48 offen lds
s_add_u32 m0, s92, 126976
s_nop 0
buffer_load_dwordx4 v42, s[4:7], s48 offen lds
s_add_u32 m0, s92, 128000
s_nop 0
buffer_load_dwordx4 v43, s[4:7], s48 offen lds
s_add_u32 m0, s92, 129024
s_nop 0
buffer_load_dwordx4 v44, s[4:7], s48 offen lds
s_add_u32 m0, s92, 130048
s_nop 0
buffer_load_dwordx4 v45, s[4:7], s48 offen lds
s_add_u32 m0, s92, 131072
s_nop 0
buffer_load_dwordx4 v46, s[4:7], s48 offen lds
s_add_u32 m0, s92, 132096
s_nop 0
buffer_load_dwordx4 v47, s[4:7], s48 offen lds
s_waitcnt vmcnt(12)
s_barrier
s_lshl_b32 s48, s95, 7
s_add_u32 s95, s95, 1
s_cmp_eq_u32 s95, 10
s_cselect_b32 s95, 0, s95
s_add_u32 m0, s92, 0
s_nop 0
buffer_load_dwordx4 v36, s[4:7], s48 offen lds
s_add_u32 m0, s92, 1024
s_nop 0
buffer_load_dwordx4 v37, s[4:7], s48 offen lds
s_add_u32 m0, s92, 2048
s_nop 0
buffer_load_dwordx4 v38, s[4:7], s48 offen lds
s_add_u32 m0, s92, 3072
s_nop 0
buffer_load_dwordx4 v39, s[4:7], s48 offen lds
s_add_u32 m0, s92, 4096
s_nop 0
buffer_load_dwordx4 v40, s[4:7], s48 offen lds
s_add_u32 m0, s92, 5120
s_nop 0
buffer_load_dwordx4 v41, s[4:7], s48 offen lds
s_add_u32 m0, s92, 6144
s_nop 0
buffer_load_dwordx4 v42, s[4:7], s48 offen lds
s_add_u32 m0, s92, 7168
s_nop 0
buffer_load_dwordx4 v43, s[4:7], s48 offen lds
s_add_u32 m0, s92, 8192
s_nop 0
buffer_load_dwordx4 v44, s[4:7], s48 offen lds
s_add_u32 m0, s92, 9216
s_nop 0
buffer_load_dwordx4 v45, s[4:7], s48 offen lds
s_add_u32 m0, s92, 10240
s_nop 0
buffer_load_dwordx4 v46, s[4:7], s48 offen lds
s_add_u32 m0, s92, 11264
s_nop 0
buffer_load_dwordx4 v47, s[4:7], s48 offen lds
s_waitcnt vmcnt(12)
s_barrier
s_lshl_b32 s48, s95, 7
s_add_u32 s95, s95, 1
s_cmp_eq_u32 s95, 10
s_cselect_b32 s95, 0, s95
s_add_u32 m0, s92, 18432
s_nop 0
buffer_load_dwordx4 v36, s[4:7], s48 offen lds
s_add_u32 m0, s92, 19456
s_nop 0
buffer_load_dwordx4 v37, s[4:7], s48 offen lds
s_add_u32 m0, s92, 20480
s_nop 0
buffer_load_dwordx4 v38, s[4:7], s48 offen lds
s_add_u32 m0, s92, 21504
s_nop 0
buffer_load_dwordx4 v39, s[4:7], s48 offen lds
s_add_u32 m0, s92, 22528
s_nop 0
buffer_load_dwordx4 v40, s[4:7], s48 offen lds
s_add_u32 m0, s92, 23552
s_nop 0
buffer_load_dwordx4 v41, s[4:7], s48 offen lds
s_add_u32 m0, s92, 24576
s_nop 0
buffer_load_dwordx4 v42, s[4:7], s48 offen lds
s_add_u32 m0, s92, 25600
s_nop 0
buffer_load_dwordx4 v43, s[4:7], s48 offen lds
s_add_u32 m0, s92, 26624
s_nop 0
buffer_load_dwordx4 v44, s[4:7], s48 offen lds
s_add_u32 m0, s92, 27648
s_nop 0
buffer_load_dwordx4 v45, s[4:7], s48 offen lds
s_add_u32 m0, s92, 28672
s_nop 0
buffer_load_dwordx4 v46, s[4:7], s48 offen lds
s_add_u32 m0, s92, 29696
s_nop 0
buffer_load_dwordx4 v47, s[4:7], s48 offen lds
s_waitcnt vmcnt(12)
s_barrier
s_waitcnt vmcnt(0)
s_barrier
s_barrier
v_mov_b32 v10, 139264
ds_read_b64 v[8:9], v10
s_waitcnt lgkmcnt(0)
v_readfirstlane_b32 s39, v8
v_readfirstlane_b32 s40, v9
s_nop 2
s_barrier
s_and_b32 s42, s37, 7
s_lshr_b32 s43, 0xa5, s42
s_bitcmp1_b32 s43, 0
s_cbranch_scc0 L_norep_29
s_lshl_b32 s43, 1, s42
s_sub_u32 s43, s43, 1
s_and_b32 s43, s43, 0xa5
s_bcnt1_i32_b32 s43, s43
s_lshr_b32 s44, s37, 3
s_lshl_b32 s44, s44, 2
s_add_u32 s43, s43, s44
s_lshl_b32 s44, s36, 3
s_add_u32 s61, s43, s44
s_mov_b32 s88, s80
s_mov_b32 s89, s81
s_mov_b32 s90, 0x1e0000
s_mov_b32 s91, 0x20000
s_mul_i32 s42, s61, 3
s_add_u32 s44, s42, 0
s_mul_i32 s51, s44, 1366
s_lshr_b32 s51, s51, 16
s_mul_i32 s52, s51, 48
s_sub_u32 s52, s44, s52
s_mul_i32 s52, s52, 40960
s_mul_i32 s51, s51, 160
s_add_u32 s52, s52, s51
s_mul_i32 s44, s44, 5120
s_add_u32 s44, s44, 25165824
s_add_u32 s24, s44, 0
v_add_u32 v4, 0, v1
v_mul_u32_u24 v5, 6554, v4
v_lshrrev_b32 v6, 16, v5
v_mul_u32_u24 v5, 10, v6
v_sub_u32 v7, v4, v5
v_mul_u32_u24 v6, 1280, v6
v_lshl_add_u32 v10, v7, 4, v6
v_add_u32 v32, s52, v10
s_add_u32 s25, s44, 1024
v_add_u32 v4, 64, v1
v_mul_u32_u24 v5, 6554, v4
v_lshrrev_b32 v6, 16, v5
v_mul_u32_u24 v5, 10, v6
v_sub_u32 v7, v4, v5
v_mul_u32_u24 v6, 1280, v6
v_lshl_add_u32 v11, v7, 4, v6
v_add_u32 v33, s52, v11
s_add_u32 s26, s44, 2048
v_add_u32 v4, 128, v1
v_mul_u32_u24 v5, 6554, v4
v_lshrrev_b32 v6, 16, v5
v_mul_u32_u24 v5, 10, v6
v_sub_u32 v7, v4, v5
v_mul_u32_u24 v6, 1280, v6
v_lshl_add_u32 v12, v7, 4, v6
v_add_u32 v34, s52, v12
s_add_u32 s27, s44, 3072
v_add_u32 v4, 192, v1
v_mul_u32_u24 v5, 6554, v4
v_lshrrev_b32 v6, 16, v5
v_mul_u32_u24 v5, 10, v6
v_sub_u32 v7, v4, v5
v_mul_u32_u24 v6, 1280, v6
v_lshl_add_u32 v13, v7, 4, v6
v_add_u32 v35, s52, v13
s_add_u32 s28, s44, 4096
v_add_u32 v4, 256, v1
v_mul_u32_u24 v5, 6554, v4
v_lshrrev_b32 v6, 16, v5
v_mul_u32_u24 v5, 10, v6
v_sub_u32 v7, v4, v5
v_mul_u32_u24 v6, 1280, v6
v_lshl_add_u32 v14, v7, 4, v6
v_add_u32 v36, s52, v14
s_add_u32 s44, s42, 1
s_mul_i32 s51, s44, 1366
s_lshr_b32 s51, s51, 16
s_mul_i32 s52, s51, 48
s_sub_u32 s52, s44, s52
s_mul_i32 s52, s52, 40960
s_mul_i32 s51, s51, 160
s_add_u32 s52, s52, s51
s_mul_i32 s44, s44, 5120
s_add_u32 s44, s44, 25165824
s_add_u32 s29, s44, 0
v_add_u32 v37, s52, v10
s_add_u32 s30, s44, 1024
v_add_u32 v38, s52, v11
s_add_u32 s31, s44, 2048
v_add_u32 v39, s52, v12
s_add_u32 s32, s44, 3072
v_add_u32 v40, s52, v13
s_add_u32 s33, s44, 4096
v_add_u32 v41, s52, v14
s_add_u32 s44, s42, 2
s_mul_i32 s51, s44, 1366
s_lshr_b32 s51, s51, 16
s_mul_i32 s52, s51, 48
s_sub_u32 s52, s44, s52
s_mul_i32 s52, s52, 40960
s_mul_i32 s51, s51, 160
s_add_u32 s52, s52, s51
s_mul_i32 s44, s44, 5120
s_add_u32 s44, s44, 25165824
s_add_u32 s34, s44, 0
v_add_u32 v42, s52, v10
s_add_u32 s35, s44, 1024
v_add_u32 v43, s52, v11
s_add_u32 s62, s44, 2048
v_add_u32 v44, s52, v12
s_add_u32 s63, s44, 3072
v_add_u32 v45, s52, v13
s_add_u32 s64, s44, 4096
v_add_u32 v46, s52, v14
buffer_load_dwordx4 v[64:67], v32, s[88:91], 0 offen
buffer_load_dwordx4 v[68:71], v33, s[88:91], 0 offen
buffer_load_dwordx4 v[72:75], v34, s[88:91], 0 offen
buffer_load_dwordx4 v[76:79], v35, s[88:91], 0 offen
buffer_load_dwordx4 v[80:83], v36, s[88:91], 0 offen
buffer_load_dwordx4 v[84:87], v37, s[88:91], 0 offen
buffer_load_dwordx4 v[88:91], v38, s[88:91], 0 offen
buffer_load_dwordx4 v[92:95], v39, s[88:91], 0 offen
buffer_load_dwordx4 v[96:99], v40, s[88:91], 0 offen
buffer_load_dwordx4 v[100:103], v41, s[88:91], 0 offen
buffer_load_dwordx4 v[104:107], v42, s[88:91], 0 offen
buffer_load_dwordx4 v[108:111], v43, s[88:91], 0 offen
buffer_load_dwordx4 v[112:115], v44, s[88:91], 0 offen
buffer_load_dwordx4 v[116:119], v45, s[88:91], 0 offen
buffer_load_dwordx4 v[120:123], v46, s[88:91], 0 offen
v_lshlrev_b32 v4, 4, v1
s_waitcnt vmcnt(14)
buffer_store_dwordx4 v[64:67], v4, s[12:15], s24 offen sc1
s_waitcnt vmcnt(14)
buffer_store_dwordx4 v[68:71], v4, s[12:15], s25 offen sc1
s_waitcnt vmcnt(14)
buffer_store_dwordx4 v[72:75], v4, s[12:15], s26 offen sc1
s_waitcnt vmcnt(14)
buffer_store_dwordx4 v[76:79], v4, s[12:15], s27 offen sc1
s_waitcnt vmcnt(14)
buffer_store_dwordx4 v[80:83], v4, s[12:15], s28 offen sc1
s_waitcnt vmcnt(14)
buffer_store_dwordx4 v[84:87], v4, s[12:15], s29 offen sc1
s_waitcnt vmcnt(14)
buffer_store_dwordx4 v[88:91], v4, s[12:15], s30 offen sc1
s_waitcnt vmcnt(14)
buffer_store_dwordx4 v[92:95], v4, s[12:15], s31 offen sc1
s_waitcnt vmcnt(14)
buffer_store_dwordx4 v[96:99], v4, s[12:15], s32 offen sc1
s_waitcnt vmcnt(14)
buffer_store_dwordx4 v[100:103], v4, s[12:15], s33 offen sc1
s_waitcnt vmcnt(14)
buffer_store_dwordx4 v[104:107], v4, s[12:15], s34 offen sc1
s_waitcnt vmcnt(14)
buffer_store_dwordx4 v[108:111], v4, s[12:15], s35 offen sc1
s_waitcnt vmcnt(14)
buffer_store_dwordx4 v[112:115], v4, s[12:15], s62 offen sc1
s_waitcnt vmcnt(14)
buffer_store_dwordx4 v[116:119], v4, s[12:15], s63 offen sc1
s_waitcnt vmcnt(14)
buffer_store_dwordx4 v[120:123], v4, s[12:15], s64 offen sc1
L_norep_29:
s_lshl_b32 s42, s36, 8
s_add_u32 s43, s39, 1
v_mov_b32 v4, s43
s_lshl_b32 s44, s37, 2
v_mov_b32 v5, s44
v_lshlrev_b32 v6, 2, v2
s_mov_b32 s45, 100000
v_cmp_ne_u32 s[48:49], s37, v2
s_barrier
s_mov_b64 exec, 1
s_cmp_eq_u32 s40, 0
s_cbranch_scc1 L_fsafe_30
buffer_store_dword v4, v5, s[12:15], s42 offen
s_branch L_fdone_31
L_fsafe_30:
buffer_store_dword v4, v5, s[12:15], s42 offen sc1
L_fdone_31:
s_mov_b64 exec, -1
buffer_load_dword v7, v6, s[12:15], s42 offen sc1
s_barrier
s_branch L_pchk_34
L_ptop_32:
buffer_load_dword v7, v6, s[12:15], s42 offen sc1
L_pchk_34:
s_waitcnt vmcnt(0)
v_subrev_u32 v7, s43, v7
v_cmp_lt_u32 vcc, 2, v7
s_nop 1
s_and_b64 vcc, vcc, s[48:49]
s_cmp_eq_u64 vcc, 0
s_cbranch_scc1 L_pgot_33
s_sub_u32 s45, s45, 1
s_cmp_lg_u32 s45, 0
s_cbranch_scc1 L_ptop_32
L_pgot_33:
s_cmp_lg_u32 s40, 0
s_cbranch_scc1 L_pfast_35
buffer_inv sc1
s_waitcnt vmcnt(0)
L_pfast_35:
s_barrier
s_waitcnt vmcnt(0)
v_mov_b32 v4, s39
s_lshl_b32 s42, s2, 2
s_add_u32 s42, s42, 4096
v_mov_b32 v5, 0
s_mov_b64 exec, 1
buffer_store_dword v4, v5, s[12:15], s42 offen sc1
s_mov_b64 exec, -1
s_barrier
s_barrier
s_barrier
s_lshl_b32 s42, s36, 8
s_add_u32 s43, s39, 2
v_mov_b32 v4, s43
s_lshl_b32 s44, s37, 2
v_mov_b32 v5, s44
v_lshlrev_b32 v6, 2, v2
v_lshlrev_b32 v10, 4, v1
s_mov_b32 s44, 4096
s_mov_b32 s45, 100000
v_cmp_ne_u32 s[48:49], s37, v2
s_waitcnt vmcnt(0)
s_barrier
s_mov_b64 exec, 1
s_cmp_eq_u32 s40, 0
s_cbranch_scc1 L_fsafe_36
buffer_store_dword v4, v5, s[12:15], s42 offen
s_branch L_fdone_37
L_fsafe_36:
buffer_store_dword v4, v5, s[12:15], s42 offen sc1
L_fdone_37:
s_mov_b64 exec, -1
buffer_load_dword v7, v6, s[12:15], s42 offen sc1
buffer_load_dwordx4 v[12:15], v10, s[12:15], s44 offen sc1
s_barrier
s_branch L_pchk_40
L_ptop_38:
buffer_load_dword v7, v6, s[12:15], s42 offen sc1
buffer_load_dwordx4 v[12:15], v10, s[12:15], s44 offen sc1
L_pchk_40:
s_waitcnt vmcnt(0)
v_subrev_u32 v7, s43, v7
v_cmp_lt_u32 vcc, 1, v7
v_xor_b32 v12, s39, v12
v_xor_b32 v13, s39, v13
v_xor_b32 v14, s39, v14
v_xor_b32 v15, s39, v15
v_or3_b32 v12, v12, v13, v14
v_or_b32 v12, v12, v15
v_cmp_ne_u32 s[46:47], 0, v12
s_nop 1
s_and_b64 vcc, vcc, s[48:49]
s_or_b64 vcc, vcc, s[46:47]
s_cmp_eq_u64 vcc, 0
s_cbranch_scc1 L_pgot_39
s_sub_u32 s45, s45, 1
s_cmp_lg_u32 s45, 0
s_cbranch_scc1 L_ptop_38
L_pgot_39:
s_cmp_lg_u32 s40, 0
s_cbranch_scc1 L_pfast_41
buffer_inv sc1
s_waitcnt vmcnt(0)
L_pfast_41:
s_barrier
s_barrier
s_barrier
s_barrier
s_barrier
s_barrier
s_barrier
s_barrier
s_barrier
s_barrier
s_barrier
s_lshl_b32 s42, s36, 8
s_add_u32 s43, s39, 3
v_mov_b32 v4, s43
s_lshl_b32 s44, s37, 2
v_mov_b32 v5, s44
v_lshlrev_b32 v6, 2, v2
s_mov_b32 s45, 100000
v_cmp_ne_u32 s[48:49], s37, v2
s_waitcnt vmcnt(0)
s_barrier
s_mov_b64 exec, 1
s_cmp_eq_u32 s40, 0
s_cbranch_scc1 L_fsafe_42
buffer_store_dword v4, v5, s[12:15], s42 offen
s_branch L_fdone_43
L_fsafe_42:
buffer_store_dword v4, v5, s[12:15], s42 offen sc1
L_fdone_43:
s_mov_b64 exec, -1
buffer_load_dword v7, v6, s[12:15], s42 offen sc1
s_barrier
s_branch L_pchk_46
L_ptop_44:
buffer_load_dword v7, v6, s[12:15], s42 offen sc1
L_pchk_46:
s_waitcnt vmcnt(0)
v_subrev_u32 v7, s43, v7
v_cmp_lt_u32 vcc, 0, v7
s_nop 1
s_and_b64 vcc, vcc, s[48:49]
s_cmp_eq_u64 vcc, 0
s_cbranch_scc1 L_pgot_45
s_sub_u32 s45, s45, 1
s_cmp_lg_u32 s45, 0
s_cbranch_scc1 L_ptop_44
L_pgot_45:
s_cmp_lg_u32 s40, 0
s_cbranch_scc1 L_pfast_47
buffer_inv sc1
s_waitcnt vmcnt(0)
L_pfast_47:
s_barrier
s_barrier
s_barrier
s_barrier
s_barrier
s_barrier
s_barrier
s_waitcnt vmcnt(0)
s_endpgm
L_end:
s_endpgm
L_code_end:

.section .rodata,"a"
.p2align 6
.amdhsa_kernel sequential_preLN__sliding_local_dilated__glu_gated_glu__prompt_kernel
  .amdhsa_next_free_vgpr 256
  .amdhsa_next_free_sgpr 102
  .amdhsa_accum_offset 256
  .amdhsa_group_segment_fixed_size 0
  .amdhsa_kernarg_size 80
  .amdhsa_user_sgpr_count 2
  .amdhsa_user_sgpr_kernarg_segment_ptr 1
  .amdhsa_system_sgpr_workgroup_id_x 1
.end_amdhsa_kernel
```
